```python
import torch

def _softmax(x, axis=-1):
    return torch.softmax(x, dim=axis)
def _gelu(x):
    return torch.nn.functional.gelu(x, approximate="tanh")
def _silu(x):
    return torch.nn.functional.silu(x)
def _sigmoid(x):
    return torch.sigmoid(x)
def _layernorm(x, axis=-1, eps=1e-5):
    m = x.mean(dim=axis, keepdim=True)
    v = x.var(dim=axis, keepdim=True, unbiased=False)
    return (x - m) / torch.sqrt(v + eps)
def _scatter_add(tgt, idx, src, axis=0):
    return tgt.clone().index_add_(axis, idx, src)
def _segment_sum(src, seg, n):
    out = torch.zeros((n,) + src.shape[1:], dtype=src.dtype)
    return out.index_add_(0, seg, src)
def _pad(x, pw):
    flat = tuple(v for pair in reversed(pw) for v in pair)
    return torch.nn.functional.pad(x, flat)

kernel_name = 'parallel_sum__linear_kernel_hedgehog__mixer_s_mlp__prompt'

def setup_inputs():

    _w = (lambda a: (lambda t: t.to(torch.bfloat16) if t.is_floating_point() else t)(torch.as_tensor(a)))
    def _A_setup():
        B, S, D, H = 1, 2048, 576, 32
        Dh = D // H
        return {
            "x": _w((lambda *s: torch.randn(*s, dtype=torch.bfloat16) * 0.05)(B, S, D)),
            "wqkv": _w((lambda *s: torch.randn(*s, dtype=torch.bfloat16) * 0.8)(D, 3 * D)),
            "w_phi": _w((lambda *s: torch.randn(*s, dtype=torch.bfloat16) * 0.8)(H, Dh, Dh) * (Dh ** -0.5)),
            "wo": _w((lambda *s: torch.randn(*s, dtype=torch.bfloat16) * 0.1)(D, D)),
        }
    _A_in = _A_setup()

    def _B_setup():
        B, S, D, F = 1, 2048, 576, 4608
        return {
            "x":  _w((lambda *s: torch.randn(*s, dtype=torch.bfloat16) * 0.05)(B, S, D)),
            "w1": _w((lambda *s: torch.randn(*s, dtype=torch.bfloat16) * 3.2)(D, D) * (D ** -0.5)),
            "w2": _w((lambda *s: torch.randn(*s, dtype=torch.bfloat16) * 3.2)(D, D) * (D ** -0.5)),
            "w3": _w((lambda *s: torch.randn(*s, dtype=torch.bfloat16) * 3.2)(D, F) * (D ** -0.5)),
            "w4": _w((lambda *s: torch.randn(*s, dtype=torch.bfloat16) * 3.2)(F, D) * (F ** -0.5)),
        }
    _B_in = _B_setup()

    return {
        "A_x": _A_in["x"],
        "A_wqkv": _A_in["wqkv"],
        "A_w_phi": _A_in["w_phi"],
        "A_wo": _A_in["wo"],
        "B_x": _B_in["x"],
        "B_w1": _B_in["w1"],
        "B_w2": _B_in["w2"],
        "B_w3": _B_in["w3"],
        "B_w4": _B_in["w4"],
    }

def reference(A_x, A_wqkv, A_w_phi, A_wo, B_x, B_w1, B_w2, B_w3, B_w4):
    def _A_ref(x, wqkv, w_phi, wo):
        B, S, D = x.shape
        H = 32; Dh = D // H
        qkv = (lambda x, *d: x.permute(*d))((x @ wqkv).reshape(B, S, 3, H, Dh), 2, 0, 3, 1, 4)
        q, k, v = qkv[0], qkv[1], qkv[2]
        pq = torch.einsum("bhsd,hdf->bhsf", q, w_phi)
        pk = torch.einsum("bhsd,hdf->bhsf", k, w_phi)
        phi_q = torch.concatenate([_softmax(pq, axis=-1), _softmax(-pq, axis=-1)], axis=-1)
        phi_k = torch.concatenate([_softmax(pk, axis=-1), _softmax(-pk, axis=-1)], axis=-1)
        kv = torch.einsum("bhsf,bhsd->bhfd", phi_k, v)
        z  = torch.einsum("bhsf->bhf", phi_k)
        num = torch.einsum("bhqf,bhfd->bhqd", phi_q, kv)
        den = torch.einsum("bhqf,bhf->bhq", phi_q, z)[..., None] + 1e-6
        o = num / den
        return (lambda x, *d: x.permute(*d))(o, 0, 2, 1, 3).reshape(B, S, D) @ wo

    def _B_ref(x, w1, w2, w3, w4):
        B, S, D = x.shape
        h = _gelu(_layernorm(x, axis=-1) @ w1)
        c = D // 4
        g0 = _pad(h[:, :, 0*c:1*c], ((0, 0), (1, 0), (0, 0)))[:, :S, :]
        g1 = _pad(h[:, :, 1*c:2*c], ((0, 0), (0, 1), (0, 0)))[:, 1:, :]
        g2 = _pad(h[:, :, 2*c:3*c], ((0, 0), (2, 0), (0, 0)))[:, :S, :]
        g3 = _pad(h[:, :, 3*c:   ], ((0, 0), (0, 2), (0, 0)))[:, 2:, :]
        hs = torch.concatenate([g0, g1, g2, g3], axis=-1) @ w2
        x1 = x + hs
        h2 = _gelu(_layernorm(x1, axis=-1) @ w3) @ w4
        return x1 + h2

    x = A_x
    xn = _layernorm(x, axis=-1)
    return x + _A_ref(xn, A_wqkv, A_w_phi, A_wo) + _B_ref(xn, B_w1, B_w2, B_w3, B_w4)
```

```asm
; @launch grid=(256,1,1) block=(512,1,1) lds=163840
.amdgcn_target "amdgcn-amd-amdhsa--gfx950"
.text
    .globl parallel_sum__linear_kernel_hedgehog__mixer_s_mlp__prompt_kernel
    .p2align 8
    .type parallel_sum__linear_kernel_hedgehog__mixer_s_mlp__prompt_kernel,@function
parallel_sum__linear_kernel_hedgehog__mixer_s_mlp__prompt_kernel:
    s_cmp_ge_u32 s2, 256
    s_cbranch_scc1 L_end
    s_load_dwordx16 s[36:51], s[0:1], 0
    s_load_dwordx8 s[52:59], s[0:1], 64
    s_getpc_b64 s[96:97]
L_pc0:
    s_lshr_b32 s3, s2, 3
    v_cmp_gt_u32 vcc, 16, v0
    v_lshl_add_u32 v1, v0, 5, s3
    v_lshlrev_b32 v1, 7, v1
    s_and_saveexec_b64 s[4:5], vcc
    s_cbranch_execz L_nopf
    global_load_dword v255, v1, s[96:97]
L_nopf:
    s_mov_b64 exec, -1
    v_lshrrev_b32 v1, 6, v0
    v_and_b32 v0, 63, v0
    v_readfirstlane_b32 s20, v1
    s_and_b32 s31, s2, 7
    s_lshr_b32 s32, s2, 3
    s_and_b32 s23, s31, 1
    s_lshl_b32 s23, s23, 2
    s_and_b32 s33, s32, 3
    s_add_u32 s23, s23, s33
    s_lshr_b32 s22, s31, 1
    s_lshl_b32 s22, s22, 3
    s_lshr_b32 s33, s32, 2
    s_add_u32 s22, s22, s33
    s_and_b32 s21, s20, 3
    v_and_b32 v1, 15, v0
    v_lshrrev_b32 v2, 4, v0
    v_lshlrev_b32 v3, 4, v0
    v_mov_b32 v12, 1
    v_mov_b32 v13, 162816
    s_mov_b32 s28, 0xffff0000
    s_mov_b32 s29, 0x3f80
    s_mov_b32 s30, 0x3f800000
    s_cmp_ge_u32 s20, 4
    s_cbranch_scc1 L_grp_b
    s_lshl2_add_u32 s27, s22, s21
    v_lshrrev_b32 v16, 3, v0
    v_and_b32 v17, 7, v0
    v_xor_b32 v17, v17, v2
    v_mul_u32_u24 v16, 1152, v16
    v_lshl_add_u32 v62, v17, 4, v16
    v_xor_b32 v63, 64, v62
    v_add_u32 v63, 9216, v63
    s_mul_i32 s96, s27, 18432
    s_mul_i32 s97, s21, 18432
    s_add_u32 s97, s97, 0
    v_mov_b32 v24, 0
    v_lshl_add_u32 v25, v0, 2, v13
    ds_write_b32 v25, v24
    s_and_b32 s31, s23, 3
    s_mul_i32 s31, s31, 2
    s_lshr_b32 s32, s23, 2
    s_mul_i32 s32, s32, 1
    s_add_u32 s31, s31, s32
    s_mul_i32 s32, s22, 1
    s_add_u32 s31, s31, s32
    s_mul_i32 s32, s31, 7282
    s_lshr_b32 s32, s32, 16
    s_mul_i32 s32, s32, 9
    s_sub_u32 s83, s31, s32
    s_lshl_b32 s74, s83, 7
    s_add_u32 s75, s74, 128
    s_cmp_eq_u32 s75, 1152
    s_cselect_b32 s75, 0, s75
    s_add_u32 s76, s75, 128
    s_cmp_eq_u32 s76, 1152
    s_cselect_b32 s76, 0, s76
    s_add_u32 s77, s76, 128
    s_cmp_eq_u32 s77, 1152
    s_cselect_b32 s77, 0, s77
    s_add_u32 s78, s77, 128
    s_cmp_eq_u32 s78, 1152
    s_cselect_b32 s78, 0, s78
    s_add_u32 s79, s78, 128
    s_cmp_eq_u32 s79, 1152
    s_cselect_b32 s79, 0, s79
    s_add_u32 s80, s79, 128
    s_cmp_eq_u32 s80, 1152
    s_cselect_b32 s80, 0, s80
    s_add_u32 s81, s80, 128
    s_cmp_eq_u32 s81, 1152
    s_cselect_b32 s81, 0, s81
    s_add_u32 s82, s81, 128
    s_cmp_eq_u32 s82, 1152
    s_cselect_b32 s82, 0, s82
    v_add_u32 v62, s96, v62
    v_add_u32 v63, s96, v63
    s_setprio 2
    s_waitcnt lgkmcnt(0)
    s_barrier
    s_mov_b32 s8, s36
    s_and_b32 s9, s37, 0xffff
    s_mov_b32 s10, 2359296
    s_mov_b32 s11, 0x20000
    s_mov_b32 s4, s58
    s_and_b32 s5, s59, 0xffff
    s_mov_b32 s6, 268435456
    s_mov_b32 s7, 0x20000
    s_add_u32 m0, s97, 0
    s_nop 0
    buffer_load_dwordx4 v62, s[8:11], s74 offen lds
    s_add_u32 m0, s97, 1024
    s_nop 0
    buffer_load_dwordx4 v63, s[8:11], s74 offen lds
    s_add_u32 m0, s97, 2048
    s_nop 0
    buffer_load_dwordx4 v62, s[8:11], s75 offen lds
    s_add_u32 m0, s97, 3072
    s_nop 0
    buffer_load_dwordx4 v63, s[8:11], s75 offen lds
    s_add_u32 m0, s97, 4096
    s_nop 0
    buffer_load_dwordx4 v62, s[8:11], s76 offen lds
    s_add_u32 m0, s97, 5120
    s_nop 0
    buffer_load_dwordx4 v63, s[8:11], s76 offen lds
    s_add_u32 m0, s97, 6144
    s_nop 0
    buffer_load_dwordx4 v62, s[8:11], s77 offen lds
    s_add_u32 m0, s97, 7168
    s_nop 0
    buffer_load_dwordx4 v63, s[8:11], s77 offen lds
    s_add_u32 m0, s97, 8192
    s_nop 0
    buffer_load_dwordx4 v62, s[8:11], s78 offen lds
    s_add_u32 m0, s97, 9216
    s_nop 0
    buffer_load_dwordx4 v63, s[8:11], s78 offen lds
    s_add_u32 m0, s97, 10240
    s_nop 0
    buffer_load_dwordx4 v62, s[8:11], s79 offen lds
    s_add_u32 m0, s97, 11264
    s_nop 0
    buffer_load_dwordx4 v63, s[8:11], s79 offen lds
    s_add_u32 m0, s97, 12288
    s_nop 0
    buffer_load_dwordx4 v62, s[8:11], s80 offen lds
    s_mov_b64 exec, 1
    ds_add_u32 v13, v12 offset:76
    s_mov_b64 exec, -1
    s_add_u32 m0, s97, 13312
    s_nop 0
    buffer_load_dwordx4 v63, s[8:11], s80 offen lds
    s_add_u32 m0, s97, 14336
    s_nop 0
    buffer_load_dwordx4 v62, s[8:11], s81 offen lds
    s_add_u32 m0, s97, 15360
    s_nop 0
    buffer_load_dwordx4 v63, s[8:11], s81 offen lds
    s_add_u32 m0, s97, 16384
    s_nop 0
    buffer_load_dwordx4 v62, s[8:11], s82 offen lds
    s_add_u32 m0, s97, 17408
    s_nop 0
    buffer_load_dwordx4 v63, s[8:11], s82 offen lds
    s_setprio 0
    s_mul_i32 s92, s23, 144
    s_min_u32 s94, s21, 2
    s_lshl_b32 s31, s21, 6
    v_add_u32 v16, s31, v0
    v_mul_u32_u24 v17, 7282, v16
    v_lshrrev_b32 v18, 16, v17
    v_mul_u32_u24 v17, 9, v18
    v_sub_u32 v19, v16, v17
    v_bfe_u32 v16, v18, 1, 2
    v_and_b32 v17, 1, v18
    v_lshl_add_u32 v16, v17, 4, v16
    v_and_b32 v17, 40, v18
    v_add_u32 v16, v16, v17
    v_bfe_u32 v17, v18, 4, 1
    v_lshl_add_u32 v16, v17, 2, v16
    v_mul_u32_u24 v16, 1152, v16
    v_lshl_add_u32 v36, v19, 4, v16
    v_add_u32 v16, s31, v0
    v_add_u32 v16, 256, v16
    v_mul_u32_u24 v17, 7282, v16
    v_lshrrev_b32 v18, 16, v17
    v_mul_u32_u24 v17, 9, v18
    v_sub_u32 v19, v16, v17
    v_bfe_u32 v16, v18, 1, 2
    v_and_b32 v17, 1, v18
    v_lshl_add_u32 v16, v17, 4, v16
    v_and_b32 v17, 40, v18
    v_add_u32 v16, v16, v17
    v_bfe_u32 v17, v18, 4, 1
    v_lshl_add_u32 v16, v17, 2, v16
    v_mul_u32_u24 v16, 1152, v16
    v_lshl_add_u32 v37, v19, 4, v16
    v_add_u32 v16, 512, v0
    v_mul_u32_u24 v17, 7282, v16
    v_lshrrev_b32 v18, 16, v17
    v_mul_u32_u24 v17, 9, v18
    v_sub_u32 v19, v16, v17
    v_bfe_u32 v16, v18, 1, 2
    v_and_b32 v17, 1, v18
    v_lshl_add_u32 v16, v17, 4, v16
    v_and_b32 v17, 40, v18
    v_add_u32 v16, v16, v17
    v_bfe_u32 v17, v18, 4, 1
    v_lshl_add_u32 v16, v17, 2, v16
    v_mul_u32_u24 v16, 1152, v16
    v_lshl_add_u32 v38, v19, 4, v16
    s_lshl_b32 s93, s21, 10
    s_add_u32 s93, s93, 73728
    s_mul_i32 s95, s94, 9216
    s_add_u32 s95, s95, 81920
    s_add_u32 s31, s94, s83
    s_sub_u32 s32, s31, 9
    s_min_u32 s31, s31, s32
    s_mul_i32 s31, s31, 73728
    s_add_u32 s94, s31, s92
    s_mul_i32 s24, s83, 73728
    s_add_u32 s24, s24, s92
    s_add_u32 s25, s92, 663552
    s_mov_b32 s16, s46
    s_and_b32 s17, s47, 0xffff
    s_mov_b32 s18, 663552
    s_mov_b32 s19, 0x20000
    v_lshrrev_b32 v16, 1, v1
    v_xor_b32 v16, v16, v2
    v_lshlrev_b32 v16, 4, v16
    v_lshl_add_u32 v16, v1, 7, v16
    v_add_u32 v40, s97, v16
    v_xor_b32 v41, 64, v40
    v_add_u32 v42, s97, v3
    v_mov_b32 v152, 0x3f803f80
    v_mov_b32 v153, 0x3f803f80
    v_mov_b32 v154, 0x3f803f80
    v_mov_b32 v155, 0x3f803f80
    v_bfe_u32 v16, v0, 2, 3
    v_lshrrev_b32 v17, 5, v0
    v_lshl_add_u32 v16, v16, 1, v17
    v_mul_u32_u24 v16, 144, v16
    v_add_u32 v16, 73728, v16
    v_and_b32 v17, 3, v0
    v_lshl_add_u32 v44, v17, 3, v16
    v_and_b32 v17, 1, v0
    v_lshl_add_u32 v46, v17, 3, v16
    v_add_u32 v45, 41472, v44
    v_add_u32 v47, 41472, v46
    v_lshlrev_b32 v16, 2, v2
    v_sub_u32 v16, v1, v16
    v_cmp_eq_u32 s[60:61], 0, v16
    v_cmp_eq_u32 s[62:63], 1, v16
    v_cmp_eq_u32 s[64:65], 2, v16
    v_cmp_eq_u32 s[66:67], 3, v16
    v_cmp_gt_u32 vcc, 4, v16
    v_lshlrev_b32 v17, 3, v1
    v_mov_b32 v18, 0x40000000
    v_cndmask_b32 v60, v18, v17, vcc
    v_lshl_add_u32 v61, v2, 8, v17
    s_lshr_b32 s33, s23, 2
    s_add_u32 s33, s33, 1
    s_sub_u32 s34, 0, s33
    s_bitcmp1_b32 s23, 1
    s_cselect_b32 s33, s34, s33
    s_cselect_b32 s34, -1, 1
    s_mov_b32 s70, 2048
    s_lshl_b32 s35, s27, 4
    s_add_u32 s35, s35, s33
    v_add_u32 v16, s35, v1
    v_cmp_gt_u32 s[68:69], s70, v16
    v_and_b32 v16, 0x7ff, v16
    v_lshrrev_b32 v17, 4, v16
    v_and_b32 v16, 15, v16
    v_mul_u32_u24 v17, 18432, v17
    v_lshl_add_u32 v16, v2, 4, v16
    s_lshl_b32 s35, s23, 11
    v_lshl_add_u32 v18, v16, 4, v17
    v_add_u32 v48, s35, v18
    s_lshl_b32 s35, s23, 8
    s_add_u32 s35, s35, 16384
    v_lshl_add_u32 v18, v16, 3, v17
    v_add_u32 v18, s35, v18
    v_cmp_gt_u32 vcc, 2, v2
    v_mov_b32 v19, 0x40000000
    s_nop 0
    v_cndmask_b32 v49, v19, v18, vcc
    s_add_u32 s34, s34, s27
    s_and_b32 s34, s34, 127
    s_mul_i32 s72, s34, 256
    s_add_u32 s72, s72, 0
    s_mul_i32 s73, s27, 256
    s_add_u32 s73, s73, 0
    s_add_u32 s44, s58, 48234496
    s_addc_u32 s45, s59, 0
    v_lshlrev_b32 v59, 3, v0
    s_waitcnt vmcnt(16)
    ds_read_b128 v[176:179], v40 offset:0
    ds_read_b128 v[180:183], v41 offset:0
    s_lshl_b32 s35, s27, 4
    v_add_u32 v16, s35, v1
    s_waitcnt vmcnt(14)
    ds_read_b128 v[184:187], v40 offset:2048
    ds_read_b128 v[188:191], v41 offset:2048
    v_lshrrev_b32 v17, 4, v16
    v_and_b32 v16, 15, v16
    v_mul_u32_u24 v17, 18432, v17
    v_lshl_add_u32 v16, v2, 4, v16
    s_lshl_b32 s35, s23, 11
    v_lshl_add_u32 v18, v16, 4, v17
    v_add_u32 v34, s35, v18
    s_waitcnt vmcnt(12)
    ds_read_b128 v[192:195], v40 offset:4096
    ds_read_b128 v[196:199], v41 offset:4096
    s_waitcnt lgkmcnt(5)
    v_mfma_f32_16x16x32_bf16 v[144:147], v[152:155], v[176:179], 0
    v_mfma_f32_16x16x32_bf16 v[148:151], v[176:179], v[176:179], 0
    s_waitcnt lgkmcnt(4)
    v_mfma_f32_16x16x32_bf16 v[144:147], v[152:155], v[180:183], v[144:147]
    v_mfma_f32_16x16x32_bf16 v[148:151], v[180:183], v[180:183], v[148:151]
    s_lshl_b32 s35, s23, 8
    s_add_u32 s35, s35, 16384
    v_lshl_add_u32 v18, v16, 3, v17
    v_add_u32 v18, s35, v18
    v_cmp_gt_u32 vcc, 2, v2
    v_mov_b32 v19, 0x40000000
    s_nop 0
    v_cndmask_b32 v35, v19, v18, vcc
    s_waitcnt vmcnt(10)
    ds_read_b128 v[200:203], v40 offset:6144
    ds_read_b128 v[204:207], v41 offset:6144
    s_waitcnt lgkmcnt(5)
    v_mfma_f32_16x16x32_bf16 v[144:147], v[152:155], v[184:187], v[144:147]
    v_mfma_f32_16x16x32_bf16 v[148:151], v[184:187], v[184:187], v[148:151]
    s_waitcnt lgkmcnt(4)
    v_mfma_f32_16x16x32_bf16 v[144:147], v[152:155], v[188:191], v[144:147]
    v_mfma_f32_16x16x32_bf16 v[148:151], v[188:191], v[188:191], v[148:151]
    v_add_u32 v4, 65536, v3
    v_add_u32 v5, 131072, v3
    v_lshlrev_b32 v6, 3, v0
    v_add_u32 v6, 155648, v6
    s_waitcnt vmcnt(8)
    ds_read_b128 v[208:211], v40 offset:8192
    ds_read_b128 v[212:215], v41 offset:8192
    s_waitcnt lgkmcnt(5)
    v_mfma_f32_16x16x32_bf16 v[144:147], v[152:155], v[192:195], v[144:147]
    v_mfma_f32_16x16x32_bf16 v[148:151], v[192:195], v[192:195], v[148:151]
    s_waitcnt lgkmcnt(4)
    v_mfma_f32_16x16x32_bf16 v[144:147], v[152:155], v[196:199], v[144:147]
    v_mfma_f32_16x16x32_bf16 v[148:151], v[196:199], v[196:199], v[148:151]
    s_lshl_b32 s31, s21, 12
    s_add_u32 s31, s31, 0
    v_add_u32 v7, s31, v3
    s_lshr_b32 s31, s21, 1
    s_lshl_b32 s31, s31, 12
    s_and_b32 s32, s21, 1
    s_lshl_b32 s32, s32, 3
    s_add_u32 s31, s31, s32
    s_add_u32 s31, s31, 32768
    v_add_u32 v8, s31, v3
    s_waitcnt vmcnt(6)
    ds_read_b128 v[216:219], v40 offset:10240
    ds_read_b128 v[220:223], v41 offset:10240
    s_waitcnt lgkmcnt(5)
    v_mfma_f32_16x16x32_bf16 v[144:147], v[152:155], v[200:203], v[144:147]
    v_mfma_f32_16x16x32_bf16 v[148:151], v[200:203], v[200:203], v[148:151]
    s_waitcnt lgkmcnt(4)
    v_mfma_f32_16x16x32_bf16 v[144:147], v[152:155], v[204:207], v[144:147]
    v_mfma_f32_16x16x32_bf16 v[148:151], v[204:207], v[204:207], v[148:151]
    v_lshrrev_b32 v16, 2, v1
    v_lshlrev_b32 v16, 13, v16
    v_lshl_add_u32 v16, v2, 6, v16
    v_and_b32 v17, 3, v0
    v_lshl_add_u32 v16, v17, 4, v16
    s_lshl_b32 s31, s23, 10
    s_lshl_b32 s32, s21, 8
    s_add_u32 s31, s31, s32
    s_waitcnt vmcnt(4)
    ds_read_b128 v[224:227], v40 offset:12288
    ds_read_b128 v[228:231], v41 offset:12288
    s_waitcnt lgkmcnt(5)
    v_mfma_f32_16x16x32_bf16 v[144:147], v[152:155], v[208:211], v[144:147]
    v_mfma_f32_16x16x32_bf16 v[148:151], v[208:211], v[208:211], v[148:151]
    s_waitcnt lgkmcnt(4)
    v_mfma_f32_16x16x32_bf16 v[144:147], v[152:155], v[212:215], v[144:147]
    v_mfma_f32_16x16x32_bf16 v[148:151], v[212:215], v[212:215], v[148:151]
    s_mul_i32 s32, s22, 589824
    s_add_u32 s31, s31, s32
    s_add_u32 s31, s31, 22020096
    v_add_u32 v9, s31, v16
    v_add_u32 v10, 32768, v9
    s_mul_i32 s33, s23, 9
    s_lshl_b32 s34, s83, 3
    s_sub_u32 s33, s33, s34
    v_lshl_add_u32 v21, v1, 4, s97
    v_lshl_add_u32 v16, v2, 1, s33
    s_waitcnt vmcnt(2)
    ds_read_b128 v[232:235], v40 offset:14336
    ds_read_b128 v[236:239], v41 offset:14336
    s_waitcnt lgkmcnt(5)
    v_mfma_f32_16x16x32_bf16 v[144:147], v[152:155], v[216:219], v[144:147]
    v_mfma_f32_16x16x32_bf16 v[148:151], v[216:219], v[216:219], v[148:151]
    s_waitcnt lgkmcnt(4)
    v_mfma_f32_16x16x32_bf16 v[144:147], v[152:155], v[220:223], v[144:147]
    v_mfma_f32_16x16x32_bf16 v[148:151], v[220:223], v[220:223], v[148:151]
    v_add_u32 v17, 0, v16
    v_add_u32 v18, 72, v17
    v_min_u32 v17, v17, v18
    v_lshl_add_u32 v84, v17, 8, v21
    v_add_u32 v17, 1, v16
    v_add_u32 v18, 72, v17
    v_min_u32 v17, v17, v18
    v_lshl_add_u32 v85, v17, 8, v21
    s_waitcnt vmcnt(0)
    ds_read_b128 v[240:243], v40 offset:16384
    ds_read_b128 v[244:247], v41 offset:16384
    s_waitcnt lgkmcnt(5)
    v_mfma_f32_16x16x32_bf16 v[144:147], v[152:155], v[224:227], v[144:147]
    v_mfma_f32_16x16x32_bf16 v[148:151], v[224:227], v[224:227], v[148:151]
    s_waitcnt lgkmcnt(4)
    v_mfma_f32_16x16x32_bf16 v[144:147], v[152:155], v[228:231], v[144:147]
    v_mfma_f32_16x16x32_bf16 v[148:151], v[228:231], v[228:231], v[148:151]
    s_add_u32 s33, s33, 8
    s_add_u32 s34, s33, 72
    s_min_u32 s33, s33, s34
    s_lshl_b32 s33, s33, 8
    v_and_b32 v16, 1, v2
    v_lshl_add_u32 v16, v16, 3, v21
    v_add_u32 v86, s33, v16
    v_and_b32 v16, 7, v0
    v_lshl_add_u32 v16, v2, 3, v16
    v_lshlrev_b32 v16, 4, v16
    v_add_u32 v50, 77824, v16
    v_add_u32 v51, 41472, v50
    s_waitcnt lgkmcnt(3)
    v_mfma_f32_16x16x32_bf16 v[144:147], v[152:155], v[232:235], v[144:147]
    v_mfma_f32_16x16x32_bf16 v[148:151], v[232:235], v[232:235], v[148:151]
    s_waitcnt lgkmcnt(2)
    v_mfma_f32_16x16x32_bf16 v[144:147], v[152:155], v[236:239], v[144:147]
    v_mfma_f32_16x16x32_bf16 v[148:151], v[236:239], v[236:239], v[148:151]
    s_waitcnt lgkmcnt(1)
    v_mfma_f32_16x16x32_bf16 v[144:147], v[152:155], v[240:243], v[144:147]
    v_mfma_f32_16x16x32_bf16 v[148:151], v[240:243], v[240:243], v[148:151]
    s_waitcnt lgkmcnt(0)
    v_mfma_f32_16x16x32_bf16 v[144:147], v[152:155], v[244:247], v[144:147]
    v_mfma_f32_16x16x32_bf16 v[148:151], v[244:247], v[244:247], v[148:151]
    s_nop 7
    v_cndmask_b32 v16, 0, v148, s[60:61]
    v_cndmask_b32 v16, v16, v149, s[62:63]
    v_cndmask_b32 v16, v16, v150, s[64:65]
    v_cndmask_b32 v16, v16, v151, s[66:67]
    v_mov_b32 v17, v16
    s_nop 1
    v_permlane16_swap_b32 v16, v17
    v_add_f32 v16, v16, v17
    v_mov_b32 v17, v16
    s_nop 1
    v_permlane32_swap_b32 v16, v17
    v_add_f32 v16, v16, v17
    v_mul_f32 v144, 0x3ae38e39, v144
    v_mul_f32 v16, 0x3ae38e39, v16
    v_fma_f32 v56, -v144, v144, v16
    v_max_f32 v56, 0, v56
    v_add_f32 v52, 0x3727c5ac, v56
    v_rsq_f32 v52, v52
    s_nop 0
    v_mul_f32 v54, v144, v52
    v_mov_b32 v53, v52
    v_sub_f32 v54, 0, v54
    v_mov_b32 v55, v54
    v_lshlrev_b32 v16, 16, v176
    v_and_b32 v17, s28, v176
    v_lshlrev_b32 v18, 16, v177
    v_and_b32 v19, s28, v177
    v_lshlrev_b32 v20, 16, v178
    v_and_b32 v21, s28, v178
    v_lshlrev_b32 v22, 16, v179
    v_and_b32 v23, s28, v179
    v_pk_fma_f32 v[16:17], v[16:17], v[52:53], v[54:55]
    v_pk_fma_f32 v[18:19], v[18:19], v[52:53], v[54:55]
    v_pk_fma_f32 v[20:21], v[20:21], v[52:53], v[54:55]
    v_pk_fma_f32 v[22:23], v[22:23], v[52:53], v[54:55]
    v_cvt_pk_bf16_f32 v176, v16, v17
    v_cvt_pk_bf16_f32 v177, v18, v19
    v_cvt_pk_bf16_f32 v178, v20, v21
    v_cvt_pk_bf16_f32 v179, v22, v23
    ds_write_b128 v42, v[176:179] offset:0
    v_lshlrev_b32 v16, 16, v180
    v_and_b32 v17, s28, v180
    v_lshlrev_b32 v18, 16, v181
    v_and_b32 v19, s28, v181
    v_lshlrev_b32 v20, 16, v182
    v_and_b32 v21, s28, v182
    v_lshlrev_b32 v22, 16, v183
    v_and_b32 v23, s28, v183
    v_pk_fma_f32 v[16:17], v[16:17], v[52:53], v[54:55]
    v_pk_fma_f32 v[18:19], v[18:19], v[52:53], v[54:55]
    v_pk_fma_f32 v[20:21], v[20:21], v[52:53], v[54:55]
    v_pk_fma_f32 v[22:23], v[22:23], v[52:53], v[54:55]
    v_cvt_pk_bf16_f32 v180, v16, v17
    v_cvt_pk_bf16_f32 v181, v18, v19
    v_cvt_pk_bf16_f32 v182, v20, v21
    v_cvt_pk_bf16_f32 v183, v22, v23
    ds_write_b128 v42, v[180:183] offset:1024
    v_lshlrev_b32 v16, 16, v184
    v_and_b32 v17, s28, v184
    v_lshlrev_b32 v18, 16, v185
    v_and_b32 v19, s28, v185
    v_lshlrev_b32 v20, 16, v186
    v_and_b32 v21, s28, v186
    v_lshlrev_b32 v22, 16, v187
    v_and_b32 v23, s28, v187
    v_pk_fma_f32 v[16:17], v[16:17], v[52:53], v[54:55]
    v_pk_fma_f32 v[18:19], v[18:19], v[52:53], v[54:55]
    v_pk_fma_f32 v[20:21], v[20:21], v[52:53], v[54:55]
    v_pk_fma_f32 v[22:23], v[22:23], v[52:53], v[54:55]
    v_cvt_pk_bf16_f32 v184, v16, v17
    v_cvt_pk_bf16_f32 v185, v18, v19
    v_cvt_pk_bf16_f32 v186, v20, v21
    v_cvt_pk_bf16_f32 v187, v22, v23
    ds_write_b128 v42, v[184:187] offset:2048
    v_lshlrev_b32 v16, 16, v188
    v_and_b32 v17, s28, v188
    v_lshlrev_b32 v18, 16, v189
    v_and_b32 v19, s28, v189
    v_lshlrev_b32 v20, 16, v190
    v_and_b32 v21, s28, v190
    v_lshlrev_b32 v22, 16, v191
    v_and_b32 v23, s28, v191
    v_pk_fma_f32 v[16:17], v[16:17], v[52:53], v[54:55]
    v_pk_fma_f32 v[18:19], v[18:19], v[52:53], v[54:55]
    v_pk_fma_f32 v[20:21], v[20:21], v[52:53], v[54:55]
    v_pk_fma_f32 v[22:23], v[22:23], v[52:53], v[54:55]
    v_cvt_pk_bf16_f32 v188, v16, v17
    v_cvt_pk_bf16_f32 v189, v18, v19
    v_cvt_pk_bf16_f32 v190, v20, v21
    v_cvt_pk_bf16_f32 v191, v22, v23
    ds_write_b128 v42, v[188:191] offset:3072
    v_lshlrev_b32 v16, 16, v192
    v_and_b32 v17, s28, v192
    v_lshlrev_b32 v18, 16, v193
    v_and_b32 v19, s28, v193
    v_lshlrev_b32 v20, 16, v194
    v_and_b32 v21, s28, v194
    v_lshlrev_b32 v22, 16, v195
    v_and_b32 v23, s28, v195
    v_pk_fma_f32 v[16:17], v[16:17], v[52:53], v[54:55]
    v_pk_fma_f32 v[18:19], v[18:19], v[52:53], v[54:55]
    v_pk_fma_f32 v[20:21], v[20:21], v[52:53], v[54:55]
    v_pk_fma_f32 v[22:23], v[22:23], v[52:53], v[54:55]
    v_cvt_pk_bf16_f32 v192, v16, v17
    v_cvt_pk_bf16_f32 v193, v18, v19
    v_cvt_pk_bf16_f32 v194, v20, v21
    v_cvt_pk_bf16_f32 v195, v22, v23
    ds_write_b128 v42, v[192:195] offset:4096
    v_lshlrev_b32 v16, 16, v196
    v_and_b32 v17, s28, v196
    v_lshlrev_b32 v18, 16, v197
    v_and_b32 v19, s28, v197
    v_lshlrev_b32 v20, 16, v198
    v_and_b32 v21, s28, v198
    v_lshlrev_b32 v22, 16, v199
    v_and_b32 v23, s28, v199
    v_pk_fma_f32 v[16:17], v[16:17], v[52:53], v[54:55]
    v_pk_fma_f32 v[18:19], v[18:19], v[52:53], v[54:55]
    v_pk_fma_f32 v[20:21], v[20:21], v[52:53], v[54:55]
    v_pk_fma_f32 v[22:23], v[22:23], v[52:53], v[54:55]
    v_cvt_pk_bf16_f32 v196, v16, v17
    v_cvt_pk_bf16_f32 v197, v18, v19
    v_cvt_pk_bf16_f32 v198, v20, v21
    v_cvt_pk_bf16_f32 v199, v22, v23
    ds_write_b128 v42, v[196:199] offset:5120
    v_lshlrev_b32 v16, 16, v200
    v_and_b32 v17, s28, v200
    v_lshlrev_b32 v18, 16, v201
    v_and_b32 v19, s28, v201
    v_lshlrev_b32 v20, 16, v202
    v_and_b32 v21, s28, v202
    v_lshlrev_b32 v22, 16, v203
    v_and_b32 v23, s28, v203
    v_pk_fma_f32 v[16:17], v[16:17], v[52:53], v[54:55]
    v_pk_fma_f32 v[18:19], v[18:19], v[52:53], v[54:55]
    v_pk_fma_f32 v[20:21], v[20:21], v[52:53], v[54:55]
    v_pk_fma_f32 v[22:23], v[22:23], v[52:53], v[54:55]
    v_cvt_pk_bf16_f32 v200, v16, v17
    v_cvt_pk_bf16_f32 v201, v18, v19
    v_cvt_pk_bf16_f32 v202, v20, v21
    v_cvt_pk_bf16_f32 v203, v22, v23
    ds_write_b128 v42, v[200:203] offset:6144
    v_lshlrev_b32 v16, 16, v204
    v_and_b32 v17, s28, v204
    v_lshlrev_b32 v18, 16, v205
    v_and_b32 v19, s28, v205
    v_lshlrev_b32 v20, 16, v206
    v_and_b32 v21, s28, v206
    v_lshlrev_b32 v22, 16, v207
    v_and_b32 v23, s28, v207
    v_pk_fma_f32 v[16:17], v[16:17], v[52:53], v[54:55]
    v_pk_fma_f32 v[18:19], v[18:19], v[52:53], v[54:55]
    v_pk_fma_f32 v[20:21], v[20:21], v[52:53], v[54:55]
    v_pk_fma_f32 v[22:23], v[22:23], v[52:53], v[54:55]
    v_cvt_pk_bf16_f32 v204, v16, v17
    v_cvt_pk_bf16_f32 v205, v18, v19
    v_cvt_pk_bf16_f32 v206, v20, v21
    v_cvt_pk_bf16_f32 v207, v22, v23
    ds_write_b128 v42, v[204:207] offset:7168
    v_lshlrev_b32 v16, 16, v208
    v_and_b32 v17, s28, v208
    v_lshlrev_b32 v18, 16, v209
    v_and_b32 v19, s28, v209
    v_lshlrev_b32 v20, 16, v210
    v_and_b32 v21, s28, v210
    v_lshlrev_b32 v22, 16, v211
    v_and_b32 v23, s28, v211
    v_pk_fma_f32 v[16:17], v[16:17], v[52:53], v[54:55]
    v_pk_fma_f32 v[18:19], v[18:19], v[52:53], v[54:55]
    v_pk_fma_f32 v[20:21], v[20:21], v[52:53], v[54:55]
    v_pk_fma_f32 v[22:23], v[22:23], v[52:53], v[54:55]
    v_cvt_pk_bf16_f32 v208, v16, v17
    v_cvt_pk_bf16_f32 v209, v18, v19
    v_cvt_pk_bf16_f32 v210, v20, v21
    v_cvt_pk_bf16_f32 v211, v22, v23
    ds_write_b128 v42, v[208:211] offset:8192
    s_add_u32 m0, s93, 0
    s_nop 0
    buffer_load_dwordx4 v36, s[16:19], s24 offen lds
    v_lshlrev_b32 v16, 16, v212
    v_and_b32 v17, s28, v212
    v_lshlrev_b32 v18, 16, v213
    v_and_b32 v19, s28, v213
    v_lshlrev_b32 v20, 16, v214
    v_and_b32 v21, s28, v214
    v_lshlrev_b32 v22, 16, v215
    v_and_b32 v23, s28, v215
    v_pk_fma_f32 v[16:17], v[16:17], v[52:53], v[54:55]
    v_pk_fma_f32 v[18:19], v[18:19], v[52:53], v[54:55]
    v_pk_fma_f32 v[20:21], v[20:21], v[52:53], v[54:55]
    v_pk_fma_f32 v[22:23], v[22:23], v[52:53], v[54:55]
    v_cvt_pk_bf16_f32 v212, v16, v17
    v_cvt_pk_bf16_f32 v213, v18, v19
    v_cvt_pk_bf16_f32 v214, v20, v21
    v_cvt_pk_bf16_f32 v215, v22, v23
    ds_write_b128 v42, v[212:215] offset:9216
    s_add_u32 m0, s93, 4096
    s_nop 0
    buffer_load_dwordx4 v37, s[16:19], s24 offen lds
    v_lshlrev_b32 v16, 16, v216
    v_and_b32 v17, s28, v216
    v_lshlrev_b32 v18, 16, v217
    v_and_b32 v19, s28, v217
    v_lshlrev_b32 v20, 16, v218
    v_and_b32 v21, s28, v218
    v_lshlrev_b32 v22, 16, v219
    v_and_b32 v23, s28, v219
    v_pk_fma_f32 v[16:17], v[16:17], v[52:53], v[54:55]
    v_pk_fma_f32 v[18:19], v[18:19], v[52:53], v[54:55]
    v_pk_fma_f32 v[20:21], v[20:21], v[52:53], v[54:55]
    v_pk_fma_f32 v[22:23], v[22:23], v[52:53], v[54:55]
    v_cvt_pk_bf16_f32 v216, v16, v17
    v_cvt_pk_bf16_f32 v217, v18, v19
    v_cvt_pk_bf16_f32 v218, v20, v21
    v_cvt_pk_bf16_f32 v219, v22, v23
    ds_write_b128 v42, v[216:219] offset:10240
    s_add_u32 m0, s93, 9216
    s_add_u32 s24, s24, 73728
    s_cmp_eq_u32 s24, s25
    s_cselect_b32 s24, s92, s24
    buffer_load_dwordx4 v36, s[16:19], s24 offen lds
    v_lshlrev_b32 v16, 16, v220
    v_and_b32 v17, s28, v220
    v_lshlrev_b32 v18, 16, v221
    v_and_b32 v19, s28, v221
    v_lshlrev_b32 v20, 16, v222
    v_and_b32 v21, s28, v222
    v_lshlrev_b32 v22, 16, v223
    v_and_b32 v23, s28, v223
    v_pk_fma_f32 v[16:17], v[16:17], v[52:53], v[54:55]
    v_pk_fma_f32 v[18:19], v[18:19], v[52:53], v[54:55]
    v_pk_fma_f32 v[20:21], v[20:21], v[52:53], v[54:55]
    v_pk_fma_f32 v[22:23], v[22:23], v[52:53], v[54:55]
    v_cvt_pk_bf16_f32 v220, v16, v17
    v_cvt_pk_bf16_f32 v221, v18, v19
    v_cvt_pk_bf16_f32 v222, v20, v21
    v_cvt_pk_bf16_f32 v223, v22, v23
    ds_write_b128 v42, v[220:223] offset:11264
    s_add_u32 m0, s93, 13312
    s_nop 0
    buffer_load_dwordx4 v37, s[16:19], s24 offen lds
    v_lshlrev_b32 v16, 16, v224
    v_and_b32 v17, s28, v224
    v_lshlrev_b32 v18, 16, v225
    v_and_b32 v19, s28, v225
    v_lshlrev_b32 v20, 16, v226
    v_and_b32 v21, s28, v226
    v_lshlrev_b32 v22, 16, v227
    v_and_b32 v23, s28, v227
    v_pk_fma_f32 v[16:17], v[16:17], v[52:53], v[54:55]
    v_pk_fma_f32 v[18:19], v[18:19], v[52:53], v[54:55]
    v_pk_fma_f32 v[20:21], v[20:21], v[52:53], v[54:55]
    v_pk_fma_f32 v[22:23], v[22:23], v[52:53], v[54:55]
    v_cvt_pk_bf16_f32 v224, v16, v17
    v_cvt_pk_bf16_f32 v225, v18, v19
    v_cvt_pk_bf16_f32 v226, v20, v21
    v_cvt_pk_bf16_f32 v227, v22, v23
    ds_write_b128 v42, v[224:227] offset:12288
    s_add_u32 m0, s93, 18432
    s_add_u32 s24, s24, 73728
    s_cmp_eq_u32 s24, s25
    s_cselect_b32 s24, s92, s24
    buffer_load_dwordx4 v36, s[16:19], s24 offen lds
    v_lshlrev_b32 v16, 16, v228
    v_and_b32 v17, s28, v228
    v_lshlrev_b32 v18, 16, v229
    v_and_b32 v19, s28, v229
    v_lshlrev_b32 v20, 16, v230
    v_and_b32 v21, s28, v230
    v_lshlrev_b32 v22, 16, v231
    v_and_b32 v23, s28, v231
    v_pk_fma_f32 v[16:17], v[16:17], v[52:53], v[54:55]
    v_pk_fma_f32 v[18:19], v[18:19], v[52:53], v[54:55]
    v_pk_fma_f32 v[20:21], v[20:21], v[52:53], v[54:55]
    v_pk_fma_f32 v[22:23], v[22:23], v[52:53], v[54:55]
    v_cvt_pk_bf16_f32 v228, v16, v17
    v_cvt_pk_bf16_f32 v229, v18, v19
    v_cvt_pk_bf16_f32 v230, v20, v21
    v_cvt_pk_bf16_f32 v231, v22, v23
    ds_write_b128 v42, v[228:231] offset:13312
    s_add_u32 m0, s93, 22528
    s_nop 0
    buffer_load_dwordx4 v37, s[16:19], s24 offen lds
    v_lshlrev_b32 v16, 16, v232
    v_and_b32 v17, s28, v232
    v_lshlrev_b32 v18, 16, v233
    v_and_b32 v19, s28, v233
    v_lshlrev_b32 v20, 16, v234
    v_and_b32 v21, s28, v234
    v_lshlrev_b32 v22, 16, v235
    v_and_b32 v23, s28, v235
    v_pk_fma_f32 v[16:17], v[16:17], v[52:53], v[54:55]
    v_pk_fma_f32 v[18:19], v[18:19], v[52:53], v[54:55]
    v_pk_fma_f32 v[20:21], v[20:21], v[52:53], v[54:55]
    v_pk_fma_f32 v[22:23], v[22:23], v[52:53], v[54:55]
    v_cvt_pk_bf16_f32 v232, v16, v17
    v_cvt_pk_bf16_f32 v233, v18, v19
    v_cvt_pk_bf16_f32 v234, v20, v21
    v_cvt_pk_bf16_f32 v235, v22, v23
    ds_write_b128 v42, v[232:235] offset:14336
    s_add_u32 m0, s95, 0
    s_nop 0
    buffer_load_dwordx4 v38, s[16:19], s94 offen lds
    v_lshlrev_b32 v16, 16, v236
    v_and_b32 v17, s28, v236
    v_lshlrev_b32 v18, 16, v237
    v_and_b32 v19, s28, v237
    v_lshlrev_b32 v20, 16, v238
    v_and_b32 v21, s28, v238
    v_lshlrev_b32 v22, 16, v239
    v_and_b32 v23, s28, v239
    v_pk_fma_f32 v[16:17], v[16:17], v[52:53], v[54:55]
    v_pk_fma_f32 v[18:19], v[18:19], v[52:53], v[54:55]
    v_pk_fma_f32 v[20:21], v[20:21], v[52:53], v[54:55]
    v_pk_fma_f32 v[22:23], v[22:23], v[52:53], v[54:55]
    v_cvt_pk_bf16_f32 v236, v16, v17
    v_cvt_pk_bf16_f32 v237, v18, v19
    v_cvt_pk_bf16_f32 v238, v20, v21
    v_cvt_pk_bf16_f32 v239, v22, v23
    ds_write_b128 v42, v[236:239] offset:15360
    s_add_u32 m0, s93, 27648
    s_add_u32 s24, s24, 73728
    s_cmp_eq_u32 s24, s25
    s_cselect_b32 s24, s92, s24
    buffer_load_dwordx4 v36, s[16:19], s24 offen lds
    v_lshlrev_b32 v16, 16, v240
    v_and_b32 v17, s28, v240
    v_lshlrev_b32 v18, 16, v241
    v_and_b32 v19, s28, v241
    v_lshlrev_b32 v20, 16, v242
    v_and_b32 v21, s28, v242
    v_lshlrev_b32 v22, 16, v243
    v_and_b32 v23, s28, v243
    v_pk_fma_f32 v[16:17], v[16:17], v[52:53], v[54:55]
    v_pk_fma_f32 v[18:19], v[18:19], v[52:53], v[54:55]
    v_pk_fma_f32 v[20:21], v[20:21], v[52:53], v[54:55]
    v_pk_fma_f32 v[22:23], v[22:23], v[52:53], v[54:55]
    v_cvt_pk_bf16_f32 v240, v16, v17
    v_cvt_pk_bf16_f32 v241, v18, v19
    v_cvt_pk_bf16_f32 v242, v20, v21
    v_cvt_pk_bf16_f32 v243, v22, v23
    ds_write_b128 v42, v[240:243] offset:16384
    s_add_u32 m0, s93, 31744
    s_nop 0
    buffer_load_dwordx4 v37, s[16:19], s24 offen lds
    v_lshlrev_b32 v16, 16, v244
    v_and_b32 v17, s28, v244
    v_lshlrev_b32 v18, 16, v245
    v_and_b32 v19, s28, v245
    v_lshlrev_b32 v20, 16, v246
    v_and_b32 v21, s28, v246
    v_lshlrev_b32 v22, 16, v247
    v_and_b32 v23, s28, v247
    v_pk_fma_f32 v[16:17], v[16:17], v[52:53], v[54:55]
    v_pk_fma_f32 v[18:19], v[18:19], v[52:53], v[54:55]
    v_pk_fma_f32 v[20:21], v[20:21], v[52:53], v[54:55]
    v_pk_fma_f32 v[22:23], v[22:23], v[52:53], v[54:55]
    v_cvt_pk_bf16_f32 v244, v16, v17
    v_cvt_pk_bf16_f32 v245, v18, v19
    v_cvt_pk_bf16_f32 v246, v20, v21
    v_cvt_pk_bf16_f32 v247, v22, v23
    ds_write_b128 v42, v[244:247] offset:17408
    s_add_u32 m0, s93, 36864
    s_add_u32 s24, s24, 73728
    s_cmp_eq_u32 s24, s25
    s_cselect_b32 s24, s92, s24
    buffer_load_dwordx4 v36, s[16:19], s24 offen lds
    s_add_u32 m0, s93, 40960
    s_nop 0
    buffer_load_dwordx4 v37, s[16:19], s24 offen lds
    s_add_u32 m0, s93, 46080
    s_add_u32 s24, s24, 73728
    s_cmp_eq_u32 s24, s25
    s_cselect_b32 s24, s92, s24
    buffer_load_dwordx4 v36, s[16:19], s24 offen lds
    s_add_u32 m0, s93, 50176
    s_nop 0
    buffer_load_dwordx4 v37, s[16:19], s24 offen lds
    s_add_u32 m0, s95, 27648
    s_add_u32 s94, s94, 221184
    s_cmp_ge_u32 s94, s25
    s_cselect_b32 s26, 663552, 0
    s_sub_u32 s94, s94, s26
    buffer_load_dwordx4 v38, s[16:19], s94 offen lds
    s_add_u32 m0, s93, 55296
    s_add_u32 s24, s24, 73728
    s_cmp_eq_u32 s24, s25
    s_cselect_b32 s24, s92, s24
    buffer_load_dwordx4 v36, s[16:19], s24 offen lds
    s_add_u32 m0, s93, 59392
    s_nop 0
    buffer_load_dwordx4 v37, s[16:19], s24 offen lds
    s_add_u32 m0, s93, 64512
    s_add_u32 s24, s24, 73728
    s_cmp_eq_u32 s24, s25
    s_cselect_b32 s24, s92, s24
    buffer_load_dwordx4 v36, s[16:19], s24 offen lds
    s_add_u32 m0, s93, 68608
    s_nop 0
    buffer_load_dwordx4 v37, s[16:19], s24 offen lds
    s_add_u32 m0, s93, 73728
    s_add_u32 s24, s24, 73728
    s_cmp_eq_u32 s24, s25
    s_cselect_b32 s24, s92, s24
    buffer_load_dwordx4 v36, s[16:19], s24 offen lds
    s_add_u32 m0, s93, 77824
    s_nop 0
    buffer_load_dwordx4 v37, s[16:19], s24 offen lds
    s_add_u32 m0, s95, 55296
    s_add_u32 s94, s94, 221184
    s_cmp_ge_u32 s94, s25
    s_cselect_b32 s26, 663552, 0
    s_sub_u32 s94, s94, s26
    buffer_load_dwordx4 v38, s[16:19], s94 offen lds
    s_waitcnt vmcnt(14)
    s_mov_b64 exec, 1
    ds_add_u32 v13, v12 offset:64
    s_mov_b64 exec, -1
    s_mov_b64 exec, 1
    ds_add_u32 v13, v12 offset:28
    s_mov_b64 exec, -1
    ds_read_b128 v[156:159], v84
    ds_read_b128 v[160:163], v85
    ds_read_b64 v[164:165], v86
    ds_read_b32 v63, v13 offset:64
    s_setprio 0
    s_waitcnt lgkmcnt(0)
    v_readfirstlane_b32 s3, v63
    s_nop 0
    s_cmp_ge_u32 s3, 4
    s_cbranch_scc1 L_stok_1
    s_mov_b32 s26, 0
L_lw_2:
    ds_read_b32 v14, v13 offset:64
    s_waitcnt lgkmcnt(0)
    v_readfirstlane_b32 s3, v14
    s_nop 0
    s_cmp_ge_u32 s3, 4
    s_cbranch_scc1 L_lwdone_3
    s_add_u32 s26, s26, 1
    s_cmp_lt_u32 s26, 1000000
    s_cbranch_scc1 L_lw_2
L_lwdone_3:
L_stok_1:
    ds_read_b64_tr_b16 v[96:97], v44 offset:0
    ds_read_b64_tr_b16 v[98:99], v44 offset:2304
    ds_read_b64_tr_b16 v[100:101], v44 offset:32
    ds_read_b64_tr_b16 v[102:103], v44 offset:2336
    ds_read_b64_tr_b16 v[104:105], v44 offset:64
    ds_read_b64_tr_b16 v[106:107], v44 offset:2368
    ds_read_b64_tr_b16 v[108:109], v44 offset:96
    ds_read_b64_tr_b16 v[110:111], v44 offset:2400
    ds_read_b64_tr_b16 v[112:113], v46 offset:128
    ds_read_b64_tr_b16 v[114:115], v46 offset:2432
    ds_read_b64_tr_b16 v[116:117], v44 offset:4608
    ds_read_b64_tr_b16 v[118:119], v44 offset:6912
    ds_read_b64_tr_b16 v[120:121], v44 offset:4640
    ds_read_b64_tr_b16 v[122:123], v44 offset:6944
    v_mul_f32 v16, v56, v52
    v_fmaak_f32 v16, v16, v52, 0x3727c5ac
    v_rsq_f32 v16, v16
    s_nop 0
    v_cndmask_b32 v16, 0, v16, s[68:69]
    v_rcp_f32 v58, v16
    v_mul_f32 v56, 0xc0135761, v16
    v_mul_f32 v57, v16, v16
    v_mul_f32 v57, v57, v16
    v_mul_f32 v57, 0xbdd2d3e8, v57
    s_waitcnt lgkmcnt(12)
    v_mfma_f32_16x16x32_bf16 v[124:127], v[96:99], v[176:179], 0
    ds_read_b64_tr_b16 v[96:97], v44 offset:4672
    ds_read_b64_tr_b16 v[98:99], v44 offset:6976
    s_waitcnt lgkmcnt(12)
    v_mfma_f32_16x16x32_bf16 v[128:131], v[100:103], v[176:179], 0
    ds_read_b64_tr_b16 v[100:101], v44 offset:4704
    ds_read_b64_tr_b16 v[102:103], v44 offset:7008
    s_waitcnt lgkmcnt(12)
    v_mfma_f32_16x16x32_bf16 v[132:135], v[104:107], v[176:179], 0
    ds_read_b64_tr_b16 v[104:105], v46 offset:4736
    ds_read_b64_tr_b16 v[106:107], v46 offset:7040
    s_waitcnt lgkmcnt(12)
    v_mfma_f32_16x16x32_bf16 v[136:139], v[108:111], v[176:179], 0
    ds_read_b64_tr_b16 v[108:109], v44 offset:9216
    ds_read_b64_tr_b16 v[110:111], v44 offset:11520
    s_waitcnt lgkmcnt(12)
    v_mfma_f32_16x16x32_bf16 v[140:143], v[112:115], v[176:179], 0
    ds_read_b64_tr_b16 v[112:113], v44 offset:9248
    ds_read_b64_tr_b16 v[114:115], v44 offset:11552
    s_waitcnt lgkmcnt(12)
    v_mfma_f32_16x16x32_bf16 v[124:127], v[116:119], v[180:183], v[124:127]
    ds_read_b64_tr_b16 v[116:117], v44 offset:9280
    ds_read_b64_tr_b16 v[118:119], v44 offset:11584
    s_waitcnt lgkmcnt(12)
    v_mfma_f32_16x16x32_bf16 v[128:131], v[120:123], v[180:183], v[128:131]
    ds_read_b64_tr_b16 v[120:121], v44 offset:9312
    ds_read_b64_tr_b16 v[122:123], v44 offset:11616
    s_waitcnt lgkmcnt(12)
    v_mfma_f32_16x16x32_bf16 v[132:135], v[96:99], v[180:183], v[132:135]
    ds_read_b64_tr_b16 v[96:97], v46 offset:9344
    ds_read_b64_tr_b16 v[98:99], v46 offset:11648
    s_waitcnt lgkmcnt(12)
    v_mfma_f32_16x16x32_bf16 v[136:139], v[100:103], v[180:183], v[136:139]
    ds_read_b64_tr_b16 v[100:101], v44 offset:13824
    ds_read_b64_tr_b16 v[102:103], v44 offset:16128
    s_waitcnt lgkmcnt(12)
    v_mfma_f32_16x16x32_bf16 v[140:143], v[104:107], v[180:183], v[140:143]
    ds_read_b64_tr_b16 v[104:105], v44 offset:13856
    ds_read_b64_tr_b16 v[106:107], v44 offset:16160
    s_waitcnt lgkmcnt(12)
    v_mfma_f32_16x16x32_bf16 v[124:127], v[108:111], v[184:187], v[124:127]
    ds_read_b64_tr_b16 v[108:109], v44 offset:13888
    ds_read_b64_tr_b16 v[110:111], v44 offset:16192
    s_waitcnt lgkmcnt(12)
    v_mfma_f32_16x16x32_bf16 v[128:131], v[112:115], v[184:187], v[128:131]
    s_waitcnt vmcnt(7)
    s_mov_b64 exec, 1
    ds_add_u32 v13, v12 offset:68
    s_mov_b64 exec, -1
    ds_read_b64_tr_b16 v[112:113], v44 offset:13920
    ds_read_b64_tr_b16 v[114:115], v44 offset:16224
    s_waitcnt lgkmcnt(13)
    v_mfma_f32_16x16x32_bf16 v[132:135], v[116:119], v[184:187], v[132:135]
    ds_read_b64_tr_b16 v[116:117], v46 offset:13952
    ds_read_b64_tr_b16 v[118:119], v46 offset:16256
    s_waitcnt lgkmcnt(13)
    v_mfma_f32_16x16x32_bf16 v[136:139], v[120:123], v[184:187], v[136:139]
    ds_read_b64_tr_b16 v[120:121], v44 offset:18432
    ds_read_b64_tr_b16 v[122:123], v44 offset:20736
    s_waitcnt lgkmcnt(13)
    v_mfma_f32_16x16x32_bf16 v[140:143], v[96:99], v[184:187], v[140:143]
    ds_read_b64_tr_b16 v[96:97], v44 offset:18464
    ds_read_b64_tr_b16 v[98:99], v44 offset:20768
    s_waitcnt lgkmcnt(13)
    v_mfma_f32_16x16x32_bf16 v[124:127], v[100:103], v[188:191], v[124:127]
    ds_read_b64_tr_b16 v[100:101], v44 offset:18496
    ds_read_b64_tr_b16 v[102:103], v44 offset:20800
    s_waitcnt lgkmcnt(13)
    v_mfma_f32_16x16x32_bf16 v[128:131], v[104:107], v[188:191], v[128:131]
    ds_read_b64_tr_b16 v[104:105], v44 offset:18528
    ds_read_b64_tr_b16 v[106:107], v44 offset:20832
    s_waitcnt lgkmcnt(13)
    v_mfma_f32_16x16x32_bf16 v[132:135], v[108:111], v[188:191], v[132:135]
    ds_read_b32 v63, v13 offset:68
    ds_read_b64_tr_b16 v[108:109], v46 offset:18560
    ds_read_b64_tr_b16 v[110:111], v46 offset:20864
    s_waitcnt lgkmcnt(13)
    v_mfma_f32_16x16x32_bf16 v[136:139], v[112:115], v[188:191], v[136:139]
    ds_read_b64_tr_b16 v[112:113], v44 offset:23040
    ds_read_b64_tr_b16 v[114:115], v44 offset:25344
    s_waitcnt lgkmcnt(13)
    v_mfma_f32_16x16x32_bf16 v[140:143], v[116:119], v[188:191], v[140:143]
    ds_read_b64_tr_b16 v[116:117], v44 offset:23072
    ds_read_b64_tr_b16 v[118:119], v44 offset:25376
    s_waitcnt lgkmcnt(13)
    v_mfma_f32_16x16x32_bf16 v[124:127], v[120:123], v[192:195], v[124:127]
    ds_read_b64_tr_b16 v[120:121], v44 offset:23104
    ds_read_b64_tr_b16 v[122:123], v44 offset:25408
    s_waitcnt lgkmcnt(13)
    v_mfma_f32_16x16x32_bf16 v[128:131], v[96:99], v[192:195], v[128:131]
    ds_read_b64_tr_b16 v[96:97], v44 offset:23136
    ds_read_b64_tr_b16 v[98:99], v44 offset:25440
    s_waitcnt lgkmcnt(13)
    v_mfma_f32_16x16x32_bf16 v[132:135], v[100:103], v[192:195], v[132:135]
    ds_read_b64_tr_b16 v[100:101], v46 offset:23168
    ds_read_b64_tr_b16 v[102:103], v46 offset:25472
    s_waitcnt lgkmcnt(13)
    v_mfma_f32_16x16x32_bf16 v[136:139], v[104:107], v[192:195], v[136:139]
    s_waitcnt lgkmcnt(12)
    v_readfirstlane_b32 s3, v63
    s_nop 0
    s_cmp_ge_u32 s3, 4
    s_cbranch_scc1 L_stok_4
    s_mov_b32 s26, 0
L_lw_5:
    ds_read_b32 v14, v13 offset:68
    s_waitcnt lgkmcnt(0)
    v_readfirstlane_b32 s3, v14
    s_nop 0
    s_cmp_ge_u32 s3, 4
    s_cbranch_scc1 L_lwdone_6
    s_add_u32 s26, s26, 1
    s_cmp_lt_u32 s26, 1000000
    s_cbranch_scc1 L_lw_5
L_lwdone_6:
L_stok_4:
    ds_read_b64_tr_b16 v[104:105], v44 offset:27648
    ds_read_b64_tr_b16 v[106:107], v44 offset:29952
    s_waitcnt lgkmcnt(12)
    v_mfma_f32_16x16x32_bf16 v[140:143], v[108:111], v[192:195], v[140:143]
    ds_read_b64_tr_b16 v[108:109], v44 offset:27680
    ds_read_b64_tr_b16 v[110:111], v44 offset:29984
    s_waitcnt lgkmcnt(12)
    v_mfma_f32_16x16x32_bf16 v[124:127], v[112:115], v[196:199], v[124:127]
    ds_read_b64_tr_b16 v[112:113], v44 offset:27712
    ds_read_b64_tr_b16 v[114:115], v44 offset:30016
    s_waitcnt lgkmcnt(12)
    v_mfma_f32_16x16x32_bf16 v[128:131], v[116:119], v[196:199], v[128:131]
    ds_read_b64_tr_b16 v[116:117], v44 offset:27744
    ds_read_b64_tr_b16 v[118:119], v44 offset:30048
    s_waitcnt lgkmcnt(12)
    v_mfma_f32_16x16x32_bf16 v[132:135], v[120:123], v[196:199], v[132:135]
    ds_read_b64_tr_b16 v[120:121], v46 offset:27776
    ds_read_b64_tr_b16 v[122:123], v46 offset:30080
    s_waitcnt lgkmcnt(12)
    v_mfma_f32_16x16x32_bf16 v[136:139], v[96:99], v[196:199], v[136:139]
    ds_read_b64_tr_b16 v[96:97], v44 offset:32256
    ds_read_b64_tr_b16 v[98:99], v44 offset:34560
    s_waitcnt lgkmcnt(12)
    v_mfma_f32_16x16x32_bf16 v[140:143], v[100:103], v[196:199], v[140:143]
    ds_read_b64_tr_b16 v[100:101], v44 offset:32288
    ds_read_b64_tr_b16 v[102:103], v44 offset:34592
    s_waitcnt lgkmcnt(12)
    v_mfma_f32_16x16x32_bf16 v[124:127], v[104:107], v[200:203], v[124:127]
    ds_read_b64_tr_b16 v[104:105], v44 offset:32320
    ds_read_b64_tr_b16 v[106:107], v44 offset:34624
    s_waitcnt lgkmcnt(12)
    v_mfma_f32_16x16x32_bf16 v[128:131], v[108:111], v[200:203], v[128:131]
    ds_read_b64_tr_b16 v[108:109], v44 offset:32352
    ds_read_b64_tr_b16 v[110:111], v44 offset:34656
    s_waitcnt lgkmcnt(12)
    v_mfma_f32_16x16x32_bf16 v[132:135], v[112:115], v[200:203], v[132:135]
    ds_read_b64_tr_b16 v[112:113], v46 offset:32384
    ds_read_b64_tr_b16 v[114:115], v46 offset:34688
    s_waitcnt lgkmcnt(12)
    v_mfma_f32_16x16x32_bf16 v[136:139], v[116:119], v[200:203], v[136:139]
    ds_read_b64_tr_b16 v[116:117], v44 offset:36864
    ds_read_b64_tr_b16 v[118:119], v44 offset:39168
    s_waitcnt lgkmcnt(12)
    v_mfma_f32_16x16x32_bf16 v[140:143], v[120:123], v[200:203], v[140:143]
    ds_read_b64_tr_b16 v[120:121], v44 offset:36896
    ds_read_b64_tr_b16 v[122:123], v44 offset:39200
    s_waitcnt lgkmcnt(12)
    v_mfma_f32_16x16x32_bf16 v[124:127], v[96:99], v[204:207], v[124:127]
    ds_read_b64_tr_b16 v[96:97], v44 offset:36928
    ds_read_b64_tr_b16 v[98:99], v44 offset:39232
    s_waitcnt lgkmcnt(12)
    v_mfma_f32_16x16x32_bf16 v[128:131], v[100:103], v[204:207], v[128:131]
    ds_read_b64_tr_b16 v[100:101], v44 offset:36960
    ds_read_b64_tr_b16 v[102:103], v44 offset:39264
    s_waitcnt lgkmcnt(12)
    v_mfma_f32_16x16x32_bf16 v[132:135], v[104:107], v[204:207], v[132:135]
    ds_read_b64_tr_b16 v[104:105], v46 offset:36992
    ds_read_b64_tr_b16 v[106:107], v46 offset:39296
    s_waitcnt lgkmcnt(12)
    v_mfma_f32_16x16x32_bf16 v[136:139], v[108:111], v[204:207], v[136:139]
    ds_read_b64_tr_b16 v[108:109], v45 offset:0
    ds_read_b64_tr_b16 v[110:111], v45 offset:2304
    s_waitcnt lgkmcnt(12)
    v_mfma_f32_16x16x32_bf16 v[140:143], v[112:115], v[204:207], v[140:143]
    ds_read_b64_tr_b16 v[112:113], v45 offset:32
    ds_read_b64_tr_b16 v[114:115], v45 offset:2336
    s_waitcnt lgkmcnt(12)
    v_mfma_f32_16x16x32_bf16 v[124:127], v[116:119], v[208:211], v[124:127]
    ds_read_b64_tr_b16 v[116:117], v45 offset:64
    ds_read_b64_tr_b16 v[118:119], v45 offset:2368
    s_waitcnt lgkmcnt(12)
    v_mfma_f32_16x16x32_bf16 v[128:131], v[120:123], v[208:211], v[128:131]
    s_waitcnt vmcnt(0)
    s_mov_b64 exec, 1
    ds_add_u32 v13, v12 offset:72
    s_mov_b64 exec, -1
    ds_read_b64_tr_b16 v[120:121], v45 offset:96
    ds_read_b64_tr_b16 v[122:123], v45 offset:2400
    s_waitcnt lgkmcnt(13)
    v_mfma_f32_16x16x32_bf16 v[132:135], v[96:99], v[208:211], v[132:135]
    ds_read_b64_tr_b16 v[96:97], v47 offset:128
    ds_read_b64_tr_b16 v[98:99], v47 offset:2432
    s_waitcnt lgkmcnt(13)
    v_mfma_f32_16x16x32_bf16 v[136:139], v[100:103], v[208:211], v[136:139]
    ds_read_b64_tr_b16 v[100:101], v45 offset:4608
    ds_read_b64_tr_b16 v[102:103], v45 offset:6912
    s_waitcnt lgkmcnt(13)
    v_mfma_f32_16x16x32_bf16 v[140:143], v[104:107], v[208:211], v[140:143]
    ds_read_b64_tr_b16 v[104:105], v45 offset:4640
    ds_read_b64_tr_b16 v[106:107], v45 offset:6944
    s_waitcnt lgkmcnt(13)
    v_mfma_f32_16x16x32_bf16 v[124:127], v[108:111], v[212:215], v[124:127]
    ds_read_b64_tr_b16 v[108:109], v45 offset:4672
    ds_read_b64_tr_b16 v[110:111], v45 offset:6976
    s_waitcnt lgkmcnt(13)
    v_mfma_f32_16x16x32_bf16 v[128:131], v[112:115], v[212:215], v[128:131]
    ds_read_b64_tr_b16 v[112:113], v45 offset:4704
    ds_read_b64_tr_b16 v[114:115], v45 offset:7008
    s_waitcnt lgkmcnt(13)
    v_mfma_f32_16x16x32_bf16 v[132:135], v[116:119], v[212:215], v[132:135]
    ds_read_b32 v63, v13 offset:72
    ds_read_b64_tr_b16 v[116:117], v47 offset:4736
    ds_read_b64_tr_b16 v[118:119], v47 offset:7040
    s_waitcnt lgkmcnt(13)
    v_mfma_f32_16x16x32_bf16 v[136:139], v[120:123], v[212:215], v[136:139]
    ds_read_b64_tr_b16 v[120:121], v45 offset:9216
    ds_read_b64_tr_b16 v[122:123], v45 offset:11520
    s_waitcnt lgkmcnt(13)
    v_mfma_f32_16x16x32_bf16 v[140:143], v[96:99], v[212:215], v[140:143]
    ds_read_b64_tr_b16 v[96:97], v45 offset:9248
    ds_read_b64_tr_b16 v[98:99], v45 offset:11552
    s_waitcnt lgkmcnt(13)
    v_mfma_f32_16x16x32_bf16 v[124:127], v[100:103], v[216:219], v[124:127]
    ds_read_b64_tr_b16 v[100:101], v45 offset:9280
    ds_read_b64_tr_b16 v[102:103], v45 offset:11584
    s_waitcnt lgkmcnt(13)
    v_mfma_f32_16x16x32_bf16 v[128:131], v[104:107], v[216:219], v[128:131]
    ds_read_b64_tr_b16 v[104:105], v45 offset:9312
    ds_read_b64_tr_b16 v[106:107], v45 offset:11616
    s_waitcnt lgkmcnt(13)
    v_mfma_f32_16x16x32_bf16 v[132:135], v[108:111], v[216:219], v[132:135]
    ds_read_b64_tr_b16 v[108:109], v47 offset:9344
    ds_read_b64_tr_b16 v[110:111], v47 offset:11648
    s_waitcnt lgkmcnt(13)
    v_mfma_f32_16x16x32_bf16 v[136:139], v[112:115], v[216:219], v[136:139]
    s_waitcnt lgkmcnt(12)
    v_readfirstlane_b32 s3, v63
    s_nop 0
    s_cmp_ge_u32 s3, 4
    s_cbranch_scc1 L_stok_7
    s_mov_b32 s26, 0
L_lw_8:
    ds_read_b32 v14, v13 offset:72
    s_waitcnt lgkmcnt(0)
    v_readfirstlane_b32 s3, v14
    s_nop 0
    s_cmp_ge_u32 s3, 4
    s_cbranch_scc1 L_lwdone_9
    s_add_u32 s26, s26, 1
    s_cmp_lt_u32 s26, 1000000
    s_cbranch_scc1 L_lw_8
L_lwdone_9:
L_stok_7:
    ds_read_b64_tr_b16 v[112:113], v45 offset:13824
    ds_read_b64_tr_b16 v[114:115], v45 offset:16128
    s_waitcnt lgkmcnt(12)
    v_mfma_f32_16x16x32_bf16 v[140:143], v[116:119], v[216:219], v[140:143]
    ds_read_b64_tr_b16 v[116:117], v45 offset:13856
    ds_read_b64_tr_b16 v[118:119], v45 offset:16160
    s_waitcnt lgkmcnt(12)
    v_mfma_f32_16x16x32_bf16 v[124:127], v[120:123], v[220:223], v[124:127]
    ds_read_b64_tr_b16 v[120:121], v45 offset:13888
    ds_read_b64_tr_b16 v[122:123], v45 offset:16192
    s_waitcnt lgkmcnt(12)
    v_mfma_f32_16x16x32_bf16 v[128:131], v[96:99], v[220:223], v[128:131]
    ds_read_b64_tr_b16 v[96:97], v45 offset:13920
    ds_read_b64_tr_b16 v[98:99], v45 offset:16224
    s_waitcnt lgkmcnt(12)
    v_mfma_f32_16x16x32_bf16 v[132:135], v[100:103], v[220:223], v[132:135]
    ds_read_b64_tr_b16 v[100:101], v47 offset:13952
    ds_read_b64_tr_b16 v[102:103], v47 offset:16256
    s_waitcnt lgkmcnt(12)
    v_mfma_f32_16x16x32_bf16 v[136:139], v[104:107], v[220:223], v[136:139]
    ds_read_b64_tr_b16 v[104:105], v45 offset:18432
    ds_read_b64_tr_b16 v[106:107], v45 offset:20736
    s_waitcnt lgkmcnt(12)
    v_mfma_f32_16x16x32_bf16 v[140:143], v[108:111], v[220:223], v[140:143]
    ds_read_b64_tr_b16 v[108:109], v45 offset:18464
    ds_read_b64_tr_b16 v[110:111], v45 offset:20768
    s_waitcnt lgkmcnt(12)
    v_mfma_f32_16x16x32_bf16 v[124:127], v[112:115], v[224:227], v[124:127]
    ds_read_b64_tr_b16 v[112:113], v45 offset:18496
    ds_read_b64_tr_b16 v[114:115], v45 offset:20800
    s_waitcnt lgkmcnt(12)
    v_mfma_f32_16x16x32_bf16 v[128:131], v[116:119], v[224:227], v[128:131]
    ds_read_b64_tr_b16 v[116:117], v45 offset:18528
    ds_read_b64_tr_b16 v[118:119], v45 offset:20832
    s_waitcnt lgkmcnt(12)
    v_mfma_f32_16x16x32_bf16 v[132:135], v[120:123], v[224:227], v[132:135]
    ds_read_b64_tr_b16 v[120:121], v47 offset:18560
    ds_read_b64_tr_b16 v[122:123], v47 offset:20864
    s_waitcnt lgkmcnt(12)
    v_mfma_f32_16x16x32_bf16 v[136:139], v[96:99], v[224:227], v[136:139]
    ds_read_b64_tr_b16 v[96:97], v45 offset:23040
    ds_read_b64_tr_b16 v[98:99], v45 offset:25344
    s_waitcnt lgkmcnt(12)
    v_mfma_f32_16x16x32_bf16 v[140:143], v[100:103], v[224:227], v[140:143]
    ds_read_b64_tr_b16 v[100:101], v45 offset:23072
    ds_read_b64_tr_b16 v[102:103], v45 offset:25376
    s_waitcnt lgkmcnt(12)
    v_mfma_f32_16x16x32_bf16 v[124:127], v[104:107], v[228:231], v[124:127]
    ds_read_b64_tr_b16 v[104:105], v45 offset:23104
    ds_read_b64_tr_b16 v[106:107], v45 offset:25408
    s_waitcnt lgkmcnt(12)
    v_mfma_f32_16x16x32_bf16 v[128:131], v[108:111], v[228:231], v[128:131]
    ds_read_b64_tr_b16 v[108:109], v45 offset:23136
    ds_read_b64_tr_b16 v[110:111], v45 offset:25440
    s_waitcnt lgkmcnt(12)
    v_mfma_f32_16x16x32_bf16 v[132:135], v[112:115], v[228:231], v[132:135]
    ds_read_b64_tr_b16 v[112:113], v47 offset:23168
    ds_read_b64_tr_b16 v[114:115], v47 offset:25472
    s_waitcnt lgkmcnt(12)
    v_mfma_f32_16x16x32_bf16 v[136:139], v[116:119], v[228:231], v[136:139]
    ds_read_b64_tr_b16 v[116:117], v45 offset:27648
    ds_read_b64_tr_b16 v[118:119], v45 offset:29952
    s_waitcnt lgkmcnt(12)
    v_mfma_f32_16x16x32_bf16 v[140:143], v[120:123], v[228:231], v[140:143]
    ds_read_b64_tr_b16 v[120:121], v45 offset:27680
    ds_read_b64_tr_b16 v[122:123], v45 offset:29984
    s_waitcnt lgkmcnt(12)
    v_mfma_f32_16x16x32_bf16 v[124:127], v[96:99], v[232:235], v[124:127]
    ds_read_b64_tr_b16 v[96:97], v45 offset:27712
    ds_read_b64_tr_b16 v[98:99], v45 offset:30016
    s_waitcnt lgkmcnt(12)
    v_mfma_f32_16x16x32_bf16 v[128:131], v[100:103], v[232:235], v[128:131]
    ds_read_b64_tr_b16 v[100:101], v45 offset:27744
    ds_read_b64_tr_b16 v[102:103], v45 offset:30048
    s_waitcnt lgkmcnt(12)
    v_mfma_f32_16x16x32_bf16 v[132:135], v[104:107], v[232:235], v[132:135]
    ds_read_b64_tr_b16 v[104:105], v47 offset:27776
    ds_read_b64_tr_b16 v[106:107], v47 offset:30080
    s_waitcnt lgkmcnt(12)
    v_mfma_f32_16x16x32_bf16 v[136:139], v[108:111], v[232:235], v[136:139]
    ds_read_b64_tr_b16 v[108:109], v45 offset:32256
    ds_read_b64_tr_b16 v[110:111], v45 offset:34560
    s_waitcnt lgkmcnt(12)
    v_mfma_f32_16x16x32_bf16 v[140:143], v[112:115], v[232:235], v[140:143]
    ds_read_b64_tr_b16 v[112:113], v45 offset:32288
    ds_read_b64_tr_b16 v[114:115], v45 offset:34592
    s_waitcnt lgkmcnt(12)
    v_mfma_f32_16x16x32_bf16 v[124:127], v[116:119], v[236:239], v[124:127]
    ds_read_b64_tr_b16 v[116:117], v45 offset:32320
    ds_read_b64_tr_b16 v[118:119], v45 offset:34624
    s_waitcnt lgkmcnt(12)
    v_mfma_f32_16x16x32_bf16 v[128:131], v[120:123], v[236:239], v[128:131]
    ds_read_b64_tr_b16 v[120:121], v45 offset:32352
    ds_read_b64_tr_b16 v[122:123], v45 offset:34656
    s_waitcnt lgkmcnt(12)
    v_mfma_f32_16x16x32_bf16 v[132:135], v[96:99], v[236:239], v[132:135]
    ds_read_b64_tr_b16 v[96:97], v47 offset:32384
    ds_read_b64_tr_b16 v[98:99], v47 offset:34688
    s_waitcnt lgkmcnt(12)
    v_mfma_f32_16x16x32_bf16 v[136:139], v[100:103], v[236:239], v[136:139]
    ds_read_b64_tr_b16 v[100:101], v45 offset:36864
    ds_read_b64_tr_b16 v[102:103], v45 offset:39168
    s_waitcnt lgkmcnt(12)
    v_mfma_f32_16x16x32_bf16 v[140:143], v[104:107], v[236:239], v[140:143]
    ds_read_b64_tr_b16 v[104:105], v45 offset:36896
    ds_read_b64_tr_b16 v[106:107], v45 offset:39200
    s_waitcnt lgkmcnt(12)
    v_mfma_f32_16x16x32_bf16 v[124:127], v[108:111], v[240:243], v[124:127]
    ds_read_b64_tr_b16 v[108:109], v45 offset:36928
    ds_read_b64_tr_b16 v[110:111], v45 offset:39232
    s_waitcnt lgkmcnt(12)
    v_mfma_f32_16x16x32_bf16 v[128:131], v[112:115], v[240:243], v[128:131]
    ds_read_b64_tr_b16 v[112:113], v45 offset:36960
    ds_read_b64_tr_b16 v[114:115], v45 offset:39264
    s_waitcnt lgkmcnt(12)
    v_mfma_f32_16x16x32_bf16 v[132:135], v[116:119], v[240:243], v[132:135]
    ds_read_b64_tr_b16 v[116:117], v47 offset:36992
    ds_read_b64_tr_b16 v[118:119], v47 offset:39296
    s_waitcnt lgkmcnt(12)
    v_mfma_f32_16x16x32_bf16 v[136:139], v[120:123], v[240:243], v[136:139]
    s_waitcnt lgkmcnt(10)
    v_mfma_f32_16x16x32_bf16 v[140:143], v[96:99], v[240:243], v[140:143]
    s_waitcnt lgkmcnt(8)
    v_mfma_f32_16x16x32_bf16 v[124:127], v[100:103], v[244:247], v[124:127]
    s_waitcnt lgkmcnt(6)
    v_mfma_f32_16x16x32_bf16 v[128:131], v[104:107], v[244:247], v[128:131]
    s_waitcnt lgkmcnt(4)
    v_mfma_f32_16x16x32_bf16 v[132:135], v[108:111], v[244:247], v[132:135]
    s_waitcnt lgkmcnt(2)
    v_mfma_f32_16x16x32_bf16 v[136:139], v[112:115], v[244:247], v[136:139]
    s_waitcnt lgkmcnt(0)
    v_mfma_f32_16x16x32_bf16 v[140:143], v[116:119], v[244:247], v[140:143]
    s_setprio 3
    s_mov_b64 exec, 1
    ds_add_u32 v13, v12 offset:32
    s_mov_b64 exec, -1
    s_mov_b32 s26, 0
L_lw_10:
    ds_read_b32 v14, v13 offset:60
    s_waitcnt lgkmcnt(0)
    v_readfirstlane_b32 s3, v14
    s_nop 0
    s_cmp_ge_u32 s3, 1
    s_cbranch_scc1 L_lwdone_11
    s_add_u32 s26, s26, 1
    s_cmp_lt_u32 s26, 1000000
    s_cbranch_scc1 L_lw_10
L_lwdone_11:
    s_lshl2_add_u32 s34, s23, s21
    s_mul_i32 s94, s34, 256
    s_add_u32 s94, s94, 8
    s_mov_b32 s0, 0
    s_atomic_add s0, s[44:45], s94 glc
    v_mul_f32 v64, v124, v124
    v_mul_f32 v65, v125, v125
    v_mul_f32 v66, v126, v126
    v_mul_f32 v67, v127, v127
    v_mul_f32 v68, v128, v128
    v_mul_f32 v69, v129, v129
    v_mul_f32 v70, v130, v130
    v_mul_f32 v71, v131, v131
    v_fma_f32 v64, v64, v57, v56
    v_fma_f32 v65, v65, v57, v56
    v_fma_f32 v66, v66, v57, v56
    v_fma_f32 v67, v67, v57, v56
    v_fma_f32 v68, v68, v57, v56
    v_fma_f32 v69, v69, v57, v56
    v_fma_f32 v70, v70, v57, v56
    v_fma_f32 v71, v71, v57, v56
    v_mul_f32 v64, v64, v124
    v_mul_f32 v65, v65, v125
    v_mul_f32 v66, v66, v126
    v_mul_f32 v67, v67, v127
    v_mul_f32 v68, v68, v128
    v_mul_f32 v69, v69, v129
    v_mul_f32 v70, v70, v130
    v_mul_f32 v71, v71, v131
    v_exp_f32 v64, v64
    v_exp_f32 v65, v65
    v_exp_f32 v66, v66
    v_exp_f32 v67, v67
    v_exp_f32 v68, v68
    v_exp_f32 v69, v69
    v_exp_f32 v70, v70
    v_exp_f32 v71, v71
    v_fma_f32 v64, v64, v58, v58
    v_fma_f32 v65, v65, v58, v58
    v_fma_f32 v66, v66, v58, v58
    v_fma_f32 v67, v67, v58, v58
    v_fma_f32 v68, v68, v58, v58
    v_fma_f32 v69, v69, v58, v58
    v_fma_f32 v70, v70, v58, v58
    v_fma_f32 v71, v71, v58, v58
    v_rcp_f32 v64, v64
    v_rcp_f32 v65, v65
    v_rcp_f32 v66, v66
    v_rcp_f32 v67, v67
    v_rcp_f32 v68, v68
    v_rcp_f32 v69, v69
    v_rcp_f32 v70, v70
    v_rcp_f32 v71, v71
    v_mul_f32 v64, v64, v124
    v_mul_f32 v65, v65, v125
    v_mul_f32 v66, v66, v126
    v_mul_f32 v67, v67, v127
    v_mul_f32 v68, v68, v128
    v_mul_f32 v69, v69, v129
    v_mul_f32 v70, v70, v130
    v_mul_f32 v71, v71, v131
    v_cvt_pk_bf16_f32 v24, v64, v65
    v_cvt_pk_bf16_f32 v25, v66, v67
    v_cvt_pk_bf16_f32 v26, v68, v69
    v_cvt_pk_bf16_f32 v27, v70, v71
    s_mov_b32 s35, 3145728
    buffer_store_dwordx4 v[24:27], v48, s[4:7], s35 offen offset:0 sc1
    v_mul_f32 v72, v132, v132
    v_mul_f32 v73, v133, v133
    v_mul_f32 v74, v134, v134
    v_mul_f32 v75, v135, v135
    v_mul_f32 v76, v136, v136
    v_mul_f32 v77, v137, v137
    v_mul_f32 v78, v138, v138
    v_mul_f32 v79, v139, v139
    v_mul_f32 v80, v140, v140
    v_mul_f32 v81, v141, v141
    v_mul_f32 v82, v142, v142
    v_mul_f32 v83, v143, v143
    v_fma_f32 v72, v72, v57, v56
    v_fma_f32 v73, v73, v57, v56
    v_fma_f32 v74, v74, v57, v56
    v_fma_f32 v75, v75, v57, v56
    v_fma_f32 v76, v76, v57, v56
    v_fma_f32 v77, v77, v57, v56
    v_fma_f32 v78, v78, v57, v56
    v_fma_f32 v79, v79, v57, v56
    v_fma_f32 v80, v80, v57, v56
    v_fma_f32 v81, v81, v57, v56
    v_fma_f32 v82, v82, v57, v56
    v_fma_f32 v83, v83, v57, v56
    v_mul_f32 v72, v72, v132
    v_mul_f32 v73, v73, v133
    v_mul_f32 v74, v74, v134
    v_mul_f32 v75, v75, v135
    v_mul_f32 v76, v76, v136
    v_mul_f32 v77, v77, v137
    v_mul_f32 v78, v78, v138
    v_mul_f32 v79, v79, v139
    v_mul_f32 v80, v80, v140
    v_mul_f32 v81, v81, v141
    v_mul_f32 v82, v82, v142
    v_mul_f32 v83, v83, v143
    v_exp_f32 v72, v72
    v_exp_f32 v73, v73
    v_exp_f32 v74, v74
    v_exp_f32 v75, v75
    v_exp_f32 v76, v76
    v_exp_f32 v77, v77
    v_exp_f32 v78, v78
    v_exp_f32 v79, v79
    v_exp_f32 v80, v80
    v_exp_f32 v81, v81
    v_exp_f32 v82, v82
    v_exp_f32 v83, v83
    v_fma_f32 v72, v72, v58, v58
    v_fma_f32 v73, v73, v58, v58
    v_fma_f32 v74, v74, v58, v58
    v_fma_f32 v75, v75, v58, v58
    v_fma_f32 v76, v76, v58, v58
    v_fma_f32 v77, v77, v58, v58
    v_fma_f32 v78, v78, v58, v58
    v_fma_f32 v79, v79, v58, v58
    v_fma_f32 v80, v80, v58, v58
    v_fma_f32 v81, v81, v58, v58
    v_fma_f32 v82, v82, v58, v58
    v_fma_f32 v83, v83, v58, v58
    v_rcp_f32 v72, v72
    v_rcp_f32 v73, v73
    v_rcp_f32 v74, v74
    v_rcp_f32 v75, v75
    v_rcp_f32 v76, v76
    v_rcp_f32 v77, v77
    v_rcp_f32 v78, v78
    v_rcp_f32 v79, v79
    v_rcp_f32 v80, v80
    v_rcp_f32 v81, v81
    v_rcp_f32 v82, v82
    v_rcp_f32 v83, v83
    v_mul_f32 v72, v72, v132
    v_mul_f32 v73, v73, v133
    v_mul_f32 v74, v74, v134
    v_mul_f32 v75, v75, v135
    v_mul_f32 v76, v76, v136
    v_mul_f32 v77, v77, v137
    v_mul_f32 v78, v78, v138
    v_mul_f32 v79, v79, v139
    v_mul_f32 v80, v80, v140
    v_mul_f32 v81, v81, v141
    v_mul_f32 v82, v82, v142
    v_mul_f32 v83, v83, v143
    v_cvt_pk_bf16_f32 v28, v72, v73
    v_cvt_pk_bf16_f32 v29, v74, v75
    v_cvt_pk_bf16_f32 v30, v76, v77
    v_cvt_pk_bf16_f32 v31, v78, v79
    v_cvt_pk_bf16_f32 v32, v80, v81
    v_cvt_pk_bf16_f32 v33, v82, v83
    buffer_store_dwordx4 v[28:31], v48, s[4:7], s35 offen offset:1024 sc1
    buffer_store_dwordx2 v[32:33], v49, s[4:7], s35 offen sc1
    s_mov_b64 exec, 1
    ds_add_u32 v13, v12 offset:16
    s_mov_b64 exec, -1
    s_mul_i32 s96, s27, 18432
    s_add_u32 s96, s96, 3145728
    s_mul_i32 s92, s23, 1504256
    s_add_u32 s92, s92, 10260480
    s_lshl_b32 s93, s21, 10
    s_add_u32 s93, s93, 73728
    s_mov_b32 s26, 0
L_lw_12:
    ds_read_b32 v14, v13 offset:32
    s_waitcnt lgkmcnt(0)
    v_readfirstlane_b32 s3, v14
    s_nop 0
    s_cmp_ge_u32 s3, 4
    s_cbranch_scc1 L_lwdone_13
    s_add_u32 s26, s26, 1
    s_cmp_lt_u32 s26, 1000000
    s_cbranch_scc1 L_lw_12
L_lwdone_13:
    s_waitcnt lgkmcnt(0)
    s_cmp_ge_u32 s0, 36
    s_cbranch_scc1 L_chkok_14
    s_mov_b32 s26, 0
L_poll_15:
    s_mov_b32 s3, 0
    s_atomic_add s3, s[44:45], s94 glc
    s_waitcnt lgkmcnt(0)
    s_cmp_ge_u32 s3, 36
    s_cbranch_scc1 L_pdone_16
    s_sleep 8
    s_add_u32 s26, s26, 1
    s_cmp_lt_u32 s26, 40000
    s_cbranch_scc1 L_poll_15
L_pdone_16:
L_chkok_14:
    s_add_u32 m0, s93, 0
    s_add_u32 s26, s92, m0
    buffer_load_dwordx4 v3, s[4:7], s26 offen sc1 lds
    s_add_u32 m0, s93, 4096
    s_add_u32 s26, s92, m0
    buffer_load_dwordx4 v3, s[4:7], s26 offen sc1 lds
    s_add_u32 m0, s93, 8192
    s_add_u32 s26, s92, m0
    buffer_load_dwordx4 v3, s[4:7], s26 offen sc1 lds
    s_add_u32 m0, s93, 12288
    s_add_u32 s26, s92, m0
    buffer_load_dwordx4 v3, s[4:7], s26 offen sc1 lds
    s_add_u32 m0, s93, 16384
    s_add_u32 s26, s92, m0
    buffer_load_dwordx4 v3, s[4:7], s26 offen sc1 lds
    s_add_u32 m0, s93, 20480
    s_add_u32 s26, s92, m0
    buffer_load_dwordx4 v3, s[4:7], s26 offen sc1 lds
    s_waitcnt vmcnt(6)
    s_mov_b32 s1, 1
    s_atomic_add s1, s[44:45], s72
    s_mov_b32 s1, 1
    s_atomic_add s1, s[44:45], s73
    s_add_u32 m0, s93, 24576
    s_add_u32 s26, s92, m0
    buffer_load_dwordx4 v3, s[4:7], s26 offen sc1 lds
    s_add_u32 m0, s93, 28672
    s_add_u32 s26, s92, m0
    buffer_load_dwordx4 v3, s[4:7], s26 offen sc1 lds
    s_add_u32 m0, s93, 32768
    s_add_u32 s26, s92, m0
    buffer_load_dwordx4 v3, s[4:7], s26 offen sc1 lds
    s_add_u32 m0, s93, 36864
    s_add_u32 s26, s92, m0
    buffer_load_dwordx4 v3, s[4:7], s26 offen sc1 lds
    s_add_u32 m0, s93, 40960
    s_add_u32 s26, s92, m0
    buffer_load_dwordx4 v3, s[4:7], s26 offen sc1 lds
    s_add_u32 m0, s93, 45056
    s_add_u32 s26, s92, m0
    buffer_load_dwordx4 v3, s[4:7], s26 offen sc1 lds
    s_add_u32 m0, s93, 49152
    s_add_u32 s26, s92, m0
    buffer_load_dwordx4 v3, s[4:7], s26 offen sc1 lds
    s_add_u32 m0, s93, 53248
    s_add_u32 s26, s92, m0
    buffer_load_dwordx4 v3, s[4:7], s26 offen sc1 lds
    s_add_u32 m0, s93, 57344
    s_add_u32 s26, s92, m0
    buffer_load_dwordx4 v3, s[4:7], s26 offen sc1 lds
    s_mov_b32 s3, 0
    s_atomic_add s3, s[44:45], s73 glc
    s_add_u32 m0, s93, 61440
    s_add_u32 s26, s92, m0
    buffer_load_dwordx4 v3, s[4:7], s26 offen sc1 lds
    s_add_u32 m0, s93, 65536
    s_add_u32 s26, s92, m0
    buffer_load_dwordx4 v3, s[4:7], s26 offen sc1 lds
    s_add_u32 m0, s93, 69632
    s_add_u32 s26, s92, m0
    buffer_load_dwordx4 v3, s[4:7], s26 offen sc1 lds
    s_add_u32 m0, s93, 73728
    s_add_u32 s26, s92, m0
    buffer_load_dwordx4 v3, s[4:7], s26 offen sc1 lds
    s_add_u32 m0, s93, 77824
    s_add_u32 s26, s92, m0
    buffer_load_dwordx4 v3, s[4:7], s26 offen sc1 lds
    s_mov_b32 m0, 155648
    s_add_u32 s26, s92, m0
    buffer_load_dwordx4 v3, s[4:7], s26 offen sc1 lds
    s_waitcnt lgkmcnt(0)
    s_cmp_ge_u32 s3, 16
    s_cbranch_scc1 L_pdone_18
    s_mov_b32 s26, 0
L_poll_17:
    s_mov_b32 s3, 0
    s_atomic_add s3, s[44:45], s73 glc
    s_waitcnt lgkmcnt(0)
    s_cmp_ge_u32 s3, 16
    s_cbranch_scc1 L_pdone_18
    s_add_u32 s26, s26, 1
    s_cmp_lt_u32 s26, 40000
    s_cbranch_scc1 L_poll_17
L_pdone_18:
    buffer_load_dwordx4 v[176:179], v3, s[4:7], s96 offen offset:0 sc1
    buffer_load_dwordx4 v[180:183], v3, s[4:7], s96 offen offset:1024 sc1
    buffer_load_dwordx4 v[184:187], v3, s[4:7], s96 offen offset:2048 sc1
    buffer_load_dwordx4 v[188:191], v3, s[4:7], s96 offen offset:3072 sc1
    s_add_u32 s96, s96, 4096
    buffer_load_dwordx4 v[192:195], v3, s[4:7], s96 offen offset:0 sc1
    buffer_load_dwordx4 v[196:199], v3, s[4:7], s96 offen offset:1024 sc1
    buffer_load_dwordx4 v[200:203], v3, s[4:7], s96 offen offset:2048 sc1
    buffer_load_dwordx4 v[204:207], v3, s[4:7], s96 offen offset:3072 sc1
    s_waitcnt vmcnt(8)
    s_mov_b64 exec, 1
    ds_add_u32 v13, v12 offset:0
    s_mov_b64 exec, -1
    v_lshlrev_b32 v124, 16, v156
    v_and_b32 v128, s28, v156
    v_lshlrev_b32 v132, 16, v157
    v_and_b32 v136, s28, v157
    v_lshlrev_b32 v125, 16, v158
    v_and_b32 v129, s28, v158
    v_lshlrev_b32 v133, 16, v159
    v_and_b32 v137, s28, v159
    v_lshlrev_b32 v126, 16, v160
    v_and_b32 v130, s28, v160
    v_lshlrev_b32 v134, 16, v161
    v_and_b32 v138, s28, v161
    v_lshlrev_b32 v127, 16, v162
    v_and_b32 v131, s28, v162
    v_lshlrev_b32 v135, 16, v163
    v_and_b32 v139, s28, v163
    v_lshlrev_b32 v140, 16, v164
    v_and_b32 v141, s28, v164
    v_lshlrev_b32 v142, 16, v165
    v_and_b32 v143, s28, v165
    s_mov_b32 s26, 0
L_lw_19:
    ds_read_b32 v14, v13 offset:0
    s_waitcnt lgkmcnt(0)
    v_readfirstlane_b32 s3, v14
    s_nop 0
    s_cmp_ge_u32 s3, 4
    s_cbranch_scc1 L_lwdone_20
    s_add_u32 s26, s26, 1
    s_cmp_lt_u32 s26, 1000000
    s_cbranch_scc1 L_lw_19
L_lwdone_20:
    ds_read_b128 v[64:67], v4 offset:8192
    ds_read_b128 v[68:71], v4 offset:9216
    ds_read_b128 v[72:75], v4 offset:10240
    ds_read_b128 v[76:79], v4 offset:11264
    ds_read_b128 v[80:83], v50 offset:0
    ds_read_b128 v[84:87], v4 offset:12800
    ds_read_b128 v[88:91], v4 offset:13824
    ds_read_b128 v[92:95], v4 offset:14848
    ds_read_b128 v[96:99], v4 offset:15872
    ds_read_b128 v[100:103], v50 offset:4608
    ds_read_b128 v[104:107], v4 offset:17408
    ds_read_b128 v[108:111], v4 offset:18432
    ds_read_b128 v[112:115], v4 offset:19456
    ds_read_b128 v[116:119], v4 offset:20480
    s_waitcnt vmcnt(7) lgkmcnt(9)
    v_mfma_f32_16x16x32_bf16 v[124:127], v[64:67], v[176:179], v[124:127]
    ds_read_b128 v[64:67], v50 offset:9216
    v_mfma_f32_16x16x32_bf16 v[128:131], v[68:71], v[176:179], v[128:131]
    ds_read_b128 v[68:71], v4 offset:22016
    s_add_u32 s96, s96, 4096
    buffer_load_dwordx4 v[208:211], v3, s[4:7], s96 offen offset:0 sc1
    v_mfma_f32_16x16x32_bf16 v[132:135], v[72:75], v[176:179], v[132:135]
    ds_read_b128 v[72:75], v4 offset:23040
    v_mfma_f32_16x16x32_bf16 v[136:139], v[76:79], v[176:179], v[136:139]
    ds_read_b128 v[76:79], v4 offset:24064
    buffer_load_dwordx4 v[212:215], v3, s[4:7], s96 offen offset:1024 sc1
    v_mfma_f32_16x16x32_bf16 v[140:143], v[80:83], v[176:179], v[140:143]
    ds_read_b128 v[80:83], v4 offset:25088
    s_waitcnt vmcnt(8) lgkmcnt(9)
    v_mfma_f32_16x16x32_bf16 v[124:127], v[84:87], v[180:183], v[124:127]
    ds_read_b128 v[84:87], v50 offset:13824
    v_mfma_f32_16x16x32_bf16 v[128:131], v[88:91], v[180:183], v[128:131]
    ds_read_b128 v[88:91], v4 offset:26624
    buffer_load_dwordx4 v[216:219], v3, s[4:7], s96 offen offset:2048 sc1
    v_mfma_f32_16x16x32_bf16 v[132:135], v[92:95], v[180:183], v[132:135]
    ds_read_b128 v[92:95], v4 offset:27648
    v_mfma_f32_16x16x32_bf16 v[136:139], v[96:99], v[180:183], v[136:139]
    ds_read_b128 v[96:99], v4 offset:28672
    buffer_load_dwordx4 v[220:223], v3, s[4:7], s96 offen offset:3072 sc1
    v_mfma_f32_16x16x32_bf16 v[140:143], v[100:103], v[180:183], v[140:143]
    ds_read_b128 v[100:103], v4 offset:29696
    s_waitcnt vmcnt(9) lgkmcnt(9)
    v_mfma_f32_16x16x32_bf16 v[124:127], v[104:107], v[184:187], v[124:127]
    ds_read_b128 v[104:107], v50 offset:18432
    v_mfma_f32_16x16x32_bf16 v[128:131], v[108:111], v[184:187], v[128:131]
    ds_read_b128 v[108:111], v4 offset:31232
    s_add_u32 s96, s96, 4096
    buffer_load_dwordx4 v[224:227], v3, s[4:7], s96 offen offset:0 sc1
    v_mfma_f32_16x16x32_bf16 v[132:135], v[112:115], v[184:187], v[132:135]
    ds_read_b128 v[112:115], v4 offset:32256
    v_mfma_f32_16x16x32_bf16 v[136:139], v[116:119], v[184:187], v[136:139]
    ds_read_b128 v[116:119], v4 offset:33280
    buffer_load_dwordx4 v[228:231], v3, s[4:7], s96 offen offset:1024 sc1
    v_mfma_f32_16x16x32_bf16 v[140:143], v[64:67], v[184:187], v[140:143]
    ds_read_b128 v[64:67], v4 offset:34304
    s_waitcnt vmcnt(10) lgkmcnt(9)
    v_mfma_f32_16x16x32_bf16 v[124:127], v[68:71], v[188:191], v[124:127]
    ds_read_b128 v[68:71], v50 offset:23040
    v_mfma_f32_16x16x32_bf16 v[128:131], v[72:75], v[188:191], v[128:131]
    ds_read_b128 v[72:75], v4 offset:35840
    buffer_load_dwordx4 v[232:235], v3, s[4:7], s96 offen offset:2048 sc1
    v_mfma_f32_16x16x32_bf16 v[132:135], v[76:79], v[188:191], v[132:135]
    ds_read_b128 v[76:79], v4 offset:36864
    v_mfma_f32_16x16x32_bf16 v[136:139], v[80:83], v[188:191], v[136:139]
    ds_read_b128 v[80:83], v4 offset:37888
    buffer_load_dwordx4 v[236:239], v3, s[4:7], s96 offen offset:3072 sc1
    v_mfma_f32_16x16x32_bf16 v[140:143], v[84:87], v[188:191], v[140:143]
    ds_read_b128 v[84:87], v4 offset:38912
    s_waitcnt vmcnt(11) lgkmcnt(9)
    v_mfma_f32_16x16x32_bf16 v[124:127], v[88:91], v[192:195], v[124:127]
    ds_read_b128 v[88:91], v50 offset:27648
    v_mfma_f32_16x16x32_bf16 v[128:131], v[92:95], v[192:195], v[128:131]
    ds_read_b128 v[92:95], v4 offset:40448
    s_add_u32 s96, s96, 4096
    buffer_load_dwordx2 v[240:241], v59, s[4:7], s96 offen offset:0 sc1
    buffer_load_dwordx2 v[242:243], v59, s[4:7], s96 offen offset:512 sc1
    v_mfma_f32_16x16x32_bf16 v[132:135], v[96:99], v[192:195], v[132:135]
    ds_read_b128 v[96:99], v4 offset:41472
    v_mfma_f32_16x16x32_bf16 v[136:139], v[100:103], v[192:195], v[136:139]
    ds_read_b128 v[100:103], v4 offset:42496
    buffer_load_dwordx2 v[244:245], v59, s[4:7], s96 offen offset:1024 sc1
    buffer_load_dwordx2 v[246:247], v59, s[4:7], s96 offen offset:1536 sc1
    s_mov_b64 exec, 1
    ds_add_u32 v13, v12 offset:20
    s_mov_b64 exec, -1
    v_mfma_f32_16x16x32_bf16 v[140:143], v[104:107], v[192:195], v[140:143]
    ds_read_b128 v[104:107], v4 offset:43520
    s_waitcnt vmcnt(14) lgkmcnt(10)
    v_mfma_f32_16x16x32_bf16 v[124:127], v[108:111], v[196:199], v[124:127]
    ds_read_b128 v[108:111], v50 offset:32256
    v_mfma_f32_16x16x32_bf16 v[128:131], v[112:115], v[196:199], v[128:131]
    ds_read_b128 v[112:115], v4 offset:45056
    v_mfma_f32_16x16x32_bf16 v[132:135], v[116:119], v[196:199], v[132:135]
    ds_read_b128 v[116:119], v4 offset:46080
    v_mfma_f32_16x16x32_bf16 v[136:139], v[64:67], v[196:199], v[136:139]
    ds_read_b128 v[64:67], v4 offset:47104
    v_mfma_f32_16x16x32_bf16 v[140:143], v[68:71], v[196:199], v[140:143]
    ds_read_b128 v[68:71], v4 offset:48128
    s_waitcnt vmcnt(13) lgkmcnt(10)
    v_mfma_f32_16x16x32_bf16 v[124:127], v[72:75], v[200:203], v[124:127]
    ds_read_b128 v[72:75], v50 offset:36864
    v_mfma_f32_16x16x32_bf16 v[128:131], v[76:79], v[200:203], v[128:131]
    ds_read_b128 v[76:79], v4 offset:49664
    v_mfma_f32_16x16x32_bf16 v[132:135], v[80:83], v[200:203], v[132:135]
    ds_read_b128 v[80:83], v4 offset:50688
    v_mfma_f32_16x16x32_bf16 v[136:139], v[84:87], v[200:203], v[136:139]
    ds_read_b128 v[84:87], v4 offset:51712
    v_mfma_f32_16x16x32_bf16 v[140:143], v[88:91], v[200:203], v[140:143]
    ds_read_b128 v[88:91], v4 offset:52736
    s_waitcnt vmcnt(12) lgkmcnt(9)
    v_mfma_f32_16x16x32_bf16 v[124:127], v[92:95], v[204:207], v[124:127]
    ds_read_b128 v[92:95], v51 offset:0
    v_mfma_f32_16x16x32_bf16 v[128:131], v[96:99], v[204:207], v[128:131]
    ds_read_b128 v[96:99], v4 offset:54272
    v_mfma_f32_16x16x32_bf16 v[132:135], v[100:103], v[204:207], v[132:135]
    ds_read_b128 v[100:103], v4 offset:55296
    v_mfma_f32_16x16x32_bf16 v[136:139], v[104:107], v[204:207], v[136:139]
    ds_read_b128 v[104:107], v4 offset:56320
    v_mfma_f32_16x16x32_bf16 v[140:143], v[108:111], v[204:207], v[140:143]
    ds_read_b128 v[108:111], v4 offset:57344
    s_waitcnt vmcnt(11) lgkmcnt(9)
    v_mfma_f32_16x16x32_bf16 v[124:127], v[112:115], v[208:211], v[124:127]
    ds_read_b128 v[112:115], v51 offset:4608
    v_mfma_f32_16x16x32_bf16 v[128:131], v[116:119], v[208:211], v[128:131]
    ds_read_b128 v[116:119], v4 offset:58880
    v_mfma_f32_16x16x32_bf16 v[132:135], v[64:67], v[208:211], v[132:135]
    ds_read_b128 v[64:67], v4 offset:59904
    v_mfma_f32_16x16x32_bf16 v[136:139], v[68:71], v[208:211], v[136:139]
    ds_read_b128 v[68:71], v4 offset:60928
    v_mfma_f32_16x16x32_bf16 v[140:143], v[72:75], v[208:211], v[140:143]
    ds_read_b128 v[72:75], v4 offset:61952
    s_waitcnt vmcnt(10) lgkmcnt(9)
    v_mfma_f32_16x16x32_bf16 v[124:127], v[76:79], v[212:215], v[124:127]
    ds_read_b128 v[76:79], v51 offset:9216
    v_mfma_f32_16x16x32_bf16 v[128:131], v[80:83], v[212:215], v[128:131]
    ds_read_b128 v[80:83], v4 offset:63488
    v_mfma_f32_16x16x32_bf16 v[132:135], v[84:87], v[212:215], v[132:135]
    ds_read_b128 v[84:87], v4 offset:64512
    v_mfma_f32_16x16x32_bf16 v[136:139], v[88:91], v[212:215], v[136:139]
    ds_read_b128 v[88:91], v5 offset:0
    v_mfma_f32_16x16x32_bf16 v[140:143], v[92:95], v[212:215], v[140:143]
    ds_read_b128 v[92:95], v5 offset:1024
    s_waitcnt vmcnt(9) lgkmcnt(9)
    v_mfma_f32_16x16x32_bf16 v[124:127], v[96:99], v[216:219], v[124:127]
    ds_read_b128 v[96:99], v51 offset:13824
    v_mfma_f32_16x16x32_bf16 v[128:131], v[100:103], v[216:219], v[128:131]
    ds_read_b128 v[100:103], v5 offset:2560
    v_mfma_f32_16x16x32_bf16 v[132:135], v[104:107], v[216:219], v[132:135]
    ds_read_b128 v[104:107], v5 offset:3584
    v_mfma_f32_16x16x32_bf16 v[136:139], v[108:111], v[216:219], v[136:139]
    ds_read_b128 v[108:111], v5 offset:4608
    v_mfma_f32_16x16x32_bf16 v[140:143], v[112:115], v[216:219], v[140:143]
    ds_read_b128 v[112:115], v5 offset:5632
    s_waitcnt vmcnt(8) lgkmcnt(9)
    v_mfma_f32_16x16x32_bf16 v[124:127], v[116:119], v[220:223], v[124:127]
    ds_read_b128 v[116:119], v51 offset:18432
    v_mfma_f32_16x16x32_bf16 v[128:131], v[64:67], v[220:223], v[128:131]
    ds_read_b128 v[64:67], v5 offset:7168
    v_mfma_f32_16x16x32_bf16 v[132:135], v[68:71], v[220:223], v[132:135]
    ds_read_b128 v[68:71], v5 offset:8192
    v_mfma_f32_16x16x32_bf16 v[136:139], v[72:75], v[220:223], v[136:139]
    ds_read_b128 v[72:75], v5 offset:9216
    v_mfma_f32_16x16x32_bf16 v[140:143], v[76:79], v[220:223], v[140:143]
    ds_read_b128 v[76:79], v5 offset:10240
    s_waitcnt vmcnt(7) lgkmcnt(9)
    v_mfma_f32_16x16x32_bf16 v[124:127], v[80:83], v[224:227], v[124:127]
    ds_read_b128 v[80:83], v51 offset:23040
    v_mfma_f32_16x16x32_bf16 v[128:131], v[84:87], v[224:227], v[128:131]
    ds_read_b128 v[84:87], v5 offset:11776
    v_mfma_f32_16x16x32_bf16 v[132:135], v[88:91], v[224:227], v[132:135]
    ds_read_b128 v[88:91], v5 offset:12800
    v_mfma_f32_16x16x32_bf16 v[136:139], v[92:95], v[224:227], v[136:139]
    ds_read_b128 v[92:95], v5 offset:13824
    v_mfma_f32_16x16x32_bf16 v[140:143], v[96:99], v[224:227], v[140:143]
    ds_read_b128 v[96:99], v5 offset:14848
    s_waitcnt vmcnt(6) lgkmcnt(9)
    v_mfma_f32_16x16x32_bf16 v[124:127], v[100:103], v[228:231], v[124:127]
    ds_read_b128 v[100:103], v51 offset:27648
    v_mfma_f32_16x16x32_bf16 v[128:131], v[104:107], v[228:231], v[128:131]
    ds_read_b128 v[104:107], v5 offset:16384
    v_mfma_f32_16x16x32_bf16 v[132:135], v[108:111], v[228:231], v[132:135]
    ds_read_b128 v[108:111], v5 offset:17408
    v_mfma_f32_16x16x32_bf16 v[136:139], v[112:115], v[228:231], v[136:139]
    ds_read_b128 v[112:115], v5 offset:18432
    v_mfma_f32_16x16x32_bf16 v[140:143], v[116:119], v[228:231], v[140:143]
    ds_read_b128 v[116:119], v5 offset:19456
    s_waitcnt vmcnt(5) lgkmcnt(9)
    v_mfma_f32_16x16x32_bf16 v[124:127], v[64:67], v[232:235], v[124:127]
    ds_read_b128 v[64:67], v51 offset:32256
    v_mfma_f32_16x16x32_bf16 v[128:131], v[68:71], v[232:235], v[128:131]
    ds_read_b128 v[68:71], v5 offset:20992
    v_mfma_f32_16x16x32_bf16 v[132:135], v[72:75], v[232:235], v[132:135]
    ds_read_b128 v[72:75], v5 offset:22016
    v_mfma_f32_16x16x32_bf16 v[136:139], v[76:79], v[232:235], v[136:139]
    ds_read_b128 v[76:79], v5 offset:23040
    v_mfma_f32_16x16x32_bf16 v[140:143], v[80:83], v[232:235], v[140:143]
    ds_read_b128 v[80:83], v5 offset:24064
    s_waitcnt vmcnt(4) lgkmcnt(9)
    v_mfma_f32_16x16x32_bf16 v[124:127], v[84:87], v[236:239], v[124:127]
    ds_read_b128 v[84:87], v51 offset:36864
    v_mfma_f32_16x16x32_bf16 v[128:131], v[88:91], v[236:239], v[128:131]
    v_mfma_f32_16x16x32_bf16 v[132:135], v[92:95], v[236:239], v[132:135]
    v_mfma_f32_16x16x32_bf16 v[136:139], v[96:99], v[236:239], v[136:139]
    v_mfma_f32_16x16x32_bf16 v[140:143], v[100:103], v[236:239], v[140:143]
    s_waitcnt vmcnt(2) lgkmcnt(5)
    v_mfma_f32_16x16x32_bf16 v[124:127], v[104:107], v[240:243], v[124:127]
    v_mfma_f32_16x16x32_bf16 v[128:131], v[108:111], v[240:243], v[128:131]
    v_mfma_f32_16x16x32_bf16 v[132:135], v[112:115], v[240:243], v[132:135]
    v_mfma_f32_16x16x32_bf16 v[136:139], v[116:119], v[240:243], v[136:139]
    v_mfma_f32_16x16x32_bf16 v[140:143], v[64:67], v[240:243], v[140:143]
    s_waitcnt vmcnt(0) lgkmcnt(0)
    v_mfma_f32_16x16x32_bf16 v[124:127], v[68:71], v[244:247], v[124:127]
    v_mfma_f32_16x16x32_bf16 v[128:131], v[72:75], v[244:247], v[128:131]
    v_mfma_f32_16x16x32_bf16 v[132:135], v[76:79], v[244:247], v[132:135]
    v_mfma_f32_16x16x32_bf16 v[136:139], v[80:83], v[244:247], v[136:139]
    v_mfma_f32_16x16x32_bf16 v[140:143], v[84:87], v[244:247], v[140:143]
    s_mov_b64 exec, 1
    ds_add_u32 v13, v12 offset:4
    s_mov_b64 exec, -1
    v_cmp_gt_u32 vcc, 2, v2
    s_lshl_b32 s33, s27, 10
    s_add_u32 s33, s33, 8388608
    s_lshl_b32 s34, s23, 7
    s_add_u32 s34, s34, s33
    v_cvt_pk_bf16_f32 v24, v124, v128
    v_cvt_pk_bf16_f32 v25, v132, v136
    v_cvt_pk_bf16_f32 v26, v125, v129
    v_cvt_pk_bf16_f32 v27, v133, v137
    s_mov_b32 s35, 5767168
    buffer_store_dwordx4 v[24:27], v34, s[4:7], s35 offen offset:0 sc1
    v_mfma_f32_16x16x32_bf16 v[148:151], v[24:27], v[24:27], 0
    v_mfma_f32_16x16x32_bf16 v[144:147], v[152:155], v[24:27], 0
    v_cvt_pk_bf16_f32 v28, v126, v130
    v_cvt_pk_bf16_f32 v29, v134, v138
    v_cvt_pk_bf16_f32 v30, v127, v131
    v_cvt_pk_bf16_f32 v31, v135, v139
    buffer_store_dwordx4 v[28:31], v34, s[4:7], s35 offen offset:1024 sc1
    s_nop 0
    v_mfma_f32_16x16x32_bf16 v[148:151], v[28:31], v[28:31], v[148:151]
    v_mfma_f32_16x16x32_bf16 v[144:147], v[152:155], v[28:31], v[144:147]
    v_cvt_pk_bf16_f32 v32, v140, v141
    v_cvt_pk_bf16_f32 v33, v142, v143
    v_cndmask_b32 v18, 0, v32, vcc
    v_cndmask_b32 v19, 0, v33, vcc
    buffer_store_dwordx2 v[32:33], v35, s[4:7], s35 offen sc1
    s_nop 0
    v_mfma_f32_16x16x16_bf16 v[148:151], v[18:19], v[18:19], v[148:151]
    v_mfma_f32_16x16x16_bf16 v[144:147], v[152:153], v[18:19], v[144:147]
    s_nop 7
    v_cndmask_b32 v145, 0, v148, s[60:61]
    v_cndmask_b32 v145, v145, v149, s[62:63]
    v_cndmask_b32 v145, v145, v150, s[64:65]
    v_cndmask_b32 v145, v145, v151, s[66:67]
    buffer_store_dwordx2 v[144:145], v60, s[4:7], s34 offen sc1
    s_mov_b64 exec, 1
    ds_add_u32 v13, v12 offset:24
    s_mov_b64 exec, -1
    s_lshl2_add_u32 s34, s23, s21
    s_mul_i32 s35, s34, 256
    s_add_u32 s35, s35, 8200
    s_mov_b32 s0, 0
    s_atomic_add s0, s[44:45], s35 glc
    s_mul_i32 s24, s23, 1504256
    s_mul_i32 s31, s21, 218112
    s_add_u32 s24, s24, s31
    s_add_u32 s24, s24, 8912896
    v_add_u32 v42, 73728, v42
    s_mul_i32 s96, s27, 18432
    s_add_u32 s96, s96, 5767168
    v_and_b32 v16, 1, v1
    v_lshlrev_b32 v16, 4, v16
    v_lshlrev_b32 v16, v16, s29
    s_or_b64 vcc, s[60:61], s[62:63]
    v_cndmask_b32 v44, 0, v16, vcc
    s_or_b64 vcc, s[64:65], s[66:67]
    v_cndmask_b32 v45, 0, v16, vcc
    s_lshl_b32 s34, s21, 6
    v_lshl_add_u32 v46, v1, 2, v13
    v_add_u32 v46, s34, v46
    s_waitcnt vmcnt(0)
    s_mov_b32 s3, 1
    s_atomic_add s3, s[44:45], s73 glc
    s_waitcnt lgkmcnt(0)
    s_cmp_ge_u32 s3, 23
    s_cbranch_scc1 L_pdone_22
    s_mov_b32 s26, 0
L_poll_21:
    s_mov_b32 s3, 0
    s_atomic_add s3, s[44:45], s73 glc
    s_waitcnt lgkmcnt(0)
    s_cmp_ge_u32 s3, 24
    s_cbranch_scc1 L_pdone_22
    s_add_u32 s26, s26, 1
    s_cmp_lt_u32 s26, 40000
    s_cbranch_scc1 L_poll_21
L_pdone_22:
    buffer_load_dwordx2 v[24:25], v61, s[4:7], s33 offen offset:0 sc1
    buffer_load_dwordx2 v[26:27], v61, s[4:7], s33 offen offset:128 sc1
    buffer_load_dwordx4 v[176:179], v3, s[4:7], s96 offen offset:0 sc1
    buffer_load_dwordx4 v[180:183], v3, s[4:7], s96 offen offset:1024 sc1
    buffer_load_dwordx4 v[184:187], v3, s[4:7], s96 offen offset:2048 sc1
    buffer_load_dwordx4 v[188:191], v3, s[4:7], s96 offen offset:3072 sc1
    s_add_u32 s96, s96, 4096
    buffer_load_dwordx4 v[192:195], v3, s[4:7], s96 offen offset:0 sc1
    buffer_load_dwordx4 v[196:199], v3, s[4:7], s96 offen offset:1024 sc1
    buffer_load_dwordx4 v[200:203], v3, s[4:7], s96 offen offset:2048 sc1
    buffer_load_dwordx4 v[204:207], v3, s[4:7], s96 offen offset:3072 sc1
    s_waitcnt lgkmcnt(0)
    s_cmp_ge_u32 s0, 32
    s_cbranch_scc1 L_chkok_23
    s_mov_b32 s26, 0
L_poll_24:
    s_mov_b32 s3, 0
    s_atomic_add s3, s[44:45], s35 glc
    s_waitcnt lgkmcnt(0)
    s_cmp_ge_u32 s3, 32
    s_cbranch_scc1 L_pdone_25
    s_sleep 8
    s_add_u32 s26, s26, 1
    s_cmp_lt_u32 s26, 40000
    s_cbranch_scc1 L_poll_24
L_pdone_25:
L_chkok_23:
    s_mov_b32 s26, 0
L_lw_26:
    ds_read_b32 v14, v13 offset:4
    s_waitcnt lgkmcnt(0)
    v_readfirstlane_b32 s3, v14
    s_nop 0
    s_cmp_ge_u32 s3, 4
    s_cbranch_scc1 L_lwdone_27
    s_add_u32 s26, s26, 1
    s_cmp_lt_u32 s26, 1000000
    s_cbranch_scc1 L_lw_26
L_lwdone_27:
    s_waitcnt vmcnt(8)
    v_add_f32 v24, v24, v26
    v_add_f32 v25, v25, v27
    s_nop 1
    v_permlane16_swap_b32 v24, v25
    v_add_f32 v24, v24, v25
    v_mov_b32 v25, v24
    s_nop 1
    v_permlane32_swap_b32 v24, v25
    v_add_f32 v24, v24, v25
    v_mov_b32 v25, v24
    s_nop 1
    v_permlane16_swap_b32 v24, v25
    v_mul_f32 v48, 0xbae38e39, v24
    v_mul_f32 v49, 0xbae38e39, v24
    v_mul_f32 v50, 0xbae38e39, v24
    v_mul_f32 v51, 0xbae38e39, v24
    s_waitcnt vmcnt(7)
    s_nop 0
    v_mfma_f32_16x16x16_bf16 v[64:67], v[44:45], v[176:177], v[48:51]
    v_mfma_f32_16x16x16_bf16 v[68:71], v[44:45], v[178:179], v[48:51]
    v_mul_f32 v25, 0x3ae38e39, v25
    v_fma_f32 v25, -v48, v48, v25
    v_max_f32 v25, 0, v25
    v_add_f32 v25, 0x3727c5ac, v25
    v_rsq_f32 v26, v25
    s_nop 0
    v_mul_f32 v25, v25, v26
    v_mul_f32 v27, v26, v26
    v_mul_f32 v26, 0xc0135761, v26
    v_mul_f32 v27, 0x3d372713, v27
    v_mul_f32 v27, v27, v26
    ds_write_b32 v46, v26 offset:256
    ds_write_b32 v46, v27 offset:512
    ds_write_b32 v46, v25 offset:768
    s_add_u32 s96, s96, 4096
    buffer_load_dwordx4 v[208:211], v3, s[4:7], s96 offen offset:0 sc1
    buffer_load_dwordx4 v[212:215], v3, s[4:7], s96 offen offset:1024 sc1
    s_waitcnt vmcnt(8)
    v_mfma_f32_16x16x16_bf16 v[72:75], v[44:45], v[180:181], v[48:51]
    v_mfma_f32_16x16x16_bf16 v[76:79], v[44:45], v[182:183], v[48:51]
    buffer_load_dwordx4 v[216:219], v3, s[4:7], s96 offen offset:2048 sc1
    buffer_load_dwordx4 v[220:223], v3, s[4:7], s96 offen offset:3072 sc1
    v_cvt_pk_bf16_f32 v176, v64, v65
    v_cvt_pk_bf16_f32 v177, v66, v67
    v_cvt_pk_bf16_f32 v178, v68, v69
    v_cvt_pk_bf16_f32 v179, v70, v71
    ds_write_b128 v42, v[176:179] offset:0
    s_waitcnt vmcnt(9)
    v_mfma_f32_16x16x16_bf16 v[64:67], v[44:45], v[184:185], v[48:51]
    v_mfma_f32_16x16x16_bf16 v[68:71], v[44:45], v[186:187], v[48:51]
    s_add_u32 s96, s96, 4096
    buffer_load_dwordx4 v[224:227], v3, s[4:7], s96 offen offset:0 sc1
    buffer_load_dwordx4 v[228:231], v3, s[4:7], s96 offen offset:1024 sc1
    v_cvt_pk_bf16_f32 v180, v72, v73
    v_cvt_pk_bf16_f32 v181, v74, v75
    v_cvt_pk_bf16_f32 v182, v76, v77
    v_cvt_pk_bf16_f32 v183, v78, v79
    ds_write_b128 v42, v[180:183] offset:1024
    s_waitcnt vmcnt(10)
    v_mfma_f32_16x16x16_bf16 v[72:75], v[44:45], v[188:189], v[48:51]
    v_mfma_f32_16x16x16_bf16 v[76:79], v[44:45], v[190:191], v[48:51]
    buffer_load_dwordx4 v[232:235], v3, s[4:7], s96 offen offset:2048 sc1
    buffer_load_dwordx4 v[236:239], v3, s[4:7], s96 offen offset:3072 sc1
    v_cvt_pk_bf16_f32 v184, v64, v65
    v_cvt_pk_bf16_f32 v185, v66, v67
    v_cvt_pk_bf16_f32 v186, v68, v69
    v_cvt_pk_bf16_f32 v187, v70, v71
    ds_write_b128 v42, v[184:187] offset:2048
    s_waitcnt vmcnt(11)
    v_mfma_f32_16x16x16_bf16 v[64:67], v[44:45], v[192:193], v[48:51]
    v_mfma_f32_16x16x16_bf16 v[68:71], v[44:45], v[194:195], v[48:51]
    s_add_u32 s96, s96, 4096
    buffer_load_dwordx2 v[240:241], v59, s[4:7], s96 offen offset:0 sc1
    buffer_load_dwordx2 v[242:243], v59, s[4:7], s96 offen offset:512 sc1
    buffer_load_dwordx2 v[244:245], v59, s[4:7], s96 offen offset:1024 sc1
    buffer_load_dwordx2 v[246:247], v59, s[4:7], s96 offen offset:1536 sc1
    s_mov_b64 exec, 1
    ds_add_u32 v13, v12 offset:100
    s_mov_b64 exec, -1
    v_cvt_pk_bf16_f32 v188, v72, v73
    v_cvt_pk_bf16_f32 v189, v74, v75
    v_cvt_pk_bf16_f32 v190, v76, v77
    v_cvt_pk_bf16_f32 v191, v78, v79
    ds_write_b128 v42, v[188:191] offset:3072
    s_waitcnt vmcnt(14)
    v_mfma_f32_16x16x16_bf16 v[72:75], v[44:45], v[196:197], v[48:51]
    v_mfma_f32_16x16x16_bf16 v[76:79], v[44:45], v[198:199], v[48:51]
    buffer_load_dwordx4 v[96:99], v3, s[4:7], s24 offen offset:0 sc1
    buffer_load_dwordx4 v[100:103], v3, s[4:7], s24 offen offset:1024 sc1
    v_cvt_pk_bf16_f32 v192, v64, v65
    v_cvt_pk_bf16_f32 v193, v66, v67
    v_cvt_pk_bf16_f32 v194, v68, v69
    v_cvt_pk_bf16_f32 v195, v70, v71
    ds_write_b128 v42, v[192:195] offset:4096
    s_waitcnt vmcnt(15)
    v_mfma_f32_16x16x16_bf16 v[64:67], v[44:45], v[200:201], v[48:51]
    v_mfma_f32_16x16x16_bf16 v[68:71], v[44:45], v[202:203], v[48:51]
    buffer_load_dwordx4 v[104:107], v3, s[4:7], s24 offen offset:2048 sc1
    buffer_load_dwordx4 v[108:111], v3, s[4:7], s24 offen offset:3072 sc1
    v_cvt_pk_bf16_f32 v196, v72, v73
    v_cvt_pk_bf16_f32 v197, v74, v75
    v_cvt_pk_bf16_f32 v198, v76, v77
    v_cvt_pk_bf16_f32 v199, v78, v79
    ds_write_b128 v42, v[196:199] offset:5120
    s_waitcnt vmcnt(16)
    v_mfma_f32_16x16x16_bf16 v[72:75], v[44:45], v[204:205], v[48:51]
    v_mfma_f32_16x16x16_bf16 v[76:79], v[44:45], v[206:207], v[48:51]
    s_add_u32 s24, s24, 4096
    buffer_load_dwordx4 v[112:115], v3, s[4:7], s24 offen offset:0 sc1
    buffer_load_dwordx4 v[116:119], v3, s[4:7], s24 offen offset:1024 sc1
    v_cvt_pk_bf16_f32 v200, v64, v65
    v_cvt_pk_bf16_f32 v201, v66, v67
    v_cvt_pk_bf16_f32 v202, v68, v69
    v_cvt_pk_bf16_f32 v203, v70, v71
    ds_write_b128 v42, v[200:203] offset:6144
    s_waitcnt vmcnt(17)
    v_mfma_f32_16x16x16_bf16 v[64:67], v[44:45], v[208:209], v[48:51]
    v_mfma_f32_16x16x16_bf16 v[68:71], v[44:45], v[210:211], v[48:51]
    buffer_load_dwordx4 v[120:123], v3, s[4:7], s24 offen offset:2048 sc1
    buffer_load_dwordx4 v[124:127], v3, s[4:7], s24 offen offset:3072 sc1
    v_cvt_pk_bf16_f32 v204, v72, v73
    v_cvt_pk_bf16_f32 v205, v74, v75
    v_cvt_pk_bf16_f32 v206, v76, v77
    v_cvt_pk_bf16_f32 v207, v78, v79
    ds_write_b128 v42, v[204:207] offset:7168
    s_waitcnt vmcnt(18)
    v_mfma_f32_16x16x16_bf16 v[72:75], v[44:45], v[212:213], v[48:51]
    v_mfma_f32_16x16x16_bf16 v[76:79], v[44:45], v[214:215], v[48:51]
    s_add_u32 s24, s24, 4096
    buffer_load_dwordx4 v[128:131], v3, s[4:7], s24 offen offset:0 sc1
    buffer_load_dwordx4 v[132:135], v3, s[4:7], s24 offen offset:1024 sc1
    v_cvt_pk_bf16_f32 v208, v64, v65
    v_cvt_pk_bf16_f32 v209, v66, v67
    v_cvt_pk_bf16_f32 v210, v68, v69
    v_cvt_pk_bf16_f32 v211, v70, v71
    ds_write_b128 v42, v[208:211] offset:8192
    s_waitcnt vmcnt(19)
    v_mfma_f32_16x16x16_bf16 v[64:67], v[44:45], v[216:217], v[48:51]
    v_mfma_f32_16x16x16_bf16 v[68:71], v[44:45], v[218:219], v[48:51]
    buffer_load_dwordx4 v[136:139], v3, s[4:7], s24 offen offset:2048 sc1
    buffer_load_dwordx4 v[140:143], v3, s[4:7], s24 offen offset:3072 sc1
    v_cvt_pk_bf16_f32 v212, v72, v73
    v_cvt_pk_bf16_f32 v213, v74, v75
    v_cvt_pk_bf16_f32 v214, v76, v77
    v_cvt_pk_bf16_f32 v215, v78, v79
    ds_write_b128 v42, v[212:215] offset:9216
    s_waitcnt vmcnt(20)
    v_mfma_f32_16x16x16_bf16 v[72:75], v[44:45], v[220:221], v[48:51]
    v_mfma_f32_16x16x16_bf16 v[76:79], v[44:45], v[222:223], v[48:51]
    s_add_u32 s24, s24, 4096
    buffer_load_dwordx4 v[144:147], v3, s[4:7], s24 offen offset:0 sc1
    buffer_load_dwordx4 v[148:151], v3, s[4:7], s24 offen offset:1024 sc1
    v_cvt_pk_bf16_f32 v216, v64, v65
    v_cvt_pk_bf16_f32 v217, v66, v67
    v_cvt_pk_bf16_f32 v218, v68, v69
    v_cvt_pk_bf16_f32 v219, v70, v71
    ds_write_b128 v42, v[216:219] offset:10240
    s_waitcnt vmcnt(21)
    v_mfma_f32_16x16x16_bf16 v[64:67], v[44:45], v[224:225], v[48:51]
    v_mfma_f32_16x16x16_bf16 v[68:71], v[44:45], v[226:227], v[48:51]
    buffer_load_dwordx4 v[152:155], v3, s[4:7], s24 offen offset:2048 sc1
    buffer_load_dwordx4 v[156:159], v3, s[4:7], s24 offen offset:3072 sc1
    s_mov_b64 exec, 1
    ds_add_u32 v13, v12 offset:104
    s_mov_b64 exec, -1
    v_cvt_pk_bf16_f32 v220, v72, v73
    v_cvt_pk_bf16_f32 v221, v74, v75
    v_cvt_pk_bf16_f32 v222, v76, v77
    v_cvt_pk_bf16_f32 v223, v78, v79
    ds_write_b128 v42, v[220:223] offset:11264
    s_waitcnt vmcnt(22)
    v_mfma_f32_16x16x16_bf16 v[72:75], v[44:45], v[228:229], v[48:51]
    v_mfma_f32_16x16x16_bf16 v[76:79], v[44:45], v[230:231], v[48:51]
    v_cvt_pk_bf16_f32 v224, v64, v65
    v_cvt_pk_bf16_f32 v225, v66, v67
    v_cvt_pk_bf16_f32 v226, v68, v69
    v_cvt_pk_bf16_f32 v227, v70, v71
    ds_write_b128 v42, v[224:227] offset:12288
    s_waitcnt vmcnt(21)
    v_mfma_f32_16x16x16_bf16 v[64:67], v[44:45], v[232:233], v[48:51]
    v_mfma_f32_16x16x16_bf16 v[68:71], v[44:45], v[234:235], v[48:51]
    v_cvt_pk_bf16_f32 v228, v72, v73
    v_cvt_pk_bf16_f32 v229, v74, v75
    v_cvt_pk_bf16_f32 v230, v76, v77
    v_cvt_pk_bf16_f32 v231, v78, v79
    ds_write_b128 v42, v[228:231] offset:13312
    s_waitcnt vmcnt(20)
    v_mfma_f32_16x16x16_bf16 v[72:75], v[44:45], v[236:237], v[48:51]
    v_mfma_f32_16x16x16_bf16 v[76:79], v[44:45], v[238:239], v[48:51]
    v_cvt_pk_bf16_f32 v232, v64, v65
    v_cvt_pk_bf16_f32 v233, v66, v67
    v_cvt_pk_bf16_f32 v234, v68, v69
    v_cvt_pk_bf16_f32 v235, v70, v71
    ds_write_b128 v42, v[232:235] offset:14336
    s_waitcnt vmcnt(18)
    v_mfma_f32_16x16x16_bf16 v[64:67], v[44:45], v[240:241], v[48:51]
    v_mfma_f32_16x16x16_bf16 v[68:71], v[44:45], v[242:243], v[48:51]
    v_cvt_pk_bf16_f32 v236, v72, v73
    v_cvt_pk_bf16_f32 v237, v74, v75
    v_cvt_pk_bf16_f32 v238, v76, v77
    v_cvt_pk_bf16_f32 v239, v78, v79
    ds_write_b128 v42, v[236:239] offset:15360
    s_waitcnt vmcnt(16)
    v_mfma_f32_16x16x16_bf16 v[72:75], v[44:45], v[244:245], v[48:51]
    v_mfma_f32_16x16x16_bf16 v[76:79], v[44:45], v[246:247], v[48:51]
    v_cvt_pk_bf16_f32 v240, v64, v65
    v_cvt_pk_bf16_f32 v241, v66, v67
    v_cvt_pk_bf16_f32 v242, v68, v69
    v_cvt_pk_bf16_f32 v243, v70, v71
    ds_write_b128 v42, v[240:243] offset:16384
    s_nop 1
    v_cvt_pk_bf16_f32 v244, v72, v73
    v_cvt_pk_bf16_f32 v245, v74, v75
    v_cvt_pk_bf16_f32 v246, v76, v77
    v_cvt_pk_bf16_f32 v247, v78, v79
    ds_write_b128 v42, v[244:247] offset:17408
    s_mov_b64 exec, 1
    ds_add_u32 v13, v12 offset:8
    s_mov_b64 exec, -1
    s_mov_b32 s26, 0
L_lw_28:
    ds_read_b32 v14, v13 offset:8
    s_waitcnt lgkmcnt(0)
    v_readfirstlane_b32 s3, v14
    s_nop 0
    s_cmp_ge_u32 s3, 4
    s_cbranch_scc1 L_lwdone_29
    s_add_u32 s26, s26, 1
    s_cmp_lt_u32 s26, 1000000
    s_cbranch_scc1 L_lw_28
L_lwdone_29:
    ds_read_b128 v[64:67], v4 offset:8192
    ds_read_b128 v[68:71], v4 offset:26624
    ds_read_b128 v[72:75], v4 offset:45056
    ds_read_b128 v[76:79], v4 offset:63488
    v_lshl_add_u32 v16, v1, 2, v13
    ds_read_b32 v160, v16 offset:256
    ds_read_b32 v161, v16 offset:320
    ds_read_b32 v162, v16 offset:384
    ds_read_b32 v163, v16 offset:448
    ds_read_b32 v164, v16 offset:512
    ds_read_b32 v165, v16 offset:576
    ds_read_b32 v166, v16 offset:640
    ds_read_b32 v167, v16 offset:704
    ds_read_b32 v168, v16 offset:768
    ds_read_b32 v169, v16 offset:832
    ds_read_b32 v170, v16 offset:896
    ds_read_b32 v171, v16 offset:960
    s_setprio 1
    s_waitcnt vmcnt(14) lgkmcnt(12)
    v_mfma_f32_16x16x32_bf16 v[176:179], v[96:99], v[64:67], 0
    ds_read_b128 v[80:83], v4 offset:9216
    v_mfma_f32_16x16x32_bf16 v[180:183], v[96:99], v[68:71], 0
    ds_read_b128 v[84:87], v4 offset:27648
    v_mfma_f32_16x16x32_bf16 v[184:187], v[96:99], v[72:75], 0
    s_add_u32 s24, s24, 4096
    v_mfma_f32_16x16x32_bf16 v[188:191], v[96:99], v[76:79], 0
    v_mfma_f32_16x16x32_bf16 v[204:207], v[100:103], v[76:79], 0
    buffer_load_dwordx4 v[96:99], v3, s[4:7], s24 offen offset:0 sc1
    v_mfma_f32_16x16x32_bf16 v[200:203], v[100:103], v[72:75], 0
    ds_read_b128 v[88:91], v4 offset:46080
    v_mfma_f32_16x16x32_bf16 v[196:199], v[100:103], v[68:71], 0
    ds_read_b128 v[92:95], v4 offset:64512
    v_mfma_f32_16x16x32_bf16 v[192:195], v[100:103], v[64:67], 0
    s_waitcnt vmcnt(13)
    v_mfma_f32_16x16x32_bf16 v[208:211], v[104:107], v[64:67], 0
    buffer_load_dwordx4 v[100:103], v3, s[4:7], s24 offen offset:1024 sc1
    v_mfma_f32_16x16x32_bf16 v[212:215], v[104:107], v[68:71], 0
    v_mfma_f32_16x16x32_bf16 v[216:219], v[104:107], v[72:75], 0
    v_mfma_f32_16x16x32_bf16 v[220:223], v[104:107], v[76:79], 0
    v_mfma_f32_16x16x32_bf16 v[236:239], v[108:111], v[76:79], 0
    buffer_load_dwordx4 v[104:107], v3, s[4:7], s24 offen offset:2048 sc1
    v_mfma_f32_16x16x32_bf16 v[232:235], v[108:111], v[72:75], 0
    v_mfma_f32_16x16x32_bf16 v[228:231], v[108:111], v[68:71], 0
    v_mfma_f32_16x16x32_bf16 v[224:227], v[108:111], v[64:67], 0
    s_waitcnt vmcnt(13)
    v_mfma_f32_16x16x32_bf16 v[240:243], v[112:115], v[64:67], 0
    buffer_load_dwordx4 v[108:111], v3, s[4:7], s24 offen offset:3072 sc1
    v_mfma_f32_16x16x32_bf16 v[244:247], v[112:115], v[68:71], 0
    v_mfma_f32_16x16x32_bf16 v[248:251], v[112:115], v[72:75], 0
    s_add_u32 s24, s24, 4096
    v_mfma_f32_16x16x32_bf16 v[252:255], v[112:115], v[76:79], 0
    s_waitcnt vmcnt(13) lgkmcnt(0)
    v_mfma_f32_16x16x32_bf16 v[176:179], v[116:119], v[80:83], v[176:179]
    buffer_load_dwordx4 v[112:115], v3, s[4:7], s24 offen offset:0 sc1
    v_mfma_f32_16x16x32_bf16 v[180:183], v[116:119], v[84:87], v[180:183]
    ds_read_b128 v[64:67], v4 offset:10240
    v_mfma_f32_16x16x32_bf16 v[184:187], v[116:119], v[88:91], v[184:187]
    ds_read_b128 v[68:71], v4 offset:28672
    v_mfma_f32_16x16x32_bf16 v[188:191], v[116:119], v[92:95], v[188:191]
    v_mfma_f32_16x16x32_bf16 v[204:207], v[120:123], v[92:95], v[204:207]
    buffer_load_dwordx4 v[116:119], v3, s[4:7], s24 offen offset:1024 sc1
    v_mfma_f32_16x16x32_bf16 v[200:203], v[120:123], v[88:91], v[200:203]
    ds_read_b128 v[72:75], v4 offset:47104
    v_mfma_f32_16x16x32_bf16 v[196:199], v[120:123], v[84:87], v[196:199]
    ds_read_b128 v[76:79], v5 offset:0
    v_mfma_f32_16x16x32_bf16 v[192:195], v[120:123], v[80:83], v[192:195]
    s_waitcnt vmcnt(13)
    v_mfma_f32_16x16x32_bf16 v[208:211], v[124:127], v[80:83], v[208:211]
    buffer_load_dwordx4 v[120:123], v3, s[4:7], s24 offen offset:2048 sc1
    v_mfma_f32_16x16x32_bf16 v[212:215], v[124:127], v[84:87], v[212:215]
    v_mfma_f32_16x16x32_bf16 v[216:219], v[124:127], v[88:91], v[216:219]
    v_mfma_f32_16x16x32_bf16 v[220:223], v[124:127], v[92:95], v[220:223]
    v_mfma_f32_16x16x32_bf16 v[236:239], v[128:131], v[92:95], v[236:239]
    buffer_load_dwordx4 v[124:127], v3, s[4:7], s24 offen offset:3072 sc1
    v_mfma_f32_16x16x32_bf16 v[232:235], v[128:131], v[88:91], v[232:235]
    v_mfma_f32_16x16x32_bf16 v[228:231], v[128:131], v[84:87], v[228:231]
    s_add_u32 s24, s24, 4096
    v_mfma_f32_16x16x32_bf16 v[224:227], v[128:131], v[80:83], v[224:227]
    s_waitcnt vmcnt(13)
    v_mfma_f32_16x16x32_bf16 v[240:243], v[132:135], v[80:83], v[240:243]
    buffer_load_dwordx4 v[128:131], v3, s[4:7], s24 offen offset:0 sc1
    v_mfma_f32_16x16x32_bf16 v[244:247], v[132:135], v[84:87], v[244:247]
    v_mfma_f32_16x16x32_bf16 v[248:251], v[132:135], v[88:91], v[248:251]
    v_mfma_f32_16x16x32_bf16 v[252:255], v[132:135], v[92:95], v[252:255]
    s_waitcnt vmcnt(13) lgkmcnt(0)
    v_mfma_f32_16x16x32_bf16 v[176:179], v[136:139], v[64:67], v[176:179]
    buffer_load_dwordx4 v[132:135], v3, s[4:7], s24 offen offset:1024 sc1
    v_mfma_f32_16x16x32_bf16 v[180:183], v[136:139], v[68:71], v[180:183]
    ds_read_b128 v[80:83], v4 offset:11264
    v_mfma_f32_16x16x32_bf16 v[184:187], v[136:139], v[72:75], v[184:187]
    ds_read_b128 v[84:87], v4 offset:29696
    v_mfma_f32_16x16x32_bf16 v[188:191], v[136:139], v[76:79], v[188:191]
    v_mfma_f32_16x16x32_bf16 v[204:207], v[140:143], v[76:79], v[204:207]
    buffer_load_dwordx4 v[136:139], v3, s[4:7], s24 offen offset:2048 sc1
    v_mfma_f32_16x16x32_bf16 v[200:203], v[140:143], v[72:75], v[200:203]
    ds_read_b128 v[88:91], v4 offset:48128
    v_mfma_f32_16x16x32_bf16 v[196:199], v[140:143], v[68:71], v[196:199]
    ds_read_b128 v[92:95], v5 offset:1024
    v_mfma_f32_16x16x32_bf16 v[192:195], v[140:143], v[64:67], v[192:195]
    s_waitcnt vmcnt(13)
    v_mfma_f32_16x16x32_bf16 v[208:211], v[144:147], v[64:67], v[208:211]
    buffer_load_dwordx4 v[140:143], v3, s[4:7], s24 offen offset:3072 sc1
    v_mfma_f32_16x16x32_bf16 v[212:215], v[144:147], v[68:71], v[212:215]
    v_mfma_f32_16x16x32_bf16 v[216:219], v[144:147], v[72:75], v[216:219]
    s_add_u32 s24, s24, 4096
    v_mfma_f32_16x16x32_bf16 v[220:223], v[144:147], v[76:79], v[220:223]
    v_mfma_f32_16x16x32_bf16 v[236:239], v[148:151], v[76:79], v[236:239]
    buffer_load_dwordx4 v[144:147], v3, s[4:7], s24 offen offset:0 sc1
    v_mfma_f32_16x16x32_bf16 v[232:235], v[148:151], v[72:75], v[232:235]
    v_mfma_f32_16x16x32_bf16 v[228:231], v[148:151], v[68:71], v[228:231]
    v_mfma_f32_16x16x32_bf16 v[224:227], v[148:151], v[64:67], v[224:227]
    s_waitcnt vmcnt(13)
    v_mfma_f32_16x16x32_bf16 v[240:243], v[152:155], v[64:67], v[240:243]
    buffer_load_dwordx4 v[148:151], v3, s[4:7], s24 offen offset:1024 sc1
    v_mfma_f32_16x16x32_bf16 v[244:247], v[152:155], v[68:71], v[244:247]
    v_mfma_f32_16x16x32_bf16 v[248:251], v[152:155], v[72:75], v[248:251]
    v_mfma_f32_16x16x32_bf16 v[252:255], v[152:155], v[76:79], v[252:255]
    s_waitcnt vmcnt(13) lgkmcnt(0)
    v_mfma_f32_16x16x32_bf16 v[176:179], v[156:159], v[80:83], v[176:179]
    buffer_load_dwordx4 v[152:155], v3, s[4:7], s24 offen offset:2048 sc1
    v_mfma_f32_16x16x32_bf16 v[180:183], v[156:159], v[84:87], v[180:183]
    ds_read_b128 v[64:67], v4 offset:12288
    v_mfma_f32_16x16x32_bf16 v[184:187], v[156:159], v[88:91], v[184:187]
    ds_read_b128 v[68:71], v4 offset:30720
    v_mfma_f32_16x16x32_bf16 v[188:191], v[156:159], v[92:95], v[188:191]
    v_mfma_f32_16x16x32_bf16 v[204:207], v[96:99], v[92:95], v[204:207]
    buffer_load_dwordx4 v[156:159], v3, s[4:7], s24 offen offset:3072 sc1
    v_mfma_f32_16x16x32_bf16 v[200:203], v[96:99], v[88:91], v[200:203]
    ds_read_b128 v[72:75], v4 offset:49152
    v_mfma_f32_16x16x32_bf16 v[196:199], v[96:99], v[84:87], v[196:199]
    s_add_u32 s24, s24, 4096
    v_mfma_f32_16x16x32_bf16 v[192:195], v[96:99], v[80:83], v[192:195]
    s_waitcnt vmcnt(13)
    v_mfma_f32_16x16x32_bf16 v[208:211], v[100:103], v[80:83], v[208:211]
    buffer_load_dwordx4 v[96:99], v3, s[4:7], s24 offen offset:0 sc1
    v_mfma_f32_16x16x32_bf16 v[212:215], v[100:103], v[84:87], v[212:215]
    ds_read_b128 v[76:79], v5 offset:2048
    v_mfma_f32_16x16x32_bf16 v[216:219], v[100:103], v[88:91], v[216:219]
    v_mfma_f32_16x16x32_bf16 v[220:223], v[100:103], v[92:95], v[220:223]
    v_mfma_f32_16x16x32_bf16 v[236:239], v[104:107], v[92:95], v[236:239]
    buffer_load_dwordx4 v[100:103], v3, s[4:7], s24 offen offset:1024 sc1
    v_mfma_f32_16x16x32_bf16 v[232:235], v[104:107], v[88:91], v[232:235]
    v_mfma_f32_16x16x32_bf16 v[228:231], v[104:107], v[84:87], v[228:231]
    v_mfma_f32_16x16x32_bf16 v[224:227], v[104:107], v[80:83], v[224:227]
    s_waitcnt vmcnt(13)
    v_mfma_f32_16x16x32_bf16 v[240:243], v[108:111], v[80:83], v[240:243]
    buffer_load_dwordx4 v[104:107], v3, s[4:7], s24 offen offset:2048 sc1
    v_mfma_f32_16x16x32_bf16 v[244:247], v[108:111], v[84:87], v[244:247]
    v_mfma_f32_16x16x32_bf16 v[248:251], v[108:111], v[88:91], v[248:251]
    v_mfma_f32_16x16x32_bf16 v[252:255], v[108:111], v[92:95], v[252:255]
    s_waitcnt vmcnt(13) lgkmcnt(0)
    v_mfma_f32_16x16x32_bf16 v[176:179], v[112:115], v[64:67], v[176:179]
    buffer_load_dwordx4 v[108:111], v3, s[4:7], s24 offen offset:3072 sc1
    v_mfma_f32_16x16x32_bf16 v[180:183], v[112:115], v[68:71], v[180:183]
    ds_read_b128 v[80:83], v4 offset:13312
    v_mfma_f32_16x16x32_bf16 v[184:187], v[112:115], v[72:75], v[184:187]
    s_add_u32 s24, s24, 4096
    v_mfma_f32_16x16x32_bf16 v[188:191], v[112:115], v[76:79], v[188:191]
    v_mfma_f32_16x16x32_bf16 v[204:207], v[116:119], v[76:79], v[204:207]
    buffer_load_dwordx4 v[112:115], v3, s[4:7], s24 offen offset:0 sc1
    v_mfma_f32_16x16x32_bf16 v[200:203], v[116:119], v[72:75], v[200:203]
    ds_read_b128 v[84:87], v4 offset:31744
    v_mfma_f32_16x16x32_bf16 v[196:199], v[116:119], v[68:71], v[196:199]
    ds_read_b128 v[88:91], v4 offset:50176
    v_mfma_f32_16x16x32_bf16 v[192:195], v[116:119], v[64:67], v[192:195]
    s_waitcnt vmcnt(13)
    v_mfma_f32_16x16x32_bf16 v[208:211], v[120:123], v[64:67], v[208:211]
    buffer_load_dwordx4 v[116:119], v3, s[4:7], s24 offen offset:1024 sc1
    v_mfma_f32_16x16x32_bf16 v[212:215], v[120:123], v[68:71], v[212:215]
    ds_read_b128 v[92:95], v5 offset:3072
    v_mfma_f32_16x16x32_bf16 v[216:219], v[120:123], v[72:75], v[216:219]
    v_mfma_f32_16x16x32_bf16 v[220:223], v[120:123], v[76:79], v[220:223]
    v_mfma_f32_16x16x32_bf16 v[236:239], v[124:127], v[76:79], v[236:239]
    buffer_load_dwordx4 v[120:123], v3, s[4:7], s24 offen offset:2048 sc1
    v_mfma_f32_16x16x32_bf16 v[232:235], v[124:127], v[72:75], v[232:235]
    v_mfma_f32_16x16x32_bf16 v[228:231], v[124:127], v[68:71], v[228:231]
    v_mfma_f32_16x16x32_bf16 v[224:227], v[124:127], v[64:67], v[224:227]
    s_waitcnt vmcnt(13)
    v_mfma_f32_16x16x32_bf16 v[240:243], v[128:131], v[64:67], v[240:243]
    buffer_load_dwordx4 v[124:127], v3, s[4:7], s24 offen offset:3072 sc1
    v_mfma_f32_16x16x32_bf16 v[244:247], v[128:131], v[68:71], v[244:247]
    v_mfma_f32_16x16x32_bf16 v[248:251], v[128:131], v[72:75], v[248:251]
    s_add_u32 s24, s24, 4096
    v_mfma_f32_16x16x32_bf16 v[252:255], v[128:131], v[76:79], v[252:255]
    s_waitcnt vmcnt(13) lgkmcnt(0)
    v_mfma_f32_16x16x32_bf16 v[176:179], v[132:135], v[80:83], v[176:179]
    buffer_load_dwordx4 v[128:131], v3, s[4:7], s24 offen offset:0 sc1
    v_mfma_f32_16x16x32_bf16 v[180:183], v[132:135], v[84:87], v[180:183]
    ds_read_b128 v[64:67], v4 offset:14336
    v_mfma_f32_16x16x32_bf16 v[184:187], v[132:135], v[88:91], v[184:187]
    ds_read_b128 v[68:71], v4 offset:32768
    v_mfma_f32_16x16x32_bf16 v[188:191], v[132:135], v[92:95], v[188:191]
    v_mfma_f32_16x16x32_bf16 v[204:207], v[136:139], v[92:95], v[204:207]
    buffer_load_dwordx4 v[132:135], v3, s[4:7], s24 offen offset:1024 sc1
    v_mfma_f32_16x16x32_bf16 v[200:203], v[136:139], v[88:91], v[200:203]
    ds_read_b128 v[72:75], v4 offset:51200
    v_mfma_f32_16x16x32_bf16 v[196:199], v[136:139], v[84:87], v[196:199]
    ds_read_b128 v[76:79], v5 offset:4096
    v_mfma_f32_16x16x32_bf16 v[192:195], v[136:139], v[80:83], v[192:195]
    s_waitcnt vmcnt(13)
    v_mfma_f32_16x16x32_bf16 v[208:211], v[140:143], v[80:83], v[208:211]
    buffer_load_dwordx4 v[136:139], v3, s[4:7], s24 offen offset:2048 sc1
    v_mfma_f32_16x16x32_bf16 v[212:215], v[140:143], v[84:87], v[212:215]
    v_mfma_f32_16x16x32_bf16 v[216:219], v[140:143], v[88:91], v[216:219]
    v_mfma_f32_16x16x32_bf16 v[220:223], v[140:143], v[92:95], v[220:223]
    v_mfma_f32_16x16x32_bf16 v[236:239], v[144:147], v[92:95], v[236:239]
    buffer_load_dwordx4 v[140:143], v3, s[4:7], s24 offen offset:3072 sc1
    v_mfma_f32_16x16x32_bf16 v[232:235], v[144:147], v[88:91], v[232:235]
    v_mfma_f32_16x16x32_bf16 v[228:231], v[144:147], v[84:87], v[228:231]
    s_add_u32 s24, s24, 4096
    v_mfma_f32_16x16x32_bf16 v[224:227], v[144:147], v[80:83], v[224:227]
    s_waitcnt vmcnt(13)
    v_mfma_f32_16x16x32_bf16 v[240:243], v[148:151], v[80:83], v[240:243]
    buffer_load_dwordx4 v[144:147], v3, s[4:7], s24 offen offset:0 sc1
    v_mfma_f32_16x16x32_bf16 v[244:247], v[148:151], v[84:87], v[244:247]
    v_mfma_f32_16x16x32_bf16 v[248:251], v[148:151], v[88:91], v[248:251]
    v_mfma_f32_16x16x32_bf16 v[252:255], v[148:151], v[92:95], v[252:255]
    s_waitcnt vmcnt(13) lgkmcnt(0)
    v_mfma_f32_16x16x32_bf16 v[176:179], v[152:155], v[64:67], v[176:179]
    buffer_load_dwordx4 v[148:151], v3, s[4:7], s24 offen offset:1024 sc1
    v_mfma_f32_16x16x32_bf16 v[180:183], v[152:155], v[68:71], v[180:183]
    ds_read_b128 v[80:83], v4 offset:15360
    v_mfma_f32_16x16x32_bf16 v[184:187], v[152:155], v[72:75], v[184:187]
    ds_read_b128 v[84:87], v4 offset:33792
    v_mfma_f32_16x16x32_bf16 v[188:191], v[152:155], v[76:79], v[188:191]
    v_mfma_f32_16x16x32_bf16 v[204:207], v[156:159], v[76:79], v[204:207]
    buffer_load_dwordx4 v[152:155], v3, s[4:7], s24 offen offset:2048 sc1
    v_mfma_f32_16x16x32_bf16 v[200:203], v[156:159], v[72:75], v[200:203]
    ds_read_b128 v[88:91], v4 offset:52224
    v_mfma_f32_16x16x32_bf16 v[196:199], v[156:159], v[68:71], v[196:199]
    ds_read_b128 v[92:95], v5 offset:5120
    v_mfma_f32_16x16x32_bf16 v[192:195], v[156:159], v[64:67], v[192:195]
    s_waitcnt vmcnt(13)
    v_mfma_f32_16x16x32_bf16 v[208:211], v[96:99], v[64:67], v[208:211]
    buffer_load_dwordx4 v[156:159], v3, s[4:7], s24 offen offset:3072 sc1
    v_mfma_f32_16x16x32_bf16 v[212:215], v[96:99], v[68:71], v[212:215]
    v_mfma_f32_16x16x32_bf16 v[216:219], v[96:99], v[72:75], v[216:219]
    s_add_u32 s24, s24, 4096
    v_mfma_f32_16x16x32_bf16 v[220:223], v[96:99], v[76:79], v[220:223]
    v_mfma_f32_16x16x32_bf16 v[236:239], v[100:103], v[76:79], v[236:239]
    buffer_load_dwordx4 v[96:99], v3, s[4:7], s24 offen offset:0 sc1
    v_mfma_f32_16x16x32_bf16 v[232:235], v[100:103], v[72:75], v[232:235]
    v_mfma_f32_16x16x32_bf16 v[228:231], v[100:103], v[68:71], v[228:231]
    v_mfma_f32_16x16x32_bf16 v[224:227], v[100:103], v[64:67], v[224:227]
    s_waitcnt vmcnt(13)
    v_mfma_f32_16x16x32_bf16 v[240:243], v[104:107], v[64:67], v[240:243]
    buffer_load_dwordx4 v[100:103], v3, s[4:7], s24 offen offset:1024 sc1
    v_mfma_f32_16x16x32_bf16 v[244:247], v[104:107], v[68:71], v[244:247]
    v_mfma_f32_16x16x32_bf16 v[248:251], v[104:107], v[72:75], v[248:251]
    v_mfma_f32_16x16x32_bf16 v[252:255], v[104:107], v[76:79], v[252:255]
    s_waitcnt vmcnt(13) lgkmcnt(0)
    v_mfma_f32_16x16x32_bf16 v[176:179], v[108:111], v[80:83], v[176:179]
    buffer_load_dwordx4 v[104:107], v3, s[4:7], s24 offen offset:2048 sc1
    v_mfma_f32_16x16x32_bf16 v[180:183], v[108:111], v[84:87], v[180:183]
    ds_read_b128 v[64:67], v4 offset:16384
    v_mfma_f32_16x16x32_bf16 v[184:187], v[108:111], v[88:91], v[184:187]
    ds_read_b128 v[68:71], v4 offset:34816
    v_mfma_f32_16x16x32_bf16 v[188:191], v[108:111], v[92:95], v[188:191]
    v_mfma_f32_16x16x32_bf16 v[204:207], v[112:115], v[92:95], v[204:207]
    buffer_load_dwordx4 v[108:111], v3, s[4:7], s24 offen offset:3072 sc1
    v_mfma_f32_16x16x32_bf16 v[200:203], v[112:115], v[88:91], v[200:203]
    ds_read_b128 v[72:75], v4 offset:53248
    v_mfma_f32_16x16x32_bf16 v[196:199], v[112:115], v[84:87], v[196:199]
    s_add_u32 s24, s24, 4096
    v_mfma_f32_16x16x32_bf16 v[192:195], v[112:115], v[80:83], v[192:195]
    s_waitcnt vmcnt(13)
    v_mfma_f32_16x16x32_bf16 v[208:211], v[116:119], v[80:83], v[208:211]
    buffer_load_dwordx4 v[112:115], v3, s[4:7], s24 offen offset:0 sc1
    v_mfma_f32_16x16x32_bf16 v[212:215], v[116:119], v[84:87], v[212:215]
    ds_read_b128 v[76:79], v5 offset:6144
    v_mfma_f32_16x16x32_bf16 v[216:219], v[116:119], v[88:91], v[216:219]
    v_mfma_f32_16x16x32_bf16 v[220:223], v[116:119], v[92:95], v[220:223]
    v_mfma_f32_16x16x32_bf16 v[236:239], v[120:123], v[92:95], v[236:239]
    buffer_load_dwordx4 v[116:119], v3, s[4:7], s24 offen offset:1024 sc1
    v_mfma_f32_16x16x32_bf16 v[232:235], v[120:123], v[88:91], v[232:235]
    v_mfma_f32_16x16x32_bf16 v[228:231], v[120:123], v[84:87], v[228:231]
    v_mfma_f32_16x16x32_bf16 v[224:227], v[120:123], v[80:83], v[224:227]
    s_waitcnt vmcnt(13)
    v_mfma_f32_16x16x32_bf16 v[240:243], v[124:127], v[80:83], v[240:243]
    buffer_load_dwordx4 v[120:123], v3, s[4:7], s24 offen offset:2048 sc1
    v_mfma_f32_16x16x32_bf16 v[244:247], v[124:127], v[84:87], v[244:247]
    v_mfma_f32_16x16x32_bf16 v[248:251], v[124:127], v[88:91], v[248:251]
    v_mfma_f32_16x16x32_bf16 v[252:255], v[124:127], v[92:95], v[252:255]
    s_waitcnt vmcnt(13) lgkmcnt(0)
    v_mfma_f32_16x16x32_bf16 v[176:179], v[128:131], v[64:67], v[176:179]
    buffer_load_dwordx4 v[124:127], v3, s[4:7], s24 offen offset:3072 sc1
    v_mfma_f32_16x16x32_bf16 v[180:183], v[128:131], v[68:71], v[180:183]
    ds_read_b128 v[80:83], v4 offset:17408
    v_mfma_f32_16x16x32_bf16 v[184:187], v[128:131], v[72:75], v[184:187]
    s_add_u32 s24, s24, 4096
    v_mfma_f32_16x16x32_bf16 v[188:191], v[128:131], v[76:79], v[188:191]
    v_mfma_f32_16x16x32_bf16 v[204:207], v[132:135], v[76:79], v[204:207]
    buffer_load_dwordx4 v[128:131], v3, s[4:7], s24 offen offset:0 sc1
    v_mfma_f32_16x16x32_bf16 v[200:203], v[132:135], v[72:75], v[200:203]
    ds_read_b128 v[84:87], v4 offset:35840
    v_mfma_f32_16x16x32_bf16 v[196:199], v[132:135], v[68:71], v[196:199]
    ds_read_b128 v[88:91], v4 offset:54272
    v_mfma_f32_16x16x32_bf16 v[192:195], v[132:135], v[64:67], v[192:195]
    s_waitcnt vmcnt(13)
    v_mfma_f32_16x16x32_bf16 v[208:211], v[136:139], v[64:67], v[208:211]
    buffer_load_dwordx4 v[132:135], v3, s[4:7], s24 offen offset:1024 sc1
    v_mfma_f32_16x16x32_bf16 v[212:215], v[136:139], v[68:71], v[212:215]
    ds_read_b128 v[92:95], v5 offset:7168
    v_mfma_f32_16x16x32_bf16 v[216:219], v[136:139], v[72:75], v[216:219]
    v_mfma_f32_16x16x32_bf16 v[220:223], v[136:139], v[76:79], v[220:223]
    v_mfma_f32_16x16x32_bf16 v[236:239], v[140:143], v[76:79], v[236:239]
    buffer_load_dwordx4 v[136:139], v3, s[4:7], s24 offen offset:2048 sc1
    v_mfma_f32_16x16x32_bf16 v[232:235], v[140:143], v[72:75], v[232:235]
    v_mfma_f32_16x16x32_bf16 v[228:231], v[140:143], v[68:71], v[228:231]
    v_mfma_f32_16x16x32_bf16 v[224:227], v[140:143], v[64:67], v[224:227]
    s_waitcnt vmcnt(13)
    v_mfma_f32_16x16x32_bf16 v[240:243], v[144:147], v[64:67], v[240:243]
    buffer_load_dwordx4 v[140:143], v3, s[4:7], s24 offen offset:3072 sc1
    v_mfma_f32_16x16x32_bf16 v[244:247], v[144:147], v[68:71], v[244:247]
    v_mfma_f32_16x16x32_bf16 v[248:251], v[144:147], v[72:75], v[248:251]
    s_add_u32 s24, s24, 4096
    v_mfma_f32_16x16x32_bf16 v[252:255], v[144:147], v[76:79], v[252:255]
    s_waitcnt vmcnt(13) lgkmcnt(0)
    v_mfma_f32_16x16x32_bf16 v[176:179], v[148:151], v[80:83], v[176:179]
    buffer_load_dwordx4 v[144:147], v3, s[4:7], s24 offen offset:0 sc1
    v_mfma_f32_16x16x32_bf16 v[180:183], v[148:151], v[84:87], v[180:183]
    ds_read_b128 v[64:67], v4 offset:18432
    v_mfma_f32_16x16x32_bf16 v[184:187], v[148:151], v[88:91], v[184:187]
    ds_read_b128 v[68:71], v4 offset:36864
    v_mfma_f32_16x16x32_bf16 v[188:191], v[148:151], v[92:95], v[188:191]
    v_mfma_f32_16x16x32_bf16 v[204:207], v[152:155], v[92:95], v[204:207]
    buffer_load_dwordx4 v[148:151], v3, s[4:7], s24 offen offset:1024 sc1
    v_mfma_f32_16x16x32_bf16 v[200:203], v[152:155], v[88:91], v[200:203]
    ds_read_b128 v[72:75], v4 offset:55296
    v_mfma_f32_16x16x32_bf16 v[196:199], v[152:155], v[84:87], v[196:199]
    ds_read_b128 v[76:79], v5 offset:8192
    v_mfma_f32_16x16x32_bf16 v[192:195], v[152:155], v[80:83], v[192:195]
    s_waitcnt vmcnt(13)
    v_mfma_f32_16x16x32_bf16 v[208:211], v[156:159], v[80:83], v[208:211]
    buffer_load_dwordx4 v[152:155], v3, s[4:7], s24 offen offset:2048 sc1
    v_mfma_f32_16x16x32_bf16 v[212:215], v[156:159], v[84:87], v[212:215]
    v_mfma_f32_16x16x32_bf16 v[216:219], v[156:159], v[88:91], v[216:219]
    v_mfma_f32_16x16x32_bf16 v[220:223], v[156:159], v[92:95], v[220:223]
    v_mfma_f32_16x16x32_bf16 v[236:239], v[96:99], v[92:95], v[236:239]
    buffer_load_dwordx4 v[156:159], v3, s[4:7], s24 offen offset:3072 sc1
    v_mfma_f32_16x16x32_bf16 v[232:235], v[96:99], v[88:91], v[232:235]
    v_mfma_f32_16x16x32_bf16 v[228:231], v[96:99], v[84:87], v[228:231]
    s_add_u32 s24, s24, 4096
    v_mfma_f32_16x16x32_bf16 v[224:227], v[96:99], v[80:83], v[224:227]
    s_waitcnt vmcnt(13)
    v_mfma_f32_16x16x32_bf16 v[240:243], v[100:103], v[80:83], v[240:243]
    buffer_load_dwordx4 v[96:99], v3, s[4:7], s24 offen offset:0 sc1
    v_mfma_f32_16x16x32_bf16 v[244:247], v[100:103], v[84:87], v[244:247]
    v_mfma_f32_16x16x32_bf16 v[248:251], v[100:103], v[88:91], v[248:251]
    v_mfma_f32_16x16x32_bf16 v[252:255], v[100:103], v[92:95], v[252:255]
    s_waitcnt vmcnt(13) lgkmcnt(0)
    v_mfma_f32_16x16x32_bf16 v[176:179], v[104:107], v[64:67], v[176:179]
    buffer_load_dwordx4 v[100:103], v3, s[4:7], s24 offen offset:1024 sc1
    v_mfma_f32_16x16x32_bf16 v[180:183], v[104:107], v[68:71], v[180:183]
    ds_read_b128 v[80:83], v4 offset:19456
    v_mfma_f32_16x16x32_bf16 v[184:187], v[104:107], v[72:75], v[184:187]
    ds_read_b128 v[84:87], v4 offset:37888
    v_mfma_f32_16x16x32_bf16 v[188:191], v[104:107], v[76:79], v[188:191]
    v_mfma_f32_16x16x32_bf16 v[204:207], v[108:111], v[76:79], v[204:207]
    buffer_load_dwordx4 v[104:107], v3, s[4:7], s24 offen offset:2048 sc1
    v_mfma_f32_16x16x32_bf16 v[200:203], v[108:111], v[72:75], v[200:203]
    ds_read_b128 v[88:91], v4 offset:56320
    v_mfma_f32_16x16x32_bf16 v[196:199], v[108:111], v[68:71], v[196:199]
    ds_read_b128 v[92:95], v5 offset:9216
    v_mfma_f32_16x16x32_bf16 v[192:195], v[108:111], v[64:67], v[192:195]
    s_waitcnt vmcnt(13)
    v_mfma_f32_16x16x32_bf16 v[208:211], v[112:115], v[64:67], v[208:211]
    buffer_load_dwordx4 v[108:111], v3, s[4:7], s24 offen offset:3072 sc1
    v_mfma_f32_16x16x32_bf16 v[212:215], v[112:115], v[68:71], v[212:215]
    v_mfma_f32_16x16x32_bf16 v[216:219], v[112:115], v[72:75], v[216:219]
    s_add_u32 s24, s24, 4096
    v_mfma_f32_16x16x32_bf16 v[220:223], v[112:115], v[76:79], v[220:223]
    v_mfma_f32_16x16x32_bf16 v[236:239], v[116:119], v[76:79], v[236:239]
    buffer_load_dwordx4 v[112:115], v3, s[4:7], s24 offen offset:0 sc1
    v_mfma_f32_16x16x32_bf16 v[232:235], v[116:119], v[72:75], v[232:235]
    v_mfma_f32_16x16x32_bf16 v[228:231], v[116:119], v[68:71], v[228:231]
    v_mfma_f32_16x16x32_bf16 v[224:227], v[116:119], v[64:67], v[224:227]
    s_waitcnt vmcnt(13)
    v_mfma_f32_16x16x32_bf16 v[240:243], v[120:123], v[64:67], v[240:243]
    buffer_load_dwordx4 v[116:119], v3, s[4:7], s24 offen offset:1024 sc1
    v_mfma_f32_16x16x32_bf16 v[244:247], v[120:123], v[68:71], v[244:247]
    v_mfma_f32_16x16x32_bf16 v[248:251], v[120:123], v[72:75], v[248:251]
    v_mfma_f32_16x16x32_bf16 v[252:255], v[120:123], v[76:79], v[252:255]
    s_waitcnt vmcnt(13) lgkmcnt(0)
    v_mfma_f32_16x16x32_bf16 v[176:179], v[124:127], v[80:83], v[176:179]
    buffer_load_dwordx4 v[120:123], v3, s[4:7], s24 offen offset:2048 sc1
    v_mfma_f32_16x16x32_bf16 v[180:183], v[124:127], v[84:87], v[180:183]
    ds_read_b128 v[64:67], v4 offset:20480
    v_mfma_f32_16x16x32_bf16 v[184:187], v[124:127], v[88:91], v[184:187]
    ds_read_b128 v[68:71], v4 offset:38912
    v_mfma_f32_16x16x32_bf16 v[188:191], v[124:127], v[92:95], v[188:191]
    v_mfma_f32_16x16x32_bf16 v[204:207], v[128:131], v[92:95], v[204:207]
    buffer_load_dwordx4 v[124:127], v3, s[4:7], s24 offen offset:3072 sc1
    v_mfma_f32_16x16x32_bf16 v[200:203], v[128:131], v[88:91], v[200:203]
    ds_read_b128 v[72:75], v4 offset:57344
    v_mfma_f32_16x16x32_bf16 v[196:199], v[128:131], v[84:87], v[196:199]
    s_add_u32 s24, s24, 4096
    v_mfma_f32_16x16x32_bf16 v[192:195], v[128:131], v[80:83], v[192:195]
    s_waitcnt vmcnt(13)
    v_mfma_f32_16x16x32_bf16 v[208:211], v[132:135], v[80:83], v[208:211]
    buffer_load_dwordx4 v[128:131], v3, s[4:7], s24 offen offset:0 sc1
    v_mfma_f32_16x16x32_bf16 v[212:215], v[132:135], v[84:87], v[212:215]
    ds_read_b128 v[76:79], v5 offset:10240
    v_mfma_f32_16x16x32_bf16 v[216:219], v[132:135], v[88:91], v[216:219]
    v_mfma_f32_16x16x32_bf16 v[220:223], v[132:135], v[92:95], v[220:223]
    v_mfma_f32_16x16x32_bf16 v[236:239], v[136:139], v[92:95], v[236:239]
    buffer_load_dwordx4 v[132:135], v3, s[4:7], s24 offen offset:1024 sc1
    v_mfma_f32_16x16x32_bf16 v[232:235], v[136:139], v[88:91], v[232:235]
    v_mfma_f32_16x16x32_bf16 v[228:231], v[136:139], v[84:87], v[228:231]
    v_mfma_f32_16x16x32_bf16 v[224:227], v[136:139], v[80:83], v[224:227]
    s_waitcnt vmcnt(13)
    v_mfma_f32_16x16x32_bf16 v[240:243], v[140:143], v[80:83], v[240:243]
    buffer_load_dwordx4 v[136:139], v3, s[4:7], s24 offen offset:2048 sc1
    v_mfma_f32_16x16x32_bf16 v[244:247], v[140:143], v[84:87], v[244:247]
    v_mfma_f32_16x16x32_bf16 v[248:251], v[140:143], v[88:91], v[248:251]
    v_mfma_f32_16x16x32_bf16 v[252:255], v[140:143], v[92:95], v[252:255]
    s_waitcnt vmcnt(13) lgkmcnt(0)
    v_mfma_f32_16x16x32_bf16 v[176:179], v[144:147], v[64:67], v[176:179]
    buffer_load_dwordx4 v[140:143], v3, s[4:7], s24 offen offset:3072 sc1
    v_mfma_f32_16x16x32_bf16 v[180:183], v[144:147], v[68:71], v[180:183]
    ds_read_b128 v[80:83], v4 offset:21504
    v_mfma_f32_16x16x32_bf16 v[184:187], v[144:147], v[72:75], v[184:187]
    s_add_u32 s24, s24, 4096
    v_mfma_f32_16x16x32_bf16 v[188:191], v[144:147], v[76:79], v[188:191]
    v_mfma_f32_16x16x32_bf16 v[204:207], v[148:151], v[76:79], v[204:207]
    buffer_load_dwordx4 v[144:147], v3, s[4:7], s24 offen offset:0 sc1
    v_mfma_f32_16x16x32_bf16 v[200:203], v[148:151], v[72:75], v[200:203]
    ds_read_b128 v[84:87], v4 offset:39936
    v_mfma_f32_16x16x32_bf16 v[196:199], v[148:151], v[68:71], v[196:199]
    ds_read_b128 v[88:91], v4 offset:58368
    v_mfma_f32_16x16x32_bf16 v[192:195], v[148:151], v[64:67], v[192:195]
    s_waitcnt vmcnt(13)
    v_mfma_f32_16x16x32_bf16 v[208:211], v[152:155], v[64:67], v[208:211]
    buffer_load_dwordx4 v[148:151], v3, s[4:7], s24 offen offset:1024 sc1
    v_mfma_f32_16x16x32_bf16 v[212:215], v[152:155], v[68:71], v[212:215]
    ds_read_b128 v[92:95], v5 offset:11264
    v_mfma_f32_16x16x32_bf16 v[216:219], v[152:155], v[72:75], v[216:219]
    v_mfma_f32_16x16x32_bf16 v[220:223], v[152:155], v[76:79], v[220:223]
    v_mfma_f32_16x16x32_bf16 v[236:239], v[156:159], v[76:79], v[236:239]
    buffer_load_dwordx4 v[152:155], v3, s[4:7], s24 offen offset:2048 sc1
    v_mfma_f32_16x16x32_bf16 v[232:235], v[156:159], v[72:75], v[232:235]
    v_mfma_f32_16x16x32_bf16 v[228:231], v[156:159], v[68:71], v[228:231]
    v_mfma_f32_16x16x32_bf16 v[224:227], v[156:159], v[64:67], v[224:227]
    s_waitcnt vmcnt(13)
    v_mfma_f32_16x16x32_bf16 v[240:243], v[96:99], v[64:67], v[240:243]
    buffer_load_dwordx4 v[156:159], v3, s[4:7], s24 offen offset:3072 sc1
    v_mfma_f32_16x16x32_bf16 v[244:247], v[96:99], v[68:71], v[244:247]
    v_mfma_f32_16x16x32_bf16 v[248:251], v[96:99], v[72:75], v[248:251]
    s_add_u32 s24, s24, 4096
    v_mfma_f32_16x16x32_bf16 v[252:255], v[96:99], v[76:79], v[252:255]
    s_waitcnt vmcnt(13) lgkmcnt(0)
    v_mfma_f32_16x16x32_bf16 v[176:179], v[100:103], v[80:83], v[176:179]
    buffer_load_dwordx4 v[96:99], v3, s[4:7], s24 offen offset:0 sc1
    v_mfma_f32_16x16x32_bf16 v[180:183], v[100:103], v[84:87], v[180:183]
    ds_read_b128 v[64:67], v4 offset:22528
    v_mfma_f32_16x16x32_bf16 v[184:187], v[100:103], v[88:91], v[184:187]
    ds_read_b128 v[68:71], v4 offset:40960
    v_mfma_f32_16x16x32_bf16 v[188:191], v[100:103], v[92:95], v[188:191]
    v_mfma_f32_16x16x32_bf16 v[204:207], v[104:107], v[92:95], v[204:207]
    buffer_load_dwordx4 v[100:103], v3, s[4:7], s24 offen offset:1024 sc1
    v_mfma_f32_16x16x32_bf16 v[200:203], v[104:107], v[88:91], v[200:203]
    ds_read_b128 v[72:75], v4 offset:59392
    v_mfma_f32_16x16x32_bf16 v[196:199], v[104:107], v[84:87], v[196:199]
    ds_read_b128 v[76:79], v5 offset:12288
    v_mfma_f32_16x16x32_bf16 v[192:195], v[104:107], v[80:83], v[192:195]
    s_waitcnt vmcnt(13)
    v_mfma_f32_16x16x32_bf16 v[208:211], v[108:111], v[80:83], v[208:211]
    buffer_load_dwordx4 v[104:107], v3, s[4:7], s24 offen offset:2048 sc1
    v_mfma_f32_16x16x32_bf16 v[212:215], v[108:111], v[84:87], v[212:215]
    v_mfma_f32_16x16x32_bf16 v[216:219], v[108:111], v[88:91], v[216:219]
    v_mfma_f32_16x16x32_bf16 v[220:223], v[108:111], v[92:95], v[220:223]
    v_mfma_f32_16x16x32_bf16 v[236:239], v[112:115], v[92:95], v[236:239]
    buffer_load_dwordx4 v[108:111], v3, s[4:7], s24 offen offset:3072 sc1
    v_mfma_f32_16x16x32_bf16 v[232:235], v[112:115], v[88:91], v[232:235]
    v_mfma_f32_16x16x32_bf16 v[228:231], v[112:115], v[84:87], v[228:231]
    s_add_u32 s24, s24, 4096
    v_mfma_f32_16x16x32_bf16 v[224:227], v[112:115], v[80:83], v[224:227]
    s_waitcnt vmcnt(13)
    v_mfma_f32_16x16x32_bf16 v[240:243], v[116:119], v[80:83], v[240:243]
    buffer_load_dwordx4 v[112:115], v3, s[4:7], s24 offen offset:0 sc1
    v_mfma_f32_16x16x32_bf16 v[244:247], v[116:119], v[84:87], v[244:247]
    v_mfma_f32_16x16x32_bf16 v[248:251], v[116:119], v[88:91], v[248:251]
    v_mfma_f32_16x16x32_bf16 v[252:255], v[116:119], v[92:95], v[252:255]
    s_waitcnt vmcnt(13) lgkmcnt(0)
    v_mfma_f32_16x16x32_bf16 v[176:179], v[120:123], v[64:67], v[176:179]
    ds_read_b32 v63, v13 offset:40
    buffer_load_dwordx4 v[116:119], v3, s[4:7], s24 offen offset:1024 sc1
    v_mfma_f32_16x16x32_bf16 v[180:183], v[120:123], v[68:71], v[180:183]
    ds_read_b128 v[80:83], v4 offset:23552
    v_mfma_f32_16x16x32_bf16 v[184:187], v[120:123], v[72:75], v[184:187]
    ds_read_b128 v[84:87], v4 offset:41984
    v_mfma_f32_16x16x32_bf16 v[188:191], v[120:123], v[76:79], v[188:191]
    v_mfma_f32_16x16x32_bf16 v[204:207], v[124:127], v[76:79], v[204:207]
    buffer_load_dwordx4 v[120:123], v3, s[4:7], s24 offen offset:2048 sc1
    v_mfma_f32_16x16x32_bf16 v[200:203], v[124:127], v[72:75], v[200:203]
    ds_read_b128 v[88:91], v4 offset:60416
    v_mfma_f32_16x16x32_bf16 v[196:199], v[124:127], v[68:71], v[196:199]
    ds_read_b128 v[92:95], v5 offset:13312
    v_mfma_f32_16x16x32_bf16 v[192:195], v[124:127], v[64:67], v[192:195]
    s_waitcnt vmcnt(13)
    v_mfma_f32_16x16x32_bf16 v[208:211], v[128:131], v[64:67], v[208:211]
    buffer_load_dwordx4 v[124:127], v3, s[4:7], s24 offen offset:3072 sc1
    v_mfma_f32_16x16x32_bf16 v[212:215], v[128:131], v[68:71], v[212:215]
    v_mfma_f32_16x16x32_bf16 v[216:219], v[128:131], v[72:75], v[216:219]
    s_add_u32 s24, s24, 4096
    v_mfma_f32_16x16x32_bf16 v[220:223], v[128:131], v[76:79], v[220:223]
    v_mfma_f32_16x16x32_bf16 v[236:239], v[132:135], v[76:79], v[236:239]
    buffer_load_dwordx4 v[128:131], v3, s[4:7], s24 offen offset:0 sc1
    v_mfma_f32_16x16x32_bf16 v[232:235], v[132:135], v[72:75], v[232:235]
    v_mfma_f32_16x16x32_bf16 v[228:231], v[132:135], v[68:71], v[228:231]
    v_mfma_f32_16x16x32_bf16 v[224:227], v[132:135], v[64:67], v[224:227]
    s_waitcnt vmcnt(13)
    v_mfma_f32_16x16x32_bf16 v[240:243], v[136:139], v[64:67], v[240:243]
    buffer_load_dwordx4 v[132:135], v3, s[4:7], s24 offen offset:1024 sc1
    v_mfma_f32_16x16x32_bf16 v[244:247], v[136:139], v[68:71], v[244:247]
    v_mfma_f32_16x16x32_bf16 v[248:251], v[136:139], v[72:75], v[248:251]
    v_mfma_f32_16x16x32_bf16 v[252:255], v[136:139], v[76:79], v[252:255]
    s_waitcnt vmcnt(13) lgkmcnt(0)
    v_mfma_f32_16x16x32_bf16 v[176:179], v[140:143], v[80:83], v[176:179]
    v_readfirstlane_b32 s3, v63
    s_nop 0
    s_cmp_ge_u32 s3, 1
    s_cbranch_scc1 L_w4ok_30
    s_mov_b32 s26, 0
L_lw_31:
    ds_read_b32 v14, v13 offset:40
    s_waitcnt lgkmcnt(0)
    v_readfirstlane_b32 s3, v14
    s_nop 0
    s_cmp_ge_u32 s3, 1
    s_cbranch_scc1 L_lwdone_32
    s_add_u32 s26, s26, 1
    s_cmp_lt_u32 s26, 1000000
    s_cbranch_scc1 L_lw_31
L_lwdone_32:
L_w4ok_30:
    buffer_load_dwordx4 v[136:139], v3, s[4:7], s24 offen offset:2048 sc1
    v_mfma_f32_16x16x32_bf16 v[180:183], v[140:143], v[84:87], v[180:183]
    ds_read_b128 v[64:67], v4 offset:24576
    v_mfma_f32_16x16x32_bf16 v[184:187], v[140:143], v[88:91], v[184:187]
    ds_read_b128 v[68:71], v4 offset:43008
    v_mfma_f32_16x16x32_bf16 v[188:191], v[140:143], v[92:95], v[188:191]
    v_mfma_f32_16x16x32_bf16 v[204:207], v[144:147], v[92:95], v[204:207]
    buffer_load_dwordx4 v[140:143], v3, s[4:7], s24 offen offset:3072 sc1
    v_mfma_f32_16x16x32_bf16 v[200:203], v[144:147], v[88:91], v[200:203]
    ds_read_b128 v[72:75], v4 offset:61440
    v_mfma_f32_16x16x32_bf16 v[196:199], v[144:147], v[84:87], v[196:199]
    s_add_u32 s24, s24, 4096
    v_mfma_f32_16x16x32_bf16 v[192:195], v[144:147], v[80:83], v[192:195]
    s_waitcnt vmcnt(13)
    v_mfma_f32_16x16x32_bf16 v[208:211], v[148:151], v[80:83], v[208:211]
    buffer_load_dwordx4 v[144:147], v3, s[4:7], s24 offen offset:0 sc1
    v_mfma_f32_16x16x32_bf16 v[212:215], v[148:151], v[84:87], v[212:215]
    ds_read_b128 v[76:79], v5 offset:14336
    v_mfma_f32_16x16x32_bf16 v[216:219], v[148:151], v[88:91], v[216:219]
    v_mfma_f32_16x16x32_bf16 v[220:223], v[148:151], v[92:95], v[220:223]
    v_mfma_f32_16x16x32_bf16 v[236:239], v[152:155], v[92:95], v[236:239]
    buffer_load_dwordx4 v[148:151], v3, s[4:7], s24 offen offset:1024 sc1
    v_mfma_f32_16x16x32_bf16 v[232:235], v[152:155], v[88:91], v[232:235]
    v_mfma_f32_16x16x32_bf16 v[228:231], v[152:155], v[84:87], v[228:231]
    v_mfma_f32_16x16x32_bf16 v[224:227], v[152:155], v[80:83], v[224:227]
    s_waitcnt vmcnt(13)
    v_mfma_f32_16x16x32_bf16 v[240:243], v[156:159], v[80:83], v[240:243]
    buffer_load_dwordx4 v[152:155], v3, s[4:7], s24 offen offset:2048 sc1
    v_mfma_f32_16x16x32_bf16 v[244:247], v[156:159], v[84:87], v[244:247]
    v_mfma_f32_16x16x32_bf16 v[248:251], v[156:159], v[88:91], v[248:251]
    v_mfma_f32_16x16x32_bf16 v[252:255], v[156:159], v[92:95], v[252:255]
    s_waitcnt vmcnt(13) lgkmcnt(0)
    v_mfma_f32_16x16x32_bf16 v[176:179], v[96:99], v[64:67], v[176:179]
    buffer_load_dwordx4 v[156:159], v3, s[4:7], s24 offen offset:3072 sc1
    v_mfma_f32_16x16x32_bf16 v[180:183], v[96:99], v[68:71], v[180:183]
    ds_read_b128 v[80:83], v4 offset:25600
    v_mfma_f32_16x16x32_bf16 v[184:187], v[96:99], v[72:75], v[184:187]
    s_add_u32 s24, s24, 4096
    v_mfma_f32_16x16x32_bf16 v[188:191], v[96:99], v[76:79], v[188:191]
    v_mfma_f32_16x16x32_bf16 v[204:207], v[100:103], v[76:79], v[204:207]
    buffer_load_dwordx4 v[96:99], v3, s[4:7], s24 offen offset:0 sc1
    v_mfma_f32_16x16x32_bf16 v[200:203], v[100:103], v[72:75], v[200:203]
    ds_read_b128 v[84:87], v4 offset:44032
    v_mfma_f32_16x16x32_bf16 v[196:199], v[100:103], v[68:71], v[196:199]
    ds_read_b128 v[88:91], v4 offset:62464
    v_mfma_f32_16x16x32_bf16 v[192:195], v[100:103], v[64:67], v[192:195]
    s_waitcnt vmcnt(13)
    v_mfma_f32_16x16x32_bf16 v[208:211], v[104:107], v[64:67], v[208:211]
    buffer_load_dwordx4 v[100:103], v3, s[4:7], s24 offen offset:1024 sc1
    v_mfma_f32_16x16x32_bf16 v[212:215], v[104:107], v[68:71], v[212:215]
    ds_read_b128 v[92:95], v5 offset:15360
    v_mfma_f32_16x16x32_bf16 v[216:219], v[104:107], v[72:75], v[216:219]
    v_mfma_f32_16x16x32_bf16 v[220:223], v[104:107], v[76:79], v[220:223]
    v_mfma_f32_16x16x32_bf16 v[236:239], v[108:111], v[76:79], v[236:239]
    buffer_load_dwordx4 v[104:107], v3, s[4:7], s24 offen offset:2048 sc1
    v_mfma_f32_16x16x32_bf16 v[232:235], v[108:111], v[72:75], v[232:235]
    v_mfma_f32_16x16x32_bf16 v[228:231], v[108:111], v[68:71], v[228:231]
    v_mfma_f32_16x16x32_bf16 v[224:227], v[108:111], v[64:67], v[224:227]
    s_waitcnt vmcnt(13)
    v_mfma_f32_16x16x32_bf16 v[240:243], v[112:115], v[64:67], v[240:243]
    buffer_load_dwordx4 v[108:111], v3, s[4:7], s24 offen offset:3072 sc1
    v_mfma_f32_16x16x32_bf16 v[244:247], v[112:115], v[68:71], v[244:247]
    v_mfma_f32_16x16x32_bf16 v[248:251], v[112:115], v[72:75], v[248:251]
    s_add_u32 s24, s24, 4096
    v_mfma_f32_16x16x32_bf16 v[252:255], v[112:115], v[76:79], v[252:255]
    s_waitcnt vmcnt(13) lgkmcnt(0)
    v_mfma_f32_16x16x32_bf16 v[176:179], v[116:119], v[80:83], v[176:179]
    buffer_load_dwordx4 v[112:115], v3, s[4:7], s24 offen offset:0 sc1
    v_mfma_f32_16x16x32_bf16 v[180:183], v[116:119], v[84:87], v[180:183]
    v_mfma_f32_16x16x32_bf16 v[184:187], v[116:119], v[88:91], v[184:187]
    v_mfma_f32_16x16x32_bf16 v[188:191], v[116:119], v[92:95], v[188:191]
    v_mfma_f32_16x16x32_bf16 v[204:207], v[120:123], v[92:95], v[204:207]
    buffer_load_dwordx4 v[116:119], v3, s[4:7], s24 offen offset:1024 sc1
    v_mfma_f32_16x16x32_bf16 v[200:203], v[120:123], v[88:91], v[200:203]
    v_mfma_f32_16x16x32_bf16 v[196:199], v[120:123], v[84:87], v[196:199]
    v_mfma_f32_16x16x32_bf16 v[192:195], v[120:123], v[80:83], v[192:195]
    s_waitcnt vmcnt(13)
    v_mfma_f32_16x16x32_bf16 v[208:211], v[124:127], v[80:83], v[208:211]
    buffer_load_dwordx4 v[120:123], v3, s[4:7], s24 offen offset:2048 sc1
    v_mfma_f32_16x16x32_bf16 v[212:215], v[124:127], v[84:87], v[212:215]
    v_mfma_f32_16x16x32_bf16 v[216:219], v[124:127], v[88:91], v[216:219]
    v_mfma_f32_16x16x32_bf16 v[220:223], v[124:127], v[92:95], v[220:223]
    v_mfma_f32_16x16x32_bf16 v[236:239], v[128:131], v[92:95], v[236:239]
    buffer_load_dwordx4 v[124:127], v3, s[4:7], s24 offen offset:3072 sc1
    v_mfma_f32_16x16x32_bf16 v[232:235], v[128:131], v[88:91], v[232:235]
    v_mfma_f32_16x16x32_bf16 v[228:231], v[128:131], v[84:87], v[228:231]
    s_add_u32 s24, s24, 4096
    v_mfma_f32_16x16x32_bf16 v[224:227], v[128:131], v[80:83], v[224:227]
    s_waitcnt vmcnt(13)
    v_mfma_f32_16x16x32_bf16 v[240:243], v[132:135], v[80:83], v[240:243]
    buffer_load_dwordx4 v[128:131], v3, s[4:7], s24 offen offset:0 sc1
    v_mfma_f32_16x16x32_bf16 v[244:247], v[132:135], v[84:87], v[244:247]
    v_mfma_f32_16x16x32_bf16 v[248:251], v[132:135], v[88:91], v[248:251]
    v_mfma_f32_16x16x32_bf16 v[252:255], v[132:135], v[92:95], v[252:255]
    buffer_load_dwordx4 v[132:135], v3, s[4:7], s24 offen offset:1024 sc1
    s_setprio 0
    s_barrier
    s_setprio 2
    s_cmp_ge_u32 s22, 20
    s_cbranch_scc1 L_nored_33
    s_bitcmp1_b32 s23, 2
    s_cbranch_scc1 L_nored_33
    s_and_b32 s91, s22, 1
    s_lshl_b32 s91, s91, 2
    s_xor_b32 s91, s91, s23
    s_lshl2_add_u32 s91, s91, s21
    s_mul_i32 s35, s91, 256
    s_add_u32 s35, s35, 24580
    s_mov_b32 s0, 0
    s_atomic_add s0, s[44:45], s35 glc
L_nored_33:
    v_mul_f32 v16, v176, v176
    v_mul_f32 v17, v177, v177
    v_mul_f32 v18, v178, v178
    v_mul_f32 v19, v179, v179
    v_fma_f32 v16, v16, v164, v160
    v_fma_f32 v17, v17, v164, v160
    v_fma_f32 v18, v18, v164, v160
    v_fma_f32 v19, v19, v164, v160
    v_mul_f32 v16, v16, v176
    v_mul_f32 v17, v17, v177
    v_mul_f32 v18, v18, v178
    v_mul_f32 v19, v19, v179
    v_exp_f32 v16, v16
    v_exp_f32 v17, v17
    v_exp_f32 v18, v18
    v_exp_f32 v19, v19
    v_fma_f32 v16, v16, v168, v168
    v_fma_f32 v17, v17, v168, v168
    v_fma_f32 v18, v18, v168, v168
    v_fma_f32 v19, v19, v168, v168
    v_rcp_f32 v16, v16
    v_rcp_f32 v17, v17
    v_rcp_f32 v18, v18
    v_rcp_f32 v19, v19
    v_mul_f32 v16, v16, v176
    v_mul_f32 v17, v17, v177
    v_mul_f32 v18, v18, v178
    v_mul_f32 v19, v19, v179
    v_cvt_pk_bf16_f32 v24, v16, v17
    v_cvt_pk_bf16_f32 v25, v18, v19
    v_mul_f32 v16, v192, v192
    v_mul_f32 v17, v193, v193
    v_mul_f32 v18, v194, v194
    v_mul_f32 v19, v195, v195
    v_fma_f32 v16, v16, v164, v160
    v_fma_f32 v17, v17, v164, v160
    v_fma_f32 v18, v18, v164, v160
    v_fma_f32 v19, v19, v164, v160
    v_mul_f32 v16, v16, v192
    v_mul_f32 v17, v17, v193
    v_mul_f32 v18, v18, v194
    v_mul_f32 v19, v19, v195
    v_exp_f32 v16, v16
    v_exp_f32 v17, v17
    v_exp_f32 v18, v18
    v_exp_f32 v19, v19
    v_fma_f32 v16, v16, v168, v168
    v_fma_f32 v17, v17, v168, v168
    v_fma_f32 v18, v18, v168, v168
    v_fma_f32 v19, v19, v168, v168
    v_rcp_f32 v16, v16
    v_rcp_f32 v17, v17
    v_rcp_f32 v18, v18
    v_rcp_f32 v19, v19
    v_mul_f32 v16, v16, v192
    v_mul_f32 v17, v17, v193
    v_mul_f32 v18, v18, v194
    v_mul_f32 v19, v19, v195
    v_cvt_pk_bf16_f32 v26, v16, v17
    v_cvt_pk_bf16_f32 v27, v18, v19
    ds_write_b128 v7, v[24:27] offset:0
    s_cmp_ge_u32 s22, 20
    s_cbranch_scc1 L_nored_34
    s_bitcmp1_b32 s23, 2
    s_cbranch_scc1 L_nored_34
    s_waitcnt lgkmcnt(0)
    s_cmp_ge_u32 s0, 50
    s_cbranch_scc1 L_chkok_35
    s_mov_b32 s26, 0
L_poll_36:
    s_mov_b32 s3, 0
    s_atomic_add s3, s[44:45], s35 glc
    s_waitcnt lgkmcnt(0)
    s_cmp_ge_u32 s3, 50
    s_cbranch_scc1 L_pdone_37
    s_sleep 8
    s_add_u32 s26, s26, 1
    s_cmp_lt_u32 s26, 40000
    s_cbranch_scc1 L_poll_36
L_pdone_37:
L_chkok_35:
    v_mul_u32_u24 v40, 2560, v2
    v_lshl_add_u32 v40, v1, 4, v40
    s_mul_i32 s32, s91, 81920
    s_lshr_b32 s33, s22, 1
    s_lshl_b32 s33, s33, 8
    s_add_u32 s32, s32, s33
    s_add_u32 s32, s32, 41943040
    buffer_load_dwordx4 v[64:67], v40, s[4:7], s32 offen sc1
    s_add_u32 s32, s32, 10240
    buffer_load_dwordx4 v[68:71], v40, s[4:7], s32 offen sc1
    s_add_u32 s32, s32, 10240
    buffer_load_dwordx4 v[72:75], v40, s[4:7], s32 offen sc1
    s_add_u32 s32, s32, 10240
    buffer_load_dwordx4 v[76:79], v40, s[4:7], s32 offen sc1
    s_add_u32 s32, s32, 10240
    buffer_load_dwordx4 v[80:83], v40, s[4:7], s32 offen sc1
    s_add_u32 s32, s32, 10240
    buffer_load_dwordx4 v[84:87], v40, s[4:7], s32 offen sc1
    s_add_u32 s32, s32, 10240
    buffer_load_dwordx4 v[88:91], v40, s[4:7], s32 offen sc1
    s_add_u32 s32, s32, 10240
    buffer_load_dwordx4 v[92:95], v40, s[4:7], s32 offen sc1
    v_lshlrev_b32 v41, 4, v1
    v_lshl_add_u32 v41, v2, 3, v41
    v_lshrrev_b32 v48, 1, v2
    v_lshl_add_u32 v41, v48, 28, v41
    v_and_b32 v48, 1, v1
    v_lshlrev_b32 v48, 4, v48
    v_lshlrev_b32 v48, v48, s29
    v_lshrrev_b32 v49, 1, v1
    v_cmp_eq_u32 vcc, 0, v49
    s_nop 1
    v_cndmask_b32 v44, 0, v48, vcc
    v_cmp_eq_u32 vcc, 1, v49
    s_nop 1
    v_cndmask_b32 v45, 0, v48, vcc
    v_cmp_eq_u32 vcc, 2, v49
    s_nop 1
    v_cndmask_b32 v46, 0, v48, vcc
    v_cmp_eq_u32 vcc, 3, v49
    s_nop 1
    v_cndmask_b32 v47, 0, v48, vcc
L_nored_34:
    v_mul_f32 v16, v180, v180
    v_mul_f32 v17, v181, v181
    v_mul_f32 v18, v182, v182
    v_mul_f32 v19, v183, v183
    v_fma_f32 v16, v16, v165, v161
    v_fma_f32 v17, v17, v165, v161
    v_fma_f32 v18, v18, v165, v161
    v_fma_f32 v19, v19, v165, v161
    v_mul_f32 v16, v16, v180
    v_mul_f32 v17, v17, v181
    v_mul_f32 v18, v18, v182
    v_mul_f32 v19, v19, v183
    v_exp_f32 v16, v16
    v_exp_f32 v17, v17
    v_exp_f32 v18, v18
    v_exp_f32 v19, v19
    v_fma_f32 v16, v16, v169, v169
    v_fma_f32 v17, v17, v169, v169
    v_fma_f32 v18, v18, v169, v169
    v_fma_f32 v19, v19, v169, v169
    v_rcp_f32 v16, v16
    v_rcp_f32 v17, v17
    v_rcp_f32 v18, v18
    v_rcp_f32 v19, v19
    v_mul_f32 v16, v16, v180
    v_mul_f32 v17, v17, v181
    v_mul_f32 v18, v18, v182
    v_mul_f32 v19, v19, v183
    v_cvt_pk_bf16_f32 v28, v16, v17
    v_cvt_pk_bf16_f32 v29, v18, v19
    v_mul_f32 v16, v196, v196
    v_mul_f32 v17, v197, v197
    v_mul_f32 v18, v198, v198
    v_mul_f32 v19, v199, v199
    v_fma_f32 v16, v16, v165, v161
    v_fma_f32 v17, v17, v165, v161
    v_fma_f32 v18, v18, v165, v161
    v_fma_f32 v19, v19, v165, v161
    v_mul_f32 v16, v16, v196
    v_mul_f32 v17, v17, v197
    v_mul_f32 v18, v18, v198
    v_mul_f32 v19, v19, v199
    v_exp_f32 v16, v16
    v_exp_f32 v17, v17
    v_exp_f32 v18, v18
    v_exp_f32 v19, v19
    v_fma_f32 v16, v16, v169, v169
    v_fma_f32 v17, v17, v169, v169
    v_fma_f32 v18, v18, v169, v169
    v_fma_f32 v19, v19, v169, v169
    v_rcp_f32 v16, v16
    v_rcp_f32 v17, v17
    v_rcp_f32 v18, v18
    v_rcp_f32 v19, v19
    v_mul_f32 v16, v16, v196
    v_mul_f32 v17, v17, v197
    v_mul_f32 v18, v18, v198
    v_mul_f32 v19, v19, v199
    v_cvt_pk_bf16_f32 v30, v16, v17
    v_cvt_pk_bf16_f32 v31, v18, v19
    ds_write_b128 v7, v[28:31] offset:1024
    v_mul_f32 v16, v184, v184
    v_mul_f32 v17, v185, v185
    v_mul_f32 v18, v186, v186
    v_mul_f32 v19, v187, v187
    v_fma_f32 v16, v16, v166, v162
    v_fma_f32 v17, v17, v166, v162
    v_fma_f32 v18, v18, v166, v162
    v_fma_f32 v19, v19, v166, v162
    v_mul_f32 v16, v16, v184
    v_mul_f32 v17, v17, v185
    v_mul_f32 v18, v18, v186
    v_mul_f32 v19, v19, v187
    v_exp_f32 v16, v16
    v_exp_f32 v17, v17
    v_exp_f32 v18, v18
    v_exp_f32 v19, v19
    v_fma_f32 v16, v16, v170, v170
    v_fma_f32 v17, v17, v170, v170
    v_fma_f32 v18, v18, v170, v170
    v_fma_f32 v19, v19, v170, v170
    v_rcp_f32 v16, v16
    v_rcp_f32 v17, v17
    v_rcp_f32 v18, v18
    v_rcp_f32 v19, v19
    v_mul_f32 v16, v16, v184
    v_mul_f32 v17, v17, v185
    v_mul_f32 v18, v18, v186
    v_mul_f32 v19, v19, v187
    v_cvt_pk_bf16_f32 v24, v16, v17
    v_cvt_pk_bf16_f32 v25, v18, v19
    v_mul_f32 v16, v200, v200
    v_mul_f32 v17, v201, v201
    v_mul_f32 v18, v202, v202
    v_mul_f32 v19, v203, v203
    v_fma_f32 v16, v16, v166, v162
    v_fma_f32 v17, v17, v166, v162
    v_fma_f32 v18, v18, v166, v162
    v_fma_f32 v19, v19, v166, v162
    v_mul_f32 v16, v16, v200
    v_mul_f32 v17, v17, v201
    v_mul_f32 v18, v18, v202
    v_mul_f32 v19, v19, v203
    v_exp_f32 v16, v16
    v_exp_f32 v17, v17
    v_exp_f32 v18, v18
    v_exp_f32 v19, v19
    v_fma_f32 v16, v16, v170, v170
    v_fma_f32 v17, v17, v170, v170
    v_fma_f32 v18, v18, v170, v170
    v_fma_f32 v19, v19, v170, v170
    v_rcp_f32 v16, v16
    v_rcp_f32 v17, v17
    v_rcp_f32 v18, v18
    v_rcp_f32 v19, v19
    v_mul_f32 v16, v16, v200
    v_mul_f32 v17, v17, v201
    v_mul_f32 v18, v18, v202
    v_mul_f32 v19, v19, v203
    v_cvt_pk_bf16_f32 v26, v16, v17
    v_cvt_pk_bf16_f32 v27, v18, v19
    ds_write_b128 v7, v[24:27] offset:2048
    s_cmp_ge_u32 s22, 20
    s_cbranch_scc1 L_nored_38
    s_bitcmp1_b32 s23, 2
    s_cbranch_scc1 L_nored_38
    s_mul_i32 s32, s91, 2560
    s_add_u32 s32, s32, s33
    s_add_u32 s32, s32, 65536
    s_waitcnt vmcnt(0)
    v_mfma_f32_16x16x32_bf16 v[48:51], v[44:47], v[64:67], 0
    v_mfma_f32_16x16x32_bf16 v[48:51], v[44:47], v[68:71], v[48:51]
    v_mfma_f32_16x16x32_bf16 v[48:51], v[44:47], v[72:75], v[48:51]
    v_mfma_f32_16x16x32_bf16 v[48:51], v[44:47], v[76:79], v[48:51]
    v_mfma_f32_16x16x32_bf16 v[48:51], v[44:47], v[80:83], v[48:51]
    v_mfma_f32_16x16x32_bf16 v[48:51], v[44:47], v[84:87], v[48:51]
    v_mfma_f32_16x16x32_bf16 v[48:51], v[44:47], v[88:91], v[48:51]
    v_mfma_f32_16x16x32_bf16 v[48:51], v[44:47], v[92:95], v[48:51]
    s_nop 7
    v_cvt_pk_bf16_f32 v48, v48, v49
    v_cvt_pk_bf16_f32 v49, v50, v51
    buffer_store_dwordx2 v[48:49], v41, s[4:7], s32 offen sc1
L_nored_38:
    v_mul_f32 v16, v188, v188
    v_mul_f32 v17, v189, v189
    v_mul_f32 v18, v190, v190
    v_mul_f32 v19, v191, v191
    v_fma_f32 v16, v16, v167, v163
    v_fma_f32 v17, v17, v167, v163
    v_fma_f32 v18, v18, v167, v163
    v_fma_f32 v19, v19, v167, v163
    v_mul_f32 v16, v16, v188
    v_mul_f32 v17, v17, v189
    v_mul_f32 v18, v18, v190
    v_mul_f32 v19, v19, v191
    v_exp_f32 v16, v16
    v_exp_f32 v17, v17
    v_exp_f32 v18, v18
    v_exp_f32 v19, v19
    v_fma_f32 v16, v16, v171, v171
    v_fma_f32 v17, v17, v171, v171
    v_fma_f32 v18, v18, v171, v171
    v_fma_f32 v19, v19, v171, v171
    v_rcp_f32 v16, v16
    v_rcp_f32 v17, v17
    v_rcp_f32 v18, v18
    v_rcp_f32 v19, v19
    v_mul_f32 v16, v16, v188
    v_mul_f32 v17, v17, v189
    v_mul_f32 v18, v18, v190
    v_mul_f32 v19, v19, v191
    v_cvt_pk_bf16_f32 v28, v16, v17
    v_cvt_pk_bf16_f32 v29, v18, v19
    v_mul_f32 v16, v204, v204
    v_mul_f32 v17, v205, v205
    v_mul_f32 v18, v206, v206
    v_mul_f32 v19, v207, v207
    v_fma_f32 v16, v16, v167, v163
    v_fma_f32 v17, v17, v167, v163
    v_fma_f32 v18, v18, v167, v163
    v_fma_f32 v19, v19, v167, v163
    v_mul_f32 v16, v16, v204
    v_mul_f32 v17, v17, v205
    v_mul_f32 v18, v18, v206
    v_mul_f32 v19, v19, v207
    v_exp_f32 v16, v16
    v_exp_f32 v17, v17
    v_exp_f32 v18, v18
    v_exp_f32 v19, v19
    v_fma_f32 v16, v16, v171, v171
    v_fma_f32 v17, v17, v171, v171
    v_fma_f32 v18, v18, v171, v171
    v_fma_f32 v19, v19, v171, v171
    v_rcp_f32 v16, v16
    v_rcp_f32 v17, v17
    v_rcp_f32 v18, v18
    v_rcp_f32 v19, v19
    v_mul_f32 v16, v16, v204
    v_mul_f32 v17, v17, v205
    v_mul_f32 v18, v18, v206
    v_mul_f32 v19, v19, v207
    v_cvt_pk_bf16_f32 v30, v16, v17
    v_cvt_pk_bf16_f32 v31, v18, v19
    ds_write_b128 v7, v[28:31] offset:3072
    v_mul_f32 v16, v208, v208
    v_mul_f32 v17, v209, v209
    v_mul_f32 v18, v210, v210
    v_mul_f32 v19, v211, v211
    v_fma_f32 v16, v16, v164, v160
    v_fma_f32 v17, v17, v164, v160
    v_fma_f32 v18, v18, v164, v160
    v_fma_f32 v19, v19, v164, v160
    v_mul_f32 v16, v16, v208
    v_mul_f32 v17, v17, v209
    v_mul_f32 v18, v18, v210
    v_mul_f32 v19, v19, v211
    v_exp_f32 v16, v16
    v_exp_f32 v17, v17
    v_exp_f32 v18, v18
    v_exp_f32 v19, v19
    v_fma_f32 v16, v16, v168, v168
    v_fma_f32 v17, v17, v168, v168
    v_fma_f32 v18, v18, v168, v168
    v_fma_f32 v19, v19, v168, v168
    v_rcp_f32 v16, v16
    v_rcp_f32 v17, v17
    v_rcp_f32 v18, v18
    v_rcp_f32 v19, v19
    v_mul_f32 v16, v16, v208
    v_mul_f32 v17, v17, v209
    v_mul_f32 v18, v18, v210
    v_mul_f32 v19, v19, v211
    v_cvt_pk_bf16_f32 v24, v16, v17
    v_cvt_pk_bf16_f32 v25, v18, v19
    v_mul_f32 v16, v224, v224
    v_mul_f32 v17, v225, v225
    v_mul_f32 v18, v226, v226
    v_mul_f32 v19, v227, v227
    v_fma_f32 v16, v16, v164, v160
    v_fma_f32 v17, v17, v164, v160
    v_fma_f32 v18, v18, v164, v160
    v_fma_f32 v19, v19, v164, v160
    v_mul_f32 v16, v16, v224
    v_mul_f32 v17, v17, v225
    v_mul_f32 v18, v18, v226
    v_mul_f32 v19, v19, v227
    v_exp_f32 v16, v16
    v_exp_f32 v17, v17
    v_exp_f32 v18, v18
    v_exp_f32 v19, v19
    v_fma_f32 v16, v16, v168, v168
    v_fma_f32 v17, v17, v168, v168
    v_fma_f32 v18, v18, v168, v168
    v_fma_f32 v19, v19, v168, v168
    v_rcp_f32 v16, v16
    v_rcp_f32 v17, v17
    v_rcp_f32 v18, v18
    v_rcp_f32 v19, v19
    v_mul_f32 v16, v16, v224
    v_mul_f32 v17, v17, v225
    v_mul_f32 v18, v18, v226
    v_mul_f32 v19, v19, v227
    v_cvt_pk_bf16_f32 v26, v16, v17
    v_cvt_pk_bf16_f32 v27, v18, v19
    ds_write_b128 v7, v[24:27] offset:16384
    s_cmp_ge_u32 s22, 20
    s_cbranch_scc1 L_nored_39
    s_bitcmp1_b32 s23, 2
    s_cbranch_scc1 L_nored_39
    s_waitcnt vmcnt(0)
    s_mov_b32 s1, 1
    s_atomic_add s1, s[44:45], s35
L_nored_39:
    v_mul_f32 v16, v212, v212
    v_mul_f32 v17, v213, v213
    v_mul_f32 v18, v214, v214
    v_mul_f32 v19, v215, v215
    v_fma_f32 v16, v16, v165, v161
    v_fma_f32 v17, v17, v165, v161
    v_fma_f32 v18, v18, v165, v161
    v_fma_f32 v19, v19, v165, v161
    v_mul_f32 v16, v16, v212
    v_mul_f32 v17, v17, v213
    v_mul_f32 v18, v18, v214
    v_mul_f32 v19, v19, v215
    v_exp_f32 v16, v16
    v_exp_f32 v17, v17
    v_exp_f32 v18, v18
    v_exp_f32 v19, v19
    v_fma_f32 v16, v16, v169, v169
    v_fma_f32 v17, v17, v169, v169
    v_fma_f32 v18, v18, v169, v169
    v_fma_f32 v19, v19, v169, v169
    v_rcp_f32 v16, v16
    v_rcp_f32 v17, v17
    v_rcp_f32 v18, v18
    v_rcp_f32 v19, v19
    v_mul_f32 v16, v16, v212
    v_mul_f32 v17, v17, v213
    v_mul_f32 v18, v18, v214
    v_mul_f32 v19, v19, v215
    v_cvt_pk_bf16_f32 v28, v16, v17
    v_cvt_pk_bf16_f32 v29, v18, v19
    v_mul_f32 v16, v228, v228
    v_mul_f32 v17, v229, v229
    v_mul_f32 v18, v230, v230
    v_mul_f32 v19, v231, v231
    v_fma_f32 v16, v16, v165, v161
    v_fma_f32 v17, v17, v165, v161
    v_fma_f32 v18, v18, v165, v161
    v_fma_f32 v19, v19, v165, v161
    v_mul_f32 v16, v16, v228
    v_mul_f32 v17, v17, v229
    v_mul_f32 v18, v18, v230
    v_mul_f32 v19, v19, v231
    v_exp_f32 v16, v16
    v_exp_f32 v17, v17
    v_exp_f32 v18, v18
    v_exp_f32 v19, v19
    v_fma_f32 v16, v16, v169, v169
    v_fma_f32 v17, v17, v169, v169
    v_fma_f32 v18, v18, v169, v169
    v_fma_f32 v19, v19, v169, v169
    v_rcp_f32 v16, v16
    v_rcp_f32 v17, v17
    v_rcp_f32 v18, v18
    v_rcp_f32 v19, v19
    v_mul_f32 v16, v16, v228
    v_mul_f32 v17, v17, v229
    v_mul_f32 v18, v18, v230
    v_mul_f32 v19, v19, v231
    v_cvt_pk_bf16_f32 v30, v16, v17
    v_cvt_pk_bf16_f32 v31, v18, v19
    ds_write_b128 v7, v[28:31] offset:17408
    v_mul_f32 v16, v216, v216
    v_mul_f32 v17, v217, v217
    v_mul_f32 v18, v218, v218
    v_mul_f32 v19, v219, v219
    v_fma_f32 v16, v16, v166, v162
    v_fma_f32 v17, v17, v166, v162
    v_fma_f32 v18, v18, v166, v162
    v_fma_f32 v19, v19, v166, v162
    v_mul_f32 v16, v16, v216
    v_mul_f32 v17, v17, v217
    v_mul_f32 v18, v18, v218
    v_mul_f32 v19, v19, v219
    v_exp_f32 v16, v16
    v_exp_f32 v17, v17
    v_exp_f32 v18, v18
    v_exp_f32 v19, v19
    v_fma_f32 v16, v16, v170, v170
    v_fma_f32 v17, v17, v170, v170
    v_fma_f32 v18, v18, v170, v170
    v_fma_f32 v19, v19, v170, v170
    v_rcp_f32 v16, v16
    v_rcp_f32 v17, v17
    v_rcp_f32 v18, v18
    v_rcp_f32 v19, v19
    v_mul_f32 v16, v16, v216
    v_mul_f32 v17, v17, v217
    v_mul_f32 v18, v18, v218
    v_mul_f32 v19, v19, v219
    v_cvt_pk_bf16_f32 v24, v16, v17
    v_cvt_pk_bf16_f32 v25, v18, v19
    v_mul_f32 v16, v232, v232
    v_mul_f32 v17, v233, v233
    v_mul_f32 v18, v234, v234
    v_mul_f32 v19, v235, v235
    v_fma_f32 v16, v16, v166, v162
    v_fma_f32 v17, v17, v166, v162
    v_fma_f32 v18, v18, v166, v162
    v_fma_f32 v19, v19, v166, v162
    v_mul_f32 v16, v16, v232
    v_mul_f32 v17, v17, v233
    v_mul_f32 v18, v18, v234
    v_mul_f32 v19, v19, v235
    v_exp_f32 v16, v16
    v_exp_f32 v17, v17
    v_exp_f32 v18, v18
    v_exp_f32 v19, v19
    v_fma_f32 v16, v16, v170, v170
    v_fma_f32 v17, v17, v170, v170
    v_fma_f32 v18, v18, v170, v170
    v_fma_f32 v19, v19, v170, v170
    v_rcp_f32 v16, v16
    v_rcp_f32 v17, v17
    v_rcp_f32 v18, v18
    v_rcp_f32 v19, v19
    v_mul_f32 v16, v16, v232
    v_mul_f32 v17, v17, v233
    v_mul_f32 v18, v18, v234
    v_mul_f32 v19, v19, v235
    v_cvt_pk_bf16_f32 v26, v16, v17
    v_cvt_pk_bf16_f32 v27, v18, v19
    ds_write_b128 v7, v[24:27] offset:18432
    v_mul_f32 v16, v220, v220
    v_mul_f32 v17, v221, v221
    v_mul_f32 v18, v222, v222
    v_mul_f32 v19, v223, v223
    v_fma_f32 v16, v16, v167, v163
    v_fma_f32 v17, v17, v167, v163
    v_fma_f32 v18, v18, v167, v163
    v_fma_f32 v19, v19, v167, v163
    v_mul_f32 v16, v16, v220
    v_mul_f32 v17, v17, v221
    v_mul_f32 v18, v18, v222
    v_mul_f32 v19, v19, v223
    v_exp_f32 v16, v16
    v_exp_f32 v17, v17
    v_exp_f32 v18, v18
    v_exp_f32 v19, v19
    v_fma_f32 v16, v16, v171, v171
    v_fma_f32 v17, v17, v171, v171
    v_fma_f32 v18, v18, v171, v171
    v_fma_f32 v19, v19, v171, v171
    v_rcp_f32 v16, v16
    v_rcp_f32 v17, v17
    v_rcp_f32 v18, v18
    v_rcp_f32 v19, v19
    v_mul_f32 v16, v16, v220
    v_mul_f32 v17, v17, v221
    v_mul_f32 v18, v18, v222
    v_mul_f32 v19, v19, v223
    v_cvt_pk_bf16_f32 v28, v16, v17
    v_cvt_pk_bf16_f32 v29, v18, v19
    v_mul_f32 v16, v236, v236
    v_mul_f32 v17, v237, v237
    v_mul_f32 v18, v238, v238
    v_mul_f32 v19, v239, v239
    v_fma_f32 v16, v16, v167, v163
    v_fma_f32 v17, v17, v167, v163
    v_fma_f32 v18, v18, v167, v163
    v_fma_f32 v19, v19, v167, v163
    v_mul_f32 v16, v16, v236
    v_mul_f32 v17, v17, v237
    v_mul_f32 v18, v18, v238
    v_mul_f32 v19, v19, v239
    v_exp_f32 v16, v16
    v_exp_f32 v17, v17
    v_exp_f32 v18, v18
    v_exp_f32 v19, v19
    v_fma_f32 v16, v16, v171, v171
    v_fma_f32 v17, v17, v171, v171
    v_fma_f32 v18, v18, v171, v171
    v_fma_f32 v19, v19, v171, v171
    v_rcp_f32 v16, v16
    v_rcp_f32 v17, v17
    v_rcp_f32 v18, v18
    v_rcp_f32 v19, v19
    v_mul_f32 v16, v16, v236
    v_mul_f32 v17, v17, v237
    v_mul_f32 v18, v18, v238
    v_mul_f32 v19, v19, v239
    v_cvt_pk_bf16_f32 v30, v16, v17
    v_cvt_pk_bf16_f32 v31, v18, v19
    ds_write_b128 v7, v[28:31] offset:19456
    v_mul_f32 v16, v240, v240
    v_mul_f32 v17, v241, v241
    v_mul_f32 v18, v242, v242
    v_mul_f32 v19, v243, v243
    v_fma_f32 v16, v16, v164, v160
    v_fma_f32 v17, v17, v164, v160
    v_fma_f32 v18, v18, v164, v160
    v_fma_f32 v19, v19, v164, v160
    v_mul_f32 v16, v16, v240
    v_mul_f32 v17, v17, v241
    v_mul_f32 v18, v18, v242
    v_mul_f32 v19, v19, v243
    v_exp_f32 v16, v16
    v_exp_f32 v17, v17
    v_exp_f32 v18, v18
    v_exp_f32 v19, v19
    v_fma_f32 v16, v16, v168, v168
    v_fma_f32 v17, v17, v168, v168
    v_fma_f32 v18, v18, v168, v168
    v_fma_f32 v19, v19, v168, v168
    v_rcp_f32 v16, v16
    v_rcp_f32 v17, v17
    v_rcp_f32 v18, v18
    v_rcp_f32 v19, v19
    v_mul_f32 v16, v16, v240
    v_mul_f32 v17, v17, v241
    v_mul_f32 v18, v18, v242
    v_mul_f32 v19, v19, v243
    v_cvt_pk_bf16_f32 v24, v16, v17
    v_cvt_pk_bf16_f32 v25, v18, v19
    ds_write_b64 v8, v[24:25] offset:0
    v_mul_f32 v16, v244, v244
    v_mul_f32 v17, v245, v245
    v_mul_f32 v18, v246, v246
    v_mul_f32 v19, v247, v247
    v_fma_f32 v16, v16, v165, v161
    v_fma_f32 v17, v17, v165, v161
    v_fma_f32 v18, v18, v165, v161
    v_fma_f32 v19, v19, v165, v161
    v_mul_f32 v16, v16, v244
    v_mul_f32 v17, v17, v245
    v_mul_f32 v18, v18, v246
    v_mul_f32 v19, v19, v247
    v_exp_f32 v16, v16
    v_exp_f32 v17, v17
    v_exp_f32 v18, v18
    v_exp_f32 v19, v19
    v_fma_f32 v16, v16, v169, v169
    v_fma_f32 v17, v17, v169, v169
    v_fma_f32 v18, v18, v169, v169
    v_fma_f32 v19, v19, v169, v169
    v_rcp_f32 v16, v16
    v_rcp_f32 v17, v17
    v_rcp_f32 v18, v18
    v_rcp_f32 v19, v19
    v_mul_f32 v16, v16, v244
    v_mul_f32 v17, v17, v245
    v_mul_f32 v18, v18, v246
    v_mul_f32 v19, v19, v247
    v_cvt_pk_bf16_f32 v26, v16, v17
    v_cvt_pk_bf16_f32 v27, v18, v19
    ds_write_b64 v8, v[26:27] offset:1024
    v_mul_f32 v16, v248, v248
    v_mul_f32 v17, v249, v249
    v_mul_f32 v18, v250, v250
    v_mul_f32 v19, v251, v251
    v_fma_f32 v16, v16, v166, v162
    v_fma_f32 v17, v17, v166, v162
    v_fma_f32 v18, v18, v166, v162
    v_fma_f32 v19, v19, v166, v162
    v_mul_f32 v16, v16, v248
    v_mul_f32 v17, v17, v249
    v_mul_f32 v18, v18, v250
    v_mul_f32 v19, v19, v251
    v_exp_f32 v16, v16
    v_exp_f32 v17, v17
    v_exp_f32 v18, v18
    v_exp_f32 v19, v19
    v_fma_f32 v16, v16, v170, v170
    v_fma_f32 v17, v17, v170, v170
    v_fma_f32 v18, v18, v170, v170
    v_fma_f32 v19, v19, v170, v170
    v_rcp_f32 v16, v16
    v_rcp_f32 v17, v17
    v_rcp_f32 v18, v18
    v_rcp_f32 v19, v19
    v_mul_f32 v16, v16, v248
    v_mul_f32 v17, v17, v249
    v_mul_f32 v18, v18, v250
    v_mul_f32 v19, v19, v251
    v_cvt_pk_bf16_f32 v24, v16, v17
    v_cvt_pk_bf16_f32 v25, v18, v19
    ds_write_b64 v8, v[24:25] offset:2048
    v_mul_f32 v16, v252, v252
    v_mul_f32 v17, v253, v253
    v_mul_f32 v18, v254, v254
    v_mul_f32 v19, v255, v255
    v_fma_f32 v16, v16, v167, v163
    v_fma_f32 v17, v17, v167, v163
    v_fma_f32 v18, v18, v167, v163
    v_fma_f32 v19, v19, v167, v163
    v_mul_f32 v16, v16, v252
    v_mul_f32 v17, v17, v253
    v_mul_f32 v18, v18, v254
    v_mul_f32 v19, v19, v255
    v_exp_f32 v16, v16
    v_exp_f32 v17, v17
    v_exp_f32 v18, v18
    v_exp_f32 v19, v19
    v_fma_f32 v16, v16, v171, v171
    v_fma_f32 v17, v17, v171, v171
    v_fma_f32 v18, v18, v171, v171
    v_fma_f32 v19, v19, v171, v171
    v_rcp_f32 v16, v16
    v_rcp_f32 v17, v17
    v_rcp_f32 v18, v18
    v_rcp_f32 v19, v19
    v_mul_f32 v16, v16, v252
    v_mul_f32 v17, v17, v253
    v_mul_f32 v18, v18, v254
    v_mul_f32 v19, v19, v255
    v_cvt_pk_bf16_f32 v26, v16, v17
    v_cvt_pk_bf16_f32 v27, v18, v19
    ds_write_b64 v8, v[26:27] offset:3072
    s_waitcnt lgkmcnt(0)
    s_setprio 0
    s_barrier
    ds_read_b128 v[64:67], v3 offset:0
    ds_read_b128 v[68:71], v3 offset:1024
    ds_read_b128 v[72:75], v3 offset:2048
    ds_read_b128 v[76:79], v3 offset:3072
    s_setprio 1
    s_waitcnt vmcnt(14) lgkmcnt(0)
    v_mfma_f32_16x16x32_bf16 v[176:179], v[136:139], v[64:67], 0
    ds_read_b128 v[80:83], v3 offset:4096
    v_mfma_f32_16x16x32_bf16 v[180:183], v[136:139], v[68:71], 0
    ds_read_b128 v[84:87], v3 offset:5120
    v_mfma_f32_16x16x32_bf16 v[184:187], v[136:139], v[72:75], 0
    ds_read_b128 v[88:91], v3 offset:6144
    v_mfma_f32_16x16x32_bf16 v[188:191], v[136:139], v[76:79], 0
    v_mfma_f32_16x16x32_bf16 v[204:207], v[140:143], v[76:79], 0
    buffer_load_dwordx4 v[136:139], v3, s[4:7], s24 offen offset:2048 sc1
    v_mfma_f32_16x16x32_bf16 v[200:203], v[140:143], v[72:75], 0
    ds_read_b128 v[92:95], v3 offset:7168
    v_mfma_f32_16x16x32_bf16 v[196:199], v[140:143], v[68:71], 0
    v_mfma_f32_16x16x32_bf16 v[192:195], v[140:143], v[64:67], 0
    s_waitcnt vmcnt(13)
    v_mfma_f32_16x16x32_bf16 v[208:211], v[144:147], v[64:67], 0
    buffer_load_dwordx4 v[140:143], v3, s[4:7], s24 offen offset:3072 sc1
    v_mfma_f32_16x16x32_bf16 v[212:215], v[144:147], v[68:71], 0
    v_mfma_f32_16x16x32_bf16 v[216:219], v[144:147], v[72:75], 0
    s_add_u32 s24, s24, 4096
    v_mfma_f32_16x16x32_bf16 v[220:223], v[144:147], v[76:79], 0
    v_mfma_f32_16x16x32_bf16 v[236:239], v[148:151], v[76:79], 0
    buffer_load_dwordx4 v[144:147], v3, s[4:7], s24 offen offset:0 sc1
    v_mfma_f32_16x16x32_bf16 v[232:235], v[148:151], v[72:75], 0
    v_mfma_f32_16x16x32_bf16 v[228:231], v[148:151], v[68:71], 0
    v_mfma_f32_16x16x32_bf16 v[224:227], v[148:151], v[64:67], 0
    s_waitcnt vmcnt(13) lgkmcnt(0)
    v_mfma_f32_16x16x32_bf16 v[176:179], v[152:155], v[80:83], v[176:179]
    buffer_load_dwordx4 v[148:151], v3, s[4:7], s24 offen offset:1024 sc1
    v_mfma_f32_16x16x32_bf16 v[180:183], v[152:155], v[84:87], v[180:183]
    ds_read_b128 v[64:67], v3 offset:8192
    v_mfma_f32_16x16x32_bf16 v[184:187], v[152:155], v[88:91], v[184:187]
    ds_read_b128 v[68:71], v3 offset:9216
    v_mfma_f32_16x16x32_bf16 v[188:191], v[152:155], v[92:95], v[188:191]
    v_mfma_f32_16x16x32_bf16 v[204:207], v[156:159], v[92:95], v[204:207]
    buffer_load_dwordx4 v[152:155], v3, s[4:7], s24 offen offset:2048 sc1
    v_mfma_f32_16x16x32_bf16 v[200:203], v[156:159], v[88:91], v[200:203]
    ds_read_b128 v[72:75], v3 offset:10240
    v_mfma_f32_16x16x32_bf16 v[196:199], v[156:159], v[84:87], v[196:199]
    ds_read_b128 v[76:79], v3 offset:11264
    v_mfma_f32_16x16x32_bf16 v[192:195], v[156:159], v[80:83], v[192:195]
    s_waitcnt vmcnt(13)
    v_mfma_f32_16x16x32_bf16 v[208:211], v[96:99], v[80:83], v[208:211]
    buffer_load_dwordx4 v[156:159], v3, s[4:7], s24 offen offset:3072 sc1
    v_mfma_f32_16x16x32_bf16 v[212:215], v[96:99], v[84:87], v[212:215]
    v_mfma_f32_16x16x32_bf16 v[216:219], v[96:99], v[88:91], v[216:219]
    s_add_u32 s24, s24, 4096
    v_mfma_f32_16x16x32_bf16 v[220:223], v[96:99], v[92:95], v[220:223]
    v_mfma_f32_16x16x32_bf16 v[236:239], v[100:103], v[92:95], v[236:239]
    buffer_load_dwordx4 v[96:99], v3, s[4:7], s24 offen offset:0 sc1
    v_mfma_f32_16x16x32_bf16 v[232:235], v[100:103], v[88:91], v[232:235]
    v_mfma_f32_16x16x32_bf16 v[228:231], v[100:103], v[84:87], v[228:231]
    v_mfma_f32_16x16x32_bf16 v[224:227], v[100:103], v[80:83], v[224:227]
    s_waitcnt vmcnt(13) lgkmcnt(0)
    v_mfma_f32_16x16x32_bf16 v[176:179], v[104:107], v[64:67], v[176:179]
    buffer_load_dwordx4 v[100:103], v3, s[4:7], s24 offen offset:1024 sc1
    v_mfma_f32_16x16x32_bf16 v[180:183], v[104:107], v[68:71], v[180:183]
    ds_read_b128 v[80:83], v3 offset:12288
    v_mfma_f32_16x16x32_bf16 v[184:187], v[104:107], v[72:75], v[184:187]
    ds_read_b128 v[84:87], v3 offset:13312
    v_mfma_f32_16x16x32_bf16 v[188:191], v[104:107], v[76:79], v[188:191]
    v_mfma_f32_16x16x32_bf16 v[204:207], v[108:111], v[76:79], v[204:207]
    buffer_load_dwordx4 v[104:107], v3, s[4:7], s24 offen offset:2048 sc1
    v_mfma_f32_16x16x32_bf16 v[200:203], v[108:111], v[72:75], v[200:203]
    ds_read_b128 v[88:91], v3 offset:14336
    v_mfma_f32_16x16x32_bf16 v[196:199], v[108:111], v[68:71], v[196:199]
    ds_read_b128 v[92:95], v3 offset:15360
    v_mfma_f32_16x16x32_bf16 v[192:195], v[108:111], v[64:67], v[192:195]
    s_waitcnt vmcnt(13)
    v_mfma_f32_16x16x32_bf16 v[208:211], v[112:115], v[64:67], v[208:211]
    buffer_load_dwordx4 v[108:111], v3, s[4:7], s24 offen offset:3072 sc1
    v_mfma_f32_16x16x32_bf16 v[212:215], v[112:115], v[68:71], v[212:215]
    v_mfma_f32_16x16x32_bf16 v[216:219], v[112:115], v[72:75], v[216:219]
    s_add_u32 s24, s24, 4096
    v_mfma_f32_16x16x32_bf16 v[220:223], v[112:115], v[76:79], v[220:223]
    v_mfma_f32_16x16x32_bf16 v[236:239], v[116:119], v[76:79], v[236:239]
    buffer_load_dwordx4 v[112:115], v3, s[4:7], s24 offen offset:0 sc1
    v_mfma_f32_16x16x32_bf16 v[232:235], v[116:119], v[72:75], v[232:235]
    v_mfma_f32_16x16x32_bf16 v[228:231], v[116:119], v[68:71], v[228:231]
    v_mfma_f32_16x16x32_bf16 v[224:227], v[116:119], v[64:67], v[224:227]
    s_waitcnt vmcnt(13) lgkmcnt(0)
    v_mfma_f32_16x16x32_bf16 v[176:179], v[120:123], v[80:83], v[176:179]
    buffer_load_dwordx4 v[116:119], v3, s[4:7], s24 offen offset:1024 sc1
    v_mfma_f32_16x16x32_bf16 v[180:183], v[120:123], v[84:87], v[180:183]
    ds_read_b128 v[64:67], v3 offset:16384
    v_mfma_f32_16x16x32_bf16 v[184:187], v[120:123], v[88:91], v[184:187]
    ds_read_b128 v[68:71], v3 offset:17408
    v_mfma_f32_16x16x32_bf16 v[188:191], v[120:123], v[92:95], v[188:191]
    v_mfma_f32_16x16x32_bf16 v[204:207], v[124:127], v[92:95], v[204:207]
    buffer_load_dwordx4 v[120:123], v3, s[4:7], s24 offen offset:2048 sc1
    v_mfma_f32_16x16x32_bf16 v[200:203], v[124:127], v[88:91], v[200:203]
    ds_read_b128 v[72:75], v3 offset:18432
    v_mfma_f32_16x16x32_bf16 v[196:199], v[124:127], v[84:87], v[196:199]
    ds_read_b128 v[76:79], v3 offset:19456
    v_mfma_f32_16x16x32_bf16 v[192:195], v[124:127], v[80:83], v[192:195]
    s_waitcnt vmcnt(13)
    v_mfma_f32_16x16x32_bf16 v[208:211], v[128:131], v[80:83], v[208:211]
    buffer_load_dwordx4 v[124:127], v3, s[4:7], s24 offen offset:3072 sc1
    v_mfma_f32_16x16x32_bf16 v[212:215], v[128:131], v[84:87], v[212:215]
    v_mfma_f32_16x16x32_bf16 v[216:219], v[128:131], v[88:91], v[216:219]
    s_add_u32 s24, s24, 4096
    v_mfma_f32_16x16x32_bf16 v[220:223], v[128:131], v[92:95], v[220:223]
    v_mfma_f32_16x16x32_bf16 v[236:239], v[132:135], v[92:95], v[236:239]
    buffer_load_dwordx4 v[128:131], v3, s[4:7], s24 offen offset:0 sc1
    v_mfma_f32_16x16x32_bf16 v[232:235], v[132:135], v[88:91], v[232:235]
    v_mfma_f32_16x16x32_bf16 v[228:231], v[132:135], v[84:87], v[228:231]
    v_mfma_f32_16x16x32_bf16 v[224:227], v[132:135], v[80:83], v[224:227]
    s_waitcnt vmcnt(13) lgkmcnt(0)
    v_mfma_f32_16x16x32_bf16 v[176:179], v[136:139], v[64:67], v[176:179]
    buffer_load_dwordx4 v[132:135], v3, s[4:7], s24 offen offset:1024 sc1
    v_mfma_f32_16x16x32_bf16 v[180:183], v[136:139], v[68:71], v[180:183]
    ds_read_b128 v[80:83], v3 offset:20480
    v_mfma_f32_16x16x32_bf16 v[184:187], v[136:139], v[72:75], v[184:187]
    ds_read_b128 v[84:87], v3 offset:21504
    v_mfma_f32_16x16x32_bf16 v[188:191], v[136:139], v[76:79], v[188:191]
    v_mfma_f32_16x16x32_bf16 v[204:207], v[140:143], v[76:79], v[204:207]
    buffer_load_dwordx4 v[160:163], v3, s[4:7], s24 offen offset:2048 sc1
    v_mfma_f32_16x16x32_bf16 v[200:203], v[140:143], v[72:75], v[200:203]
    ds_read_b128 v[88:91], v3 offset:22528
    v_mfma_f32_16x16x32_bf16 v[196:199], v[140:143], v[68:71], v[196:199]
    ds_read_b128 v[92:95], v3 offset:23552
    v_mfma_f32_16x16x32_bf16 v[192:195], v[140:143], v[64:67], v[192:195]
    s_waitcnt vmcnt(13)
    v_mfma_f32_16x16x32_bf16 v[208:211], v[144:147], v[64:67], v[208:211]
    buffer_load_dwordx4 v[164:167], v3, s[4:7], s24 offen offset:3072 sc1
    v_mfma_f32_16x16x32_bf16 v[212:215], v[144:147], v[68:71], v[212:215]
    s_add_u32 s24, s24, 4096
    buffer_load_dwordx4 v[168:171], v3, s[4:7], s24 offen offset:0 sc1
    v_mfma_f32_16x16x32_bf16 v[216:219], v[144:147], v[72:75], v[216:219]
    v_mfma_f32_16x16x32_bf16 v[220:223], v[144:147], v[76:79], v[220:223]
    v_mfma_f32_16x16x32_bf16 v[236:239], v[148:151], v[76:79], v[236:239]
    buffer_load_dwordx4 v[172:175], v3, s[4:7], s24 offen offset:1024 sc1
    v_mfma_f32_16x16x32_bf16 v[232:235], v[148:151], v[72:75], v[232:235]
    buffer_load_dwordx4 v[240:243], v3, s[4:7], s24 offen offset:2048 sc1
    v_mfma_f32_16x16x32_bf16 v[228:231], v[148:151], v[68:71], v[228:231]
    v_mfma_f32_16x16x32_bf16 v[224:227], v[148:151], v[64:67], v[224:227]
    s_waitcnt vmcnt(15) lgkmcnt(0)
    v_mfma_f32_16x16x32_bf16 v[176:179], v[152:155], v[80:83], v[176:179]
    buffer_load_dwordx4 v[244:247], v3, s[4:7], s24 offen offset:3072 sc1
    v_mfma_f32_16x16x32_bf16 v[180:183], v[152:155], v[84:87], v[180:183]
    ds_read_b128 v[64:67], v3 offset:24576
    v_mfma_f32_16x16x32_bf16 v[184:187], v[152:155], v[88:91], v[184:187]
    s_add_u32 s24, s24, 4096
    v_mfma_f32_16x16x32_bf16 v[188:191], v[152:155], v[92:95], v[188:191]
    v_mfma_f32_16x16x32_bf16 v[204:207], v[156:159], v[92:95], v[204:207]
    buffer_load_dwordx4 v[248:251], v3, s[4:7], s24 offen offset:0 sc1
    v_mfma_f32_16x16x32_bf16 v[200:203], v[156:159], v[88:91], v[200:203]
    ds_read_b128 v[68:71], v3 offset:25600
    v_mfma_f32_16x16x32_bf16 v[196:199], v[156:159], v[84:87], v[196:199]
    ds_read_b128 v[72:75], v3 offset:26624
    v_mfma_f32_16x16x32_bf16 v[192:195], v[156:159], v[80:83], v[192:195]
    s_waitcnt vmcnt(15)
    v_mfma_f32_16x16x32_bf16 v[208:211], v[96:99], v[80:83], v[208:211]
    buffer_load_dwordx4 v[252:255], v3, s[4:7], s24 offen offset:1024 sc1
    v_mfma_f32_16x16x32_bf16 v[212:215], v[96:99], v[84:87], v[212:215]
    ds_read_b128 v[76:79], v3 offset:27648
    v_mfma_f32_16x16x32_bf16 v[216:219], v[96:99], v[88:91], v[216:219]
    v_mfma_f32_16x16x32_bf16 v[220:223], v[96:99], v[92:95], v[220:223]
    v_mfma_f32_16x16x32_bf16 v[236:239], v[100:103], v[92:95], v[236:239]
    buffer_load_dwordx4 v[136:139], v3, s[4:7], s24 offen offset:2048 sc1
    v_mfma_f32_16x16x32_bf16 v[232:235], v[100:103], v[88:91], v[232:235]
    buffer_load_dwordx4 v[140:143], v3, s[4:7], s24 offen offset:3072 sc1
    v_mfma_f32_16x16x32_bf16 v[228:231], v[100:103], v[84:87], v[228:231]
    s_add_u32 s24, s24, 4096
    v_mfma_f32_16x16x32_bf16 v[224:227], v[100:103], v[80:83], v[224:227]
    s_waitcnt vmcnt(16) lgkmcnt(0)
    v_mfma_f32_16x16x32_bf16 v[176:179], v[104:107], v[64:67], v[176:179]
    buffer_load_dwordx4 v[144:147], v3, s[4:7], s24 offen offset:0 sc1
    v_mfma_f32_16x16x32_bf16 v[180:183], v[104:107], v[68:71], v[180:183]
    ds_read_b128 v[80:83], v3 offset:28672
    v_mfma_f32_16x16x32_bf16 v[184:187], v[104:107], v[72:75], v[184:187]
    ds_read_b128 v[84:87], v3 offset:29696
    v_mfma_f32_16x16x32_bf16 v[188:191], v[104:107], v[76:79], v[188:191]
    v_mfma_f32_16x16x32_bf16 v[204:207], v[108:111], v[76:79], v[204:207]
    buffer_load_dwordx4 v[148:151], v3, s[4:7], s24 offen offset:1024 sc1
    v_mfma_f32_16x16x32_bf16 v[200:203], v[108:111], v[72:75], v[200:203]
    ds_read_b128 v[88:91], v3 offset:30720
    v_mfma_f32_16x16x32_bf16 v[196:199], v[108:111], v[68:71], v[196:199]
    ds_read_b128 v[92:95], v3 offset:31744
    v_mfma_f32_16x16x32_bf16 v[192:195], v[108:111], v[64:67], v[192:195]
    s_waitcnt vmcnt(16)
    v_mfma_f32_16x16x32_bf16 v[208:211], v[112:115], v[64:67], v[208:211]
    buffer_load_dwordx4 v[152:155], v3, s[4:7], s24 offen offset:2048 sc1
    v_mfma_f32_16x16x32_bf16 v[212:215], v[112:115], v[68:71], v[212:215]
    buffer_load_dwordx4 v[156:159], v3, s[4:7], s24 offen offset:3072 sc1
    v_mfma_f32_16x16x32_bf16 v[216:219], v[112:115], v[72:75], v[216:219]
    s_add_u32 s24, s24, 4096
    v_mfma_f32_16x16x32_bf16 v[220:223], v[112:115], v[76:79], v[220:223]
    v_mfma_f32_16x16x32_bf16 v[236:239], v[116:119], v[76:79], v[236:239]
    buffer_load_dwordx4 v[96:99], v3, s[4:7], s24 offen offset:0 sc1
    v_mfma_f32_16x16x32_bf16 v[232:235], v[116:119], v[72:75], v[232:235]
    buffer_load_dwordx4 v[100:103], v3, s[4:7], s24 offen offset:1024 sc1
    v_mfma_f32_16x16x32_bf16 v[228:231], v[116:119], v[68:71], v[228:231]
    v_mfma_f32_16x16x32_bf16 v[224:227], v[116:119], v[64:67], v[224:227]
    s_waitcnt vmcnt(18) lgkmcnt(0)
    v_mfma_f32_16x16x32_bf16 v[176:179], v[120:123], v[80:83], v[176:179]
    buffer_load_dwordx4 v[104:107], v3, s[4:7], s24 offen offset:2048 sc1
    v_mfma_f32_16x16x32_bf16 v[180:183], v[120:123], v[84:87], v[180:183]
    ds_read_b128 v[64:67], v3 offset:32768
    v_mfma_f32_16x16x32_bf16 v[184:187], v[120:123], v[88:91], v[184:187]
    ds_read_b128 v[68:71], v3 offset:33792
    v_mfma_f32_16x16x32_bf16 v[188:191], v[120:123], v[92:95], v[188:191]
    v_mfma_f32_16x16x32_bf16 v[204:207], v[124:127], v[92:95], v[204:207]
    buffer_load_dwordx4 v[108:111], v3, s[4:7], s24 offen offset:3072 sc1
    v_mfma_f32_16x16x32_bf16 v[200:203], v[124:127], v[88:91], v[200:203]
    ds_read_b128 v[72:75], v3 offset:34816
    v_mfma_f32_16x16x32_bf16 v[196:199], v[124:127], v[84:87], v[196:199]
    s_add_u32 s24, s24, 4096
    v_mfma_f32_16x16x32_bf16 v[192:195], v[124:127], v[80:83], v[192:195]
    s_waitcnt vmcnt(18)
    v_mfma_f32_16x16x32_bf16 v[208:211], v[128:131], v[80:83], v[208:211]
    buffer_load_dwordx4 v[112:115], v3, s[4:7], s24 offen offset:0 sc1
    v_mfma_f32_16x16x32_bf16 v[212:215], v[128:131], v[84:87], v[212:215]
    ds_read_b128 v[76:79], v3 offset:35840
    v_mfma_f32_16x16x32_bf16 v[216:219], v[128:131], v[88:91], v[216:219]
    v_mfma_f32_16x16x32_bf16 v[220:223], v[128:131], v[92:95], v[220:223]
    v_mfma_f32_16x16x32_bf16 v[236:239], v[132:135], v[92:95], v[236:239]
    buffer_load_dwordx4 v[116:119], v3, s[4:7], s24 offen offset:1024 sc1
    v_mfma_f32_16x16x32_bf16 v[232:235], v[132:135], v[88:91], v[232:235]
    buffer_load_dwordx4 v[120:123], v3, s[4:7], s24 offen offset:2048 sc1
    v_mfma_f32_16x16x32_bf16 v[228:231], v[132:135], v[84:87], v[228:231]
    v_mfma_f32_16x16x32_bf16 v[224:227], v[132:135], v[80:83], v[224:227]
    s_waitcnt vmcnt(19) lgkmcnt(0)
    v_mfma_f32_16x16x32_bf16 v[176:179], v[160:163], v[64:67], v[176:179]
    buffer_load_dwordx4 v[124:127], v3, s[4:7], s24 offen offset:3072 sc1
    v_mfma_f32_16x16x32_bf16 v[180:183], v[160:163], v[68:71], v[180:183]
    ds_read_b128 v[80:83], v3 offset:36864
    v_mfma_f32_16x16x32_bf16 v[184:187], v[160:163], v[72:75], v[184:187]
    s_add_u32 s24, s24, 4096
    v_mfma_f32_16x16x32_bf16 v[188:191], v[160:163], v[76:79], v[188:191]
    v_mfma_f32_16x16x32_bf16 v[204:207], v[164:167], v[76:79], v[204:207]
    buffer_load_dwordx4 v[128:131], v3, s[4:7], s24 offen offset:0 sc1
    v_mfma_f32_16x16x32_bf16 v[200:203], v[164:167], v[72:75], v[200:203]
    ds_read_b128 v[84:87], v3 offset:37888
    v_mfma_f32_16x16x32_bf16 v[196:199], v[164:167], v[68:71], v[196:199]
    ds_read_b128 v[88:91], v3 offset:38912
    v_mfma_f32_16x16x32_bf16 v[192:195], v[164:167], v[64:67], v[192:195]
    s_waitcnt vmcnt(19)
    v_mfma_f32_16x16x32_bf16 v[208:211], v[168:171], v[64:67], v[208:211]
    buffer_load_dwordx4 v[132:135], v3, s[4:7], s24 offen offset:1024 sc1
    v_mfma_f32_16x16x32_bf16 v[212:215], v[168:171], v[68:71], v[212:215]
    ds_read_b128 v[92:95], v3 offset:39936
    v_mfma_f32_16x16x32_bf16 v[216:219], v[168:171], v[72:75], v[216:219]
    ds_read_b32 v63, v13 offset:84
    v_mfma_f32_16x16x32_bf16 v[220:223], v[168:171], v[76:79], v[220:223]
    v_mfma_f32_16x16x32_bf16 v[236:239], v[172:175], v[76:79], v[236:239]
    buffer_load_dwordx4 v[160:163], v3, s[4:7], s24 offen offset:2048 sc1
    v_mfma_f32_16x16x32_bf16 v[232:235], v[172:175], v[72:75], v[232:235]
    buffer_load_dwordx4 v[164:167], v3, s[4:7], s24 offen offset:3072 sc1
    v_mfma_f32_16x16x32_bf16 v[228:231], v[172:175], v[68:71], v[228:231]
    s_add_u32 s24, s24, 4096
    v_mfma_f32_16x16x32_bf16 v[224:227], v[172:175], v[64:67], v[224:227]
    s_waitcnt vmcnt(20) lgkmcnt(1)
    v_mfma_f32_16x16x32_bf16 v[176:179], v[240:243], v[80:83], v[176:179]
    buffer_load_dwordx4 v[168:171], v3, s[4:7], s24 offen offset:0 sc1
    v_mfma_f32_16x16x32_bf16 v[180:183], v[240:243], v[84:87], v[180:183]
    s_waitcnt lgkmcnt(0)
    v_readfirstlane_b32 s3, v63
    s_nop 0
    s_cmp_ge_u32 s3, 4
    s_cbranch_scc1 L_hok_40
    s_mov_b32 s26, 0
L_lw_41:
    ds_read_b32 v14, v13 offset:84
    s_waitcnt lgkmcnt(0)
    v_readfirstlane_b32 s3, v14
    s_nop 0
    s_cmp_ge_u32 s3, 4
    s_cbranch_scc1 L_lwdone_42
    s_add_u32 s26, s26, 1
    s_cmp_lt_u32 s26, 1000000
    s_cbranch_scc1 L_lw_41
L_lwdone_42:
L_hok_40:
    v_mfma_f32_16x16x32_bf16 v[184:187], v[240:243], v[88:91], v[184:187]
    ds_read_b128 v[64:67], v3 offset:40960
    v_mfma_f32_16x16x32_bf16 v[188:191], v[240:243], v[92:95], v[188:191]
    v_mfma_f32_16x16x32_bf16 v[204:207], v[244:247], v[92:95], v[204:207]
    buffer_load_dwordx4 v[172:175], v3, s[4:7], s24 offen offset:1024 sc1
    v_mfma_f32_16x16x32_bf16 v[200:203], v[244:247], v[88:91], v[200:203]
    ds_read_b128 v[68:71], v3 offset:41984
    v_mfma_f32_16x16x32_bf16 v[196:199], v[244:247], v[84:87], v[196:199]
    ds_read_b128 v[72:75], v3 offset:43008
    v_mfma_f32_16x16x32_bf16 v[192:195], v[244:247], v[80:83], v[192:195]
    s_waitcnt vmcnt(20)
    v_mfma_f32_16x16x32_bf16 v[208:211], v[248:251], v[80:83], v[208:211]
    buffer_load_dwordx4 v[240:243], v3, s[4:7], s24 offen offset:2048 sc1
    v_mfma_f32_16x16x32_bf16 v[212:215], v[248:251], v[84:87], v[212:215]
    ds_read_b128 v[76:79], v3 offset:44032
    v_mfma_f32_16x16x32_bf16 v[216:219], v[248:251], v[88:91], v[216:219]
    v_mfma_f32_16x16x32_bf16 v[220:223], v[248:251], v[92:95], v[220:223]
    v_mfma_f32_16x16x32_bf16 v[236:239], v[252:255], v[92:95], v[236:239]
    buffer_load_dwordx4 v[244:247], v3, s[4:7], s24 offen offset:3072 sc1
    v_mfma_f32_16x16x32_bf16 v[232:235], v[252:255], v[88:91], v[232:235]
    s_add_u32 s24, s24, 4096
    buffer_load_dwordx4 v[248:251], v3, s[4:7], s24 offen offset:0 sc1
    v_mfma_f32_16x16x32_bf16 v[228:231], v[252:255], v[84:87], v[228:231]
    v_mfma_f32_16x16x32_bf16 v[224:227], v[252:255], v[80:83], v[224:227]
    s_waitcnt vmcnt(21) lgkmcnt(0)
    v_mfma_f32_16x16x32_bf16 v[176:179], v[136:139], v[64:67], v[176:179]
    buffer_load_dwordx4 v[252:255], v3, s[4:7], s24 offen offset:1024 sc1
    v_mfma_f32_16x16x32_bf16 v[180:183], v[136:139], v[68:71], v[180:183]
    ds_read_b128 v[80:83], v3 offset:45056
    v_mfma_f32_16x16x32_bf16 v[184:187], v[136:139], v[72:75], v[184:187]
    ds_read_b128 v[84:87], v3 offset:46080
    v_mfma_f32_16x16x32_bf16 v[188:191], v[136:139], v[76:79], v[188:191]
    v_mfma_f32_16x16x32_bf16 v[204:207], v[140:143], v[76:79], v[204:207]
    buffer_load_dwordx4 v[136:139], v3, s[4:7], s24 offen offset:2048 sc1
    v_mfma_f32_16x16x32_bf16 v[200:203], v[140:143], v[72:75], v[200:203]
    ds_read_b128 v[88:91], v3 offset:47104
    v_mfma_f32_16x16x32_bf16 v[196:199], v[140:143], v[68:71], v[196:199]
    ds_read_b128 v[92:95], v3 offset:48128
    v_mfma_f32_16x16x32_bf16 v[192:195], v[140:143], v[64:67], v[192:195]
    s_waitcnt vmcnt(21)
    v_mfma_f32_16x16x32_bf16 v[208:211], v[144:147], v[64:67], v[208:211]
    buffer_load_dwordx4 v[140:143], v3, s[4:7], s24 offen offset:3072 sc1
    v_mfma_f32_16x16x32_bf16 v[212:215], v[144:147], v[68:71], v[212:215]
    v_mfma_f32_16x16x32_bf16 v[216:219], v[144:147], v[72:75], v[216:219]
    s_add_u32 s24, s24, 4096
    v_mfma_f32_16x16x32_bf16 v[220:223], v[144:147], v[76:79], v[220:223]
    v_mfma_f32_16x16x32_bf16 v[236:239], v[148:151], v[76:79], v[236:239]
    buffer_load_dwordx4 v[144:147], v3, s[4:7], s24 offen offset:0 sc1
    v_mfma_f32_16x16x32_bf16 v[232:235], v[148:151], v[72:75], v[232:235]
    v_mfma_f32_16x16x32_bf16 v[228:231], v[148:151], v[68:71], v[228:231]
    v_mfma_f32_16x16x32_bf16 v[224:227], v[148:151], v[64:67], v[224:227]
    s_waitcnt vmcnt(21) lgkmcnt(0)
    v_mfma_f32_16x16x32_bf16 v[176:179], v[152:155], v[80:83], v[176:179]
    buffer_load_dwordx4 v[148:151], v3, s[4:7], s24 offen offset:1024 sc1
    v_mfma_f32_16x16x32_bf16 v[180:183], v[152:155], v[84:87], v[180:183]
    ds_read_b128 v[64:67], v3 offset:49152
    v_mfma_f32_16x16x32_bf16 v[184:187], v[152:155], v[88:91], v[184:187]
    ds_read_b128 v[68:71], v3 offset:50176
    v_mfma_f32_16x16x32_bf16 v[188:191], v[152:155], v[92:95], v[188:191]
    v_mfma_f32_16x16x32_bf16 v[204:207], v[156:159], v[92:95], v[204:207]
    buffer_load_dwordx4 v[152:155], v3, s[4:7], s24 offen offset:2048 sc1
    v_mfma_f32_16x16x32_bf16 v[200:203], v[156:159], v[88:91], v[200:203]
    ds_read_b128 v[72:75], v3 offset:51200
    v_mfma_f32_16x16x32_bf16 v[196:199], v[156:159], v[84:87], v[196:199]
    ds_read_b128 v[76:79], v3 offset:52224
    v_mfma_f32_16x16x32_bf16 v[192:195], v[156:159], v[80:83], v[192:195]
    s_waitcnt vmcnt(21)
    v_mfma_f32_16x16x32_bf16 v[208:211], v[96:99], v[80:83], v[208:211]
    buffer_load_dwordx4 v[156:159], v3, s[4:7], s24 offen offset:3072 sc1
    v_mfma_f32_16x16x32_bf16 v[212:215], v[96:99], v[84:87], v[212:215]
    v_mfma_f32_16x16x32_bf16 v[216:219], v[96:99], v[88:91], v[216:219]
    s_add_u32 s24, s24, 4096
    v_mfma_f32_16x16x32_bf16 v[220:223], v[96:99], v[92:95], v[220:223]
    v_mfma_f32_16x16x32_bf16 v[236:239], v[100:103], v[92:95], v[236:239]
    buffer_load_dwordx4 v[96:99], v3, s[4:7], s24 offen offset:0 sc1
    v_mfma_f32_16x16x32_bf16 v[232:235], v[100:103], v[88:91], v[232:235]
    v_mfma_f32_16x16x32_bf16 v[228:231], v[100:103], v[84:87], v[228:231]
    v_mfma_f32_16x16x32_bf16 v[224:227], v[100:103], v[80:83], v[224:227]
    s_waitcnt vmcnt(21) lgkmcnt(0)
    v_mfma_f32_16x16x32_bf16 v[176:179], v[104:107], v[64:67], v[176:179]
    buffer_load_dwordx4 v[100:103], v3, s[4:7], s24 offen offset:1024 sc1
    v_mfma_f32_16x16x32_bf16 v[180:183], v[104:107], v[68:71], v[180:183]
    ds_read_b128 v[80:83], v3 offset:53248
    v_mfma_f32_16x16x32_bf16 v[184:187], v[104:107], v[72:75], v[184:187]
    ds_read_b128 v[84:87], v3 offset:54272
    v_mfma_f32_16x16x32_bf16 v[188:191], v[104:107], v[76:79], v[188:191]
    v_mfma_f32_16x16x32_bf16 v[204:207], v[108:111], v[76:79], v[204:207]
    buffer_load_dwordx4 v[104:107], v3, s[4:7], s24 offen offset:2048 sc1
    v_mfma_f32_16x16x32_bf16 v[200:203], v[108:111], v[72:75], v[200:203]
    ds_read_b128 v[88:91], v3 offset:55296
    v_mfma_f32_16x16x32_bf16 v[196:199], v[108:111], v[68:71], v[196:199]
    ds_read_b128 v[92:95], v3 offset:56320
    v_mfma_f32_16x16x32_bf16 v[192:195], v[108:111], v[64:67], v[192:195]
    s_waitcnt vmcnt(21)
    v_mfma_f32_16x16x32_bf16 v[208:211], v[112:115], v[64:67], v[208:211]
    buffer_load_dwordx4 v[108:111], v3, s[4:7], s24 offen offset:3072 sc1
    v_mfma_f32_16x16x32_bf16 v[212:215], v[112:115], v[68:71], v[212:215]
    ds_read_b32 v63, v13 offset:88
    v_mfma_f32_16x16x32_bf16 v[216:219], v[112:115], v[72:75], v[216:219]
    s_add_u32 s24, s24, 4096
    v_mfma_f32_16x16x32_bf16 v[220:223], v[112:115], v[76:79], v[220:223]
    v_mfma_f32_16x16x32_bf16 v[236:239], v[116:119], v[76:79], v[236:239]
    buffer_load_dwordx4 v[112:115], v3, s[4:7], s24 offen offset:0 sc1
    v_mfma_f32_16x16x32_bf16 v[232:235], v[116:119], v[72:75], v[232:235]
    v_mfma_f32_16x16x32_bf16 v[228:231], v[116:119], v[68:71], v[228:231]
    v_mfma_f32_16x16x32_bf16 v[224:227], v[116:119], v[64:67], v[224:227]
    s_waitcnt vmcnt(21) lgkmcnt(1)
    v_mfma_f32_16x16x32_bf16 v[176:179], v[120:123], v[80:83], v[176:179]
    buffer_load_dwordx4 v[116:119], v3, s[4:7], s24 offen offset:1024 sc1
    v_mfma_f32_16x16x32_bf16 v[180:183], v[120:123], v[84:87], v[180:183]
    s_waitcnt lgkmcnt(0)
    v_readfirstlane_b32 s3, v63
    s_nop 0
    s_cmp_ge_u32 s3, 4
    s_cbranch_scc1 L_hok_43
    s_mov_b32 s26, 0
L_lw_44:
    ds_read_b32 v14, v13 offset:88
    s_waitcnt lgkmcnt(0)
    v_readfirstlane_b32 s3, v14
    s_nop 0
    s_cmp_ge_u32 s3, 4
    s_cbranch_scc1 L_lwdone_45
    s_add_u32 s26, s26, 1
    s_cmp_lt_u32 s26, 1000000
    s_cbranch_scc1 L_lw_44
L_lwdone_45:
L_hok_43:
    v_mfma_f32_16x16x32_bf16 v[184:187], v[120:123], v[88:91], v[184:187]
    ds_read_b128 v[64:67], v3 offset:57344
    v_mfma_f32_16x16x32_bf16 v[188:191], v[120:123], v[92:95], v[188:191]
    v_mfma_f32_16x16x32_bf16 v[204:207], v[124:127], v[92:95], v[204:207]
    buffer_load_dwordx4 v[120:123], v3, s[4:7], s24 offen offset:2048 sc1
    v_mfma_f32_16x16x32_bf16 v[200:203], v[124:127], v[88:91], v[200:203]
    ds_read_b128 v[68:71], v3 offset:58368
    v_mfma_f32_16x16x32_bf16 v[196:199], v[124:127], v[84:87], v[196:199]
    ds_read_b128 v[72:75], v3 offset:59392
    v_mfma_f32_16x16x32_bf16 v[192:195], v[124:127], v[80:83], v[192:195]
    s_waitcnt vmcnt(21)
    v_mfma_f32_16x16x32_bf16 v[208:211], v[128:131], v[80:83], v[208:211]
    buffer_load_dwordx4 v[124:127], v3, s[4:7], s24 offen offset:3072 sc1
    v_mfma_f32_16x16x32_bf16 v[212:215], v[128:131], v[84:87], v[212:215]
    ds_read_b128 v[76:79], v3 offset:60416
    v_mfma_f32_16x16x32_bf16 v[216:219], v[128:131], v[88:91], v[216:219]
    s_add_u32 s24, s24, 4096
    v_mfma_f32_16x16x32_bf16 v[220:223], v[128:131], v[92:95], v[220:223]
    v_mfma_f32_16x16x32_bf16 v[236:239], v[132:135], v[92:95], v[236:239]
    buffer_load_dwordx4 v[128:131], v3, s[4:7], s24 offen offset:0 sc1
    v_mfma_f32_16x16x32_bf16 v[232:235], v[132:135], v[88:91], v[232:235]
    v_mfma_f32_16x16x32_bf16 v[228:231], v[132:135], v[84:87], v[228:231]
    v_mfma_f32_16x16x32_bf16 v[224:227], v[132:135], v[80:83], v[224:227]
    s_waitcnt vmcnt(21) lgkmcnt(0)
    v_mfma_f32_16x16x32_bf16 v[176:179], v[160:163], v[64:67], v[176:179]
    buffer_load_dwordx4 v[132:135], v3, s[4:7], s24 offen offset:1024 sc1
    v_mfma_f32_16x16x32_bf16 v[180:183], v[160:163], v[68:71], v[180:183]
    ds_read_b128 v[80:83], v3 offset:61440
    v_mfma_f32_16x16x32_bf16 v[184:187], v[160:163], v[72:75], v[184:187]
    ds_read_b128 v[84:87], v3 offset:62464
    v_mfma_f32_16x16x32_bf16 v[188:191], v[160:163], v[76:79], v[188:191]
    v_mfma_f32_16x16x32_bf16 v[204:207], v[164:167], v[76:79], v[204:207]
    buffer_load_dwordx4 v[160:163], v3, s[4:7], s24 offen offset:2048 sc1
    v_mfma_f32_16x16x32_bf16 v[200:203], v[164:167], v[72:75], v[200:203]
    ds_read_b128 v[88:91], v3 offset:63488
    v_mfma_f32_16x16x32_bf16 v[196:199], v[164:167], v[68:71], v[196:199]
    ds_read_b128 v[92:95], v3 offset:64512
    v_mfma_f32_16x16x32_bf16 v[192:195], v[164:167], v[64:67], v[192:195]
    s_waitcnt vmcnt(21)
    v_mfma_f32_16x16x32_bf16 v[208:211], v[168:171], v[64:67], v[208:211]
    buffer_load_dwordx4 v[164:167], v3, s[4:7], s24 offen offset:3072 sc1
    v_mfma_f32_16x16x32_bf16 v[212:215], v[168:171], v[68:71], v[212:215]
    v_mfma_f32_16x16x32_bf16 v[216:219], v[168:171], v[72:75], v[216:219]
    s_add_u32 s24, s24, 4096
    v_mfma_f32_16x16x32_bf16 v[220:223], v[168:171], v[76:79], v[220:223]
    v_mfma_f32_16x16x32_bf16 v[236:239], v[172:175], v[76:79], v[236:239]
    buffer_load_dwordx4 v[168:171], v3, s[4:7], s24 offen offset:0 sc1
    v_mfma_f32_16x16x32_bf16 v[232:235], v[172:175], v[72:75], v[232:235]
    v_mfma_f32_16x16x32_bf16 v[228:231], v[172:175], v[68:71], v[228:231]
    v_mfma_f32_16x16x32_bf16 v[224:227], v[172:175], v[64:67], v[224:227]
    s_waitcnt vmcnt(21) lgkmcnt(0)
    v_mfma_f32_16x16x32_bf16 v[176:179], v[240:243], v[80:83], v[176:179]
    buffer_load_dwordx4 v[172:175], v3, s[4:7], s24 offen offset:1024 sc1
    v_mfma_f32_16x16x32_bf16 v[180:183], v[240:243], v[84:87], v[180:183]
    ds_read_b128 v[64:67], v5 offset:16384
    v_mfma_f32_16x16x32_bf16 v[184:187], v[240:243], v[88:91], v[184:187]
    ds_read_b128 v[68:71], v5 offset:17408
    v_mfma_f32_16x16x32_bf16 v[188:191], v[240:243], v[92:95], v[188:191]
    v_mfma_f32_16x16x32_bf16 v[204:207], v[244:247], v[92:95], v[204:207]
    buffer_load_dwordx4 v[240:243], v3, s[4:7], s24 offen offset:2048 sc1
    v_mfma_f32_16x16x32_bf16 v[200:203], v[244:247], v[88:91], v[200:203]
    ds_read_b128 v[72:75], v5 offset:18432
    v_mfma_f32_16x16x32_bf16 v[196:199], v[244:247], v[84:87], v[196:199]
    ds_read_b128 v[76:79], v5 offset:19456
    v_mfma_f32_16x16x32_bf16 v[192:195], v[244:247], v[80:83], v[192:195]
    s_waitcnt vmcnt(21)
    v_mfma_f32_16x16x32_bf16 v[208:211], v[248:251], v[80:83], v[208:211]
    buffer_load_dwordx4 v[244:247], v3, s[4:7], s24 offen offset:3072 sc1
    v_mfma_f32_16x16x32_bf16 v[212:215], v[248:251], v[84:87], v[212:215]
    v_mfma_f32_16x16x32_bf16 v[216:219], v[248:251], v[88:91], v[216:219]
    s_add_u32 s24, s24, 4096
    v_mfma_f32_16x16x32_bf16 v[220:223], v[248:251], v[92:95], v[220:223]
    v_mfma_f32_16x16x32_bf16 v[236:239], v[252:255], v[92:95], v[236:239]
    buffer_load_dwordx4 v[248:251], v3, s[4:7], s24 offen offset:0 sc1
    v_mfma_f32_16x16x32_bf16 v[232:235], v[252:255], v[88:91], v[232:235]
    v_mfma_f32_16x16x32_bf16 v[228:231], v[252:255], v[84:87], v[228:231]
    v_mfma_f32_16x16x32_bf16 v[224:227], v[252:255], v[80:83], v[224:227]
    s_waitcnt vmcnt(21) lgkmcnt(0)
    v_mfma_f32_16x16x32_bf16 v[176:179], v[136:139], v[64:67], v[176:179]
    buffer_load_dwordx4 v[252:255], v3, s[4:7], s24 offen offset:1024 sc1
    v_mfma_f32_16x16x32_bf16 v[180:183], v[136:139], v[68:71], v[180:183]
    ds_read_b128 v[80:83], v5 offset:20480
    v_mfma_f32_16x16x32_bf16 v[184:187], v[136:139], v[72:75], v[184:187]
    ds_read_b128 v[84:87], v5 offset:21504
    v_mfma_f32_16x16x32_bf16 v[188:191], v[136:139], v[76:79], v[188:191]
    v_mfma_f32_16x16x32_bf16 v[204:207], v[140:143], v[76:79], v[204:207]
    buffer_load_dwordx4 v[136:139], v3, s[4:7], s24 offen offset:2048 sc1
    v_mfma_f32_16x16x32_bf16 v[200:203], v[140:143], v[72:75], v[200:203]
    ds_read_b128 v[88:91], v5 offset:22528
    v_mfma_f32_16x16x32_bf16 v[196:199], v[140:143], v[68:71], v[196:199]
    ds_read_b128 v[92:95], v5 offset:23552
    v_mfma_f32_16x16x32_bf16 v[192:195], v[140:143], v[64:67], v[192:195]
    s_waitcnt vmcnt(21)
    v_mfma_f32_16x16x32_bf16 v[208:211], v[144:147], v[64:67], v[208:211]
    buffer_load_dwordx4 v[140:143], v3, s[4:7], s24 offen offset:3072 sc1
    v_mfma_f32_16x16x32_bf16 v[212:215], v[144:147], v[68:71], v[212:215]
    v_mfma_f32_16x16x32_bf16 v[216:219], v[144:147], v[72:75], v[216:219]
    s_add_u32 s24, s24, 4096
    v_mfma_f32_16x16x32_bf16 v[220:223], v[144:147], v[76:79], v[220:223]
    v_mfma_f32_16x16x32_bf16 v[236:239], v[148:151], v[76:79], v[236:239]
    buffer_load_dwordx4 v[144:147], v3, s[4:7], s24 offen offset:0 sc1
    v_mfma_f32_16x16x32_bf16 v[232:235], v[148:151], v[72:75], v[232:235]
    v_mfma_f32_16x16x32_bf16 v[228:231], v[148:151], v[68:71], v[228:231]
    v_mfma_f32_16x16x32_bf16 v[224:227], v[148:151], v[64:67], v[224:227]
    s_waitcnt vmcnt(21) lgkmcnt(0)
    v_mfma_f32_16x16x32_bf16 v[176:179], v[152:155], v[80:83], v[176:179]
    buffer_load_dwordx4 v[148:151], v3, s[4:7], s24 offen offset:1024 sc1
    v_mfma_f32_16x16x32_bf16 v[180:183], v[152:155], v[84:87], v[180:183]
    ds_read_b64 v[64:65], v6 offset:0
    v_mfma_f32_16x16x32_bf16 v[184:187], v[152:155], v[88:91], v[184:187]
    ds_read_b64 v[68:69], v6 offset:512
    v_mfma_f32_16x16x32_bf16 v[188:191], v[152:155], v[92:95], v[188:191]
    v_mfma_f32_16x16x32_bf16 v[204:207], v[156:159], v[92:95], v[204:207]
    buffer_load_dwordx4 v[152:155], v3, s[4:7], s24 offen offset:2048 sc1
    v_mfma_f32_16x16x32_bf16 v[200:203], v[156:159], v[88:91], v[200:203]
    ds_read_b64 v[72:73], v6 offset:1024
    v_mfma_f32_16x16x32_bf16 v[196:199], v[156:159], v[84:87], v[196:199]
    ds_read_b64 v[76:77], v6 offset:1536
    v_mfma_f32_16x16x32_bf16 v[192:195], v[156:159], v[80:83], v[192:195]
    s_waitcnt vmcnt(21)
    v_mfma_f32_16x16x32_bf16 v[208:211], v[96:99], v[80:83], v[208:211]
    buffer_load_dwordx4 v[156:159], v3, s[4:7], s24 offen offset:3072 sc1
    v_mfma_f32_16x16x32_bf16 v[212:215], v[96:99], v[84:87], v[212:215]
    ds_read_b32 v63, v13 offset:92
    v_mfma_f32_16x16x32_bf16 v[216:219], v[96:99], v[88:91], v[216:219]
    s_add_u32 s24, s24, 4096
    v_mfma_f32_16x16x32_bf16 v[220:223], v[96:99], v[92:95], v[220:223]
    v_mfma_f32_16x16x32_bf16 v[236:239], v[100:103], v[92:95], v[236:239]
    buffer_load_dwordx4 v[96:99], v3, s[4:7], s24 offen offset:0 sc1
    v_mfma_f32_16x16x32_bf16 v[232:235], v[100:103], v[88:91], v[232:235]
    v_mfma_f32_16x16x32_bf16 v[228:231], v[100:103], v[84:87], v[228:231]
    v_mfma_f32_16x16x32_bf16 v[224:227], v[100:103], v[80:83], v[224:227]
    s_waitcnt vmcnt(21) lgkmcnt(1)
    v_mfma_f32_16x16x16_bf16 v[176:179], v[104:105], v[64:65], v[176:179]
    buffer_load_dwordx4 v[100:103], v3, s[4:7], s24 offen offset:1024 sc1
    v_mfma_f32_16x16x16_bf16 v[180:183], v[104:105], v[68:69], v[180:183]
    s_waitcnt lgkmcnt(0)
    v_readfirstlane_b32 s3, v63
    s_nop 0
    s_cmp_ge_u32 s3, 4
    s_cbranch_scc1 L_hok_46
    s_mov_b32 s26, 0
L_lw_47:
    ds_read_b32 v14, v13 offset:92
    s_waitcnt lgkmcnt(0)
    v_readfirstlane_b32 s3, v14
    s_nop 0
    s_cmp_ge_u32 s3, 4
    s_cbranch_scc1 L_lwdone_48
    s_add_u32 s26, s26, 1
    s_cmp_lt_u32 s26, 1000000
    s_cbranch_scc1 L_lw_47
L_lwdone_48:
L_hok_46:
    v_mfma_f32_16x16x16_bf16 v[184:187], v[104:105], v[72:73], v[184:187]
    ds_read_b128 v[80:83], v4 offset:0
    v_mfma_f32_16x16x16_bf16 v[188:191], v[104:105], v[76:77], v[188:191]
    v_mfma_f32_16x16x16_bf16 v[204:207], v[106:107], v[76:77], v[204:207]
    ds_read_b128 v[84:87], v4 offset:1024
    v_mfma_f32_16x16x16_bf16 v[200:203], v[106:107], v[72:73], v[200:203]
    ds_read_b128 v[88:91], v4 offset:2048
    v_mfma_f32_16x16x16_bf16 v[196:199], v[106:107], v[68:69], v[196:199]
    ds_read_b128 v[92:95], v4 offset:3072
    v_mfma_f32_16x16x16_bf16 v[192:195], v[106:107], v[64:65], v[192:195]
    s_waitcnt vmcnt(21)
    v_mfma_f32_16x16x16_bf16 v[208:211], v[108:109], v[64:65], v[208:211]
    buffer_load_dwordx4 v[104:107], v3, s[4:7], s24 offen offset:2048 sc1
    v_mfma_f32_16x16x16_bf16 v[212:215], v[108:109], v[68:69], v[212:215]
    v_mfma_f32_16x16x16_bf16 v[216:219], v[108:109], v[72:73], v[216:219]
    v_mfma_f32_16x16x16_bf16 v[220:223], v[108:109], v[76:77], v[220:223]
    v_mfma_f32_16x16x16_bf16 v[236:239], v[110:111], v[76:77], v[236:239]
    v_mfma_f32_16x16x16_bf16 v[232:235], v[110:111], v[72:73], v[232:235]
    v_mfma_f32_16x16x16_bf16 v[228:231], v[110:111], v[68:69], v[228:231]
    v_mfma_f32_16x16x16_bf16 v[224:227], v[110:111], v[64:65], v[224:227]
    s_waitcnt vmcnt(21) lgkmcnt(0)
    v_mfma_f32_16x16x32_bf16 v[176:179], v[112:115], v[80:83], v[176:179]
    buffer_load_dwordx4 v[108:111], v3, s[4:7], s24 offen offset:3072 sc1
    v_mfma_f32_16x16x32_bf16 v[180:183], v[112:115], v[84:87], v[180:183]
    ds_read_b128 v[64:67], v4 offset:4096
    v_mfma_f32_16x16x32_bf16 v[184:187], v[112:115], v[88:91], v[184:187]
    s_add_u32 s24, s24, 4096
    v_mfma_f32_16x16x32_bf16 v[188:191], v[112:115], v[92:95], v[188:191]
    v_mfma_f32_16x16x32_bf16 v[204:207], v[116:119], v[92:95], v[204:207]
    buffer_load_dwordx4 v[112:115], v3, s[4:7], s24 offen offset:0 sc1
    v_mfma_f32_16x16x32_bf16 v[200:203], v[116:119], v[88:91], v[200:203]
    ds_read_b128 v[68:71], v4 offset:5120
    v_mfma_f32_16x16x32_bf16 v[196:199], v[116:119], v[84:87], v[196:199]
    ds_read_b128 v[72:75], v4 offset:6144
    v_mfma_f32_16x16x32_bf16 v[192:195], v[116:119], v[80:83], v[192:195]
    s_waitcnt vmcnt(21)
    v_mfma_f32_16x16x32_bf16 v[208:211], v[120:123], v[80:83], v[208:211]
    buffer_load_dwordx4 v[116:119], v3, s[4:7], s24 offen offset:1024 sc1
    v_mfma_f32_16x16x32_bf16 v[212:215], v[120:123], v[84:87], v[212:215]
    ds_read_b128 v[76:79], v4 offset:7168
    v_mfma_f32_16x16x32_bf16 v[216:219], v[120:123], v[88:91], v[216:219]
    v_mfma_f32_16x16x32_bf16 v[220:223], v[120:123], v[92:95], v[220:223]
    v_mfma_f32_16x16x32_bf16 v[236:239], v[124:127], v[92:95], v[236:239]
    buffer_load_dwordx4 v[120:123], v3, s[4:7], s24 offen offset:2048 sc1
    v_mfma_f32_16x16x32_bf16 v[232:235], v[124:127], v[88:91], v[232:235]
    v_mfma_f32_16x16x32_bf16 v[228:231], v[124:127], v[84:87], v[228:231]
    v_mfma_f32_16x16x32_bf16 v[224:227], v[124:127], v[80:83], v[224:227]
    s_waitcnt vmcnt(21) lgkmcnt(0)
    v_mfma_f32_16x16x32_bf16 v[176:179], v[128:131], v[64:67], v[176:179]
    buffer_load_dwordx4 v[124:127], v3, s[4:7], s24 offen offset:3072 sc1
    v_mfma_f32_16x16x32_bf16 v[180:183], v[128:131], v[68:71], v[180:183]
    v_mfma_f32_16x16x32_bf16 v[184:187], v[128:131], v[72:75], v[184:187]
    s_add_u32 s24, s24, 4096
    v_mfma_f32_16x16x32_bf16 v[188:191], v[128:131], v[76:79], v[188:191]
    v_mfma_f32_16x16x32_bf16 v[204:207], v[132:135], v[76:79], v[204:207]
    buffer_load_dwordx4 v[128:131], v3, s[4:7], s24 offen offset:0 sc1
    v_mfma_f32_16x16x32_bf16 v[200:203], v[132:135], v[72:75], v[200:203]
    v_mfma_f32_16x16x32_bf16 v[196:199], v[132:135], v[68:71], v[196:199]
    v_mfma_f32_16x16x32_bf16 v[192:195], v[132:135], v[64:67], v[192:195]
    s_waitcnt vmcnt(21)
    v_mfma_f32_16x16x32_bf16 v[208:211], v[160:163], v[64:67], v[208:211]
    buffer_load_dwordx4 v[132:135], v3, s[4:7], s24 offen offset:1024 sc1
    v_mfma_f32_16x16x32_bf16 v[212:215], v[160:163], v[68:71], v[212:215]
    v_mfma_f32_16x16x32_bf16 v[216:219], v[160:163], v[72:75], v[216:219]
    v_mfma_f32_16x16x32_bf16 v[220:223], v[160:163], v[76:79], v[220:223]
    v_mfma_f32_16x16x32_bf16 v[236:239], v[164:167], v[76:79], v[236:239]
    buffer_load_dwordx4 v[160:163], v3, s[4:7], s24 offen offset:2048 sc1
    v_mfma_f32_16x16x32_bf16 v[232:235], v[164:167], v[72:75], v[232:235]
    v_mfma_f32_16x16x32_bf16 v[228:231], v[164:167], v[68:71], v[228:231]
    v_mfma_f32_16x16x32_bf16 v[224:227], v[164:167], v[64:67], v[224:227]
    buffer_load_dwordx4 v[164:167], v3, s[4:7], s24 offen offset:3072 sc1
    s_setprio 0
    s_barrier
    s_and_b32 s31, s23, 3
    v_lshrrev_b32 v16, 2, v1
    v_cmp_eq_u32 vcc, s31, v16
    v_mov_b32 v17, 0x40000000
    s_cmp_lt_u32 s23, 4
    s_cselect_b64 s[84:85], vcc, 0
    s_cselect_b64 s[86:87], 0, vcc
    v_cndmask_b32 v9, v9, v17, s[84:85]
    v_cndmask_b32 v10, v10, v17, s[86:87]
    s_lshl_b32 s31, s21, 8
    s_add_u32 s31, s31, 73728
    v_and_b32 v16, 3, v0
    v_lshl_add_u32 v16, v2, 2, v16
    v_lshl_add_u32 v16, v16, 4, s31
    v_add_u32 v17, 90112, v3
    v_cndmask_b32 v42, v17, v16, s[84:85]
    v_cndmask_b32 v43, v17, v16, s[86:87]
    s_setprio 0
    s_add_u32 s88, s21, 4
    s_cmp_eq_u32 s21, 3
    s_cselect_b32 s90, 2, 1
    s_mul_i32 s90, s90, 256
    s_mov_b32 s25, 0
    v_cvt_pk_bf16_f32 v16, v176, v177
    v_cvt_pk_bf16_f32 v17, v178, v179
    v_cvt_pk_bf16_f32 v18, v180, v181
    v_cvt_pk_bf16_f32 v19, v182, v183
    buffer_store_dwordx4 v[16:19], v9, s[4:7], s25 offen sc1
    ds_write_b128 v42, v[16:19] offset:0
    v_cvt_pk_bf16_f32 v20, v184, v185
    v_cvt_pk_bf16_f32 v21, v186, v187
    v_cvt_pk_bf16_f32 v22, v188, v189
    v_cvt_pk_bf16_f32 v23, v190, v191
    buffer_store_dwordx4 v[20:23], v10, s[4:7], s25 offen sc1
    ds_write_b128 v43, v[20:23] offset:0
    v_and_b32 v48, 3, v1
    v_cmp_eq_u32 vcc, v48, v2
    v_bfe_u32 v48, v1, 2, 1
    v_lshrrev_b32 v49, 3, v1
    v_lshl_add_u32 v48, v48, 1, v49
    v_cndmask_b32 v48, 7, v48, vcc
    v_mov_b32 v49, 0x3f80
    v_cmp_eq_u32 vcc, 0, v48
    s_nop 1
    v_cndmask_b32 v32, 0, v49, vcc
    v_lshlrev_b32 v36, 16, v32
    v_cmp_eq_u32 vcc, 1, v48
    s_nop 1
    v_cndmask_b32 v33, 0, v49, vcc
    v_lshlrev_b32 v37, 16, v33
    v_cmp_eq_u32 vcc, 2, v48
    s_nop 1
    v_cndmask_b32 v34, 0, v49, vcc
    v_lshlrev_b32 v38, 16, v34
    v_cmp_eq_u32 vcc, 3, v48
    s_nop 1
    v_cndmask_b32 v35, 0, v49, vcc
    v_lshlrev_b32 v39, 16, v35
    s_waitcnt vmcnt(1)
    s_mov_b32 s25, 65536
    v_cvt_pk_bf16_f32 v24, v192, v193
    v_cvt_pk_bf16_f32 v25, v194, v195
    v_cvt_pk_bf16_f32 v26, v196, v197
    v_cvt_pk_bf16_f32 v27, v198, v199
    buffer_store_dwordx4 v[24:27], v9, s[4:7], s25 offen sc1
    ds_write_b128 v42, v[24:27] offset:1024
    s_waitcnt vmcnt(1)
    v_cvt_pk_bf16_f32 v28, v200, v201
    v_cvt_pk_bf16_f32 v29, v202, v203
    v_cvt_pk_bf16_f32 v30, v204, v205
    v_cvt_pk_bf16_f32 v31, v206, v207
    buffer_store_dwordx4 v[28:31], v10, s[4:7], s25 offen sc1
    ds_write_b128 v43, v[28:31] offset:1024
    s_waitcnt vmcnt(1)
    s_mov_b32 s25, 131072
    v_cvt_pk_bf16_f32 v16, v208, v209
    v_cvt_pk_bf16_f32 v17, v210, v211
    v_cvt_pk_bf16_f32 v18, v212, v213
    v_cvt_pk_bf16_f32 v19, v214, v215
    buffer_store_dwordx4 v[16:19], v9, s[4:7], s25 offen sc1
    ds_write_b128 v42, v[16:19] offset:2048
    s_waitcnt vmcnt(1)
    v_cvt_pk_bf16_f32 v20, v216, v217
    v_cvt_pk_bf16_f32 v21, v218, v219
    v_cvt_pk_bf16_f32 v22, v220, v221
    v_cvt_pk_bf16_f32 v23, v222, v223
    buffer_store_dwordx4 v[20:23], v10, s[4:7], s25 offen sc1
    ds_write_b128 v43, v[20:23] offset:2048
    s_waitcnt vmcnt(1)
    s_mov_b32 s25, 196608
    v_cvt_pk_bf16_f32 v24, v224, v225
    v_cvt_pk_bf16_f32 v25, v226, v227
    v_cvt_pk_bf16_f32 v26, v228, v229
    v_cvt_pk_bf16_f32 v27, v230, v231
    buffer_store_dwordx4 v[24:27], v9, s[4:7], s25 offen sc1
    ds_write_b128 v42, v[24:27] offset:3072
    s_waitcnt vmcnt(1)
    v_cvt_pk_bf16_f32 v28, v232, v233
    v_cvt_pk_bf16_f32 v29, v234, v235
    v_cvt_pk_bf16_f32 v30, v236, v237
    v_cvt_pk_bf16_f32 v31, v238, v239
    buffer_store_dwordx4 v[28:31], v10, s[4:7], s25 offen sc1
    ds_write_b128 v43, v[28:31] offset:3072
    v_bfe_u32 v52, v0, 2, 2
    v_lshrrev_b32 v53, 5, v0
    v_lshl_add_u32 v52, v52, 1, v53
    s_lshl_b32 s33, s88, 3
    v_add_u32 v52, s33, v52
    s_and_b32 s33, s23, 3
    s_lshl_b32 s33, s33, 2
    v_and_b32 v53, 3, v0
    v_add_u32 v53, s33, v53
    s_lshr_b32 s33, s23, 2
    s_lshl_b32 s33, s33, 1
    s_lshl2_add_u32 s33, s22, s33
    v_and_b32 v54, 1, v2
    v_add_u32 v54, s33, v54
    v_lshl_add_u32 v55, v54, 4, v53
    v_mul_u32_u24 v55, 1152, v55
    v_lshl_add_u32 v40, v52, 4, v55
    buffer_load_dwordx4 v[208:211], v40, s[8:11], 0 offen
    v_mul_u32_u24 v55, 57, v52
    v_lshrrev_b32 v55, 9, v55
    v_mul_u32_u24 v56, 9, v55
    v_sub_u32 v56, v52, v56
    v_cmp_eq_u32 vcc, 8, v56
    v_and_b32 v57, 1, v56
    v_lshl_add_u32 v57, v55, 1, v57
    v_lshrrev_b32 v58, 1, v56
    v_lshl_add_u32 v57, v57, 2, v58
    v_lshl_add_u32 v57, v57, 4, v53
    v_lshlrev_b32 v57, 4, v57
    v_lshl_add_u32 v58, v55, 5, v53
    v_lshlrev_b32 v58, 3, v58
    v_add_u32 v58, 16384, v58
    v_cndmask_b32 v57, v57, v58, vcc
    v_mov_b32 v59, 0x80
    v_cndmask_b32 v59, 8, v59, vcc
    v_mul_u32_u24 v54, 18432, v54
    v_add_u32 v49, v57, v54
    v_add_u32 v50, v49, v59
    s_mov_b32 s33, 5767168
    buffer_load_dwordx2 v[212:213], v49, s[4:7], s33 offen sc1
    buffer_load_dwordx2 v[214:215], v50, s[4:7], s33 offen sc1
    s_waitcnt vmcnt(4)
    s_mul_i32 s31, s22, 1024
    s_add_u32 s31, s31, 12
    s_waitcnt vmcnt(3)
    s_mov_b64 exec, 1
    ds_add_rtn_u32 v14, v13, v12 offset:128
    s_mov_b64 exec, -1
    s_waitcnt lgkmcnt(0)
    v_readfirstlane_b32 s3, v14
    s_nop 0
    s_cmp_lg_u32 s3, 3
    s_cbranch_scc1 L_arr_49
    s_mov_b32 s1, 1
    s_atomic_add s1, s[44:45], s31
L_arr_49:
    ds_read_b128 v[64:67], v3 offset:0
    ds_read_b128 v[68:71], v3 offset:1024
    ds_read_b128 v[72:75], v3 offset:2048
    ds_read_b128 v[76:79], v3 offset:3072
    s_barrier
    s_setprio 1
    ds_read_b128 v[80:83], v3 offset:4096
    ds_read_b128 v[84:87], v3 offset:5120
    ds_read_b128 v[88:91], v3 offset:6144
    ds_read_b128 v[92:95], v3 offset:7168
    s_waitcnt lgkmcnt(4)
    v_mfma_f32_16x16x32_bf16 v[176:179], v[168:171], v[64:67], 0
    ds_read_b128 v[224:227], v3 offset:8192
    ds_read_b128 v[228:231], v3 offset:9216
    v_mfma_f32_16x16x32_bf16 v[180:183], v[168:171], v[68:71], 0
    ds_read_b128 v[232:235], v3 offset:10240
    ds_read_b128 v[236:239], v3 offset:11264
    v_mfma_f32_16x16x32_bf16 v[184:187], v[168:171], v[72:75], 0
    s_add_u32 s24, s24, 4096
    v_mfma_f32_16x16x32_bf16 v[188:191], v[168:171], v[76:79], 0
    v_mfma_f32_16x16x32_bf16 v[204:207], v[172:175], v[76:79], 0
    buffer_load_dwordx4 v[168:171], v3, s[4:7], s24 offen offset:0 sc1
    v_mfma_f32_16x16x32_bf16 v[200:203], v[172:175], v[72:75], 0
    v_mfma_f32_16x16x32_bf16 v[196:199], v[172:175], v[68:71], 0
    v_mfma_f32_16x16x32_bf16 v[192:195], v[172:175], v[64:67], 0
    s_waitcnt lgkmcnt(4)
    v_mfma_f32_16x16x32_bf16 v[176:179], v[240:243], v[80:83], v[176:179]
    buffer_load_dwordx4 v[172:175], v3, s[4:7], s24 offen offset:1024 sc1
    v_mfma_f32_16x16x32_bf16 v[180:183], v[240:243], v[84:87], v[180:183]
    ds_read_b128 v[64:67], v3 offset:12288
    ds_read_b128 v[68:71], v3 offset:13312
    v_mfma_f32_16x16x32_bf16 v[184:187], v[240:243], v[88:91], v[184:187]
    ds_read_b128 v[72:75], v3 offset:14336
    ds_read_b128 v[76:79], v3 offset:15360
    v_mfma_f32_16x16x32_bf16 v[188:191], v[240:243], v[92:95], v[188:191]
    v_mfma_f32_16x16x32_bf16 v[204:207], v[244:247], v[92:95], v[204:207]
    buffer_load_dwordx4 v[240:243], v3, s[4:7], s24 offen offset:2048 sc1
    v_mfma_f32_16x16x32_bf16 v[200:203], v[244:247], v[88:91], v[200:203]
    v_mfma_f32_16x16x32_bf16 v[196:199], v[244:247], v[84:87], v[196:199]
    v_mfma_f32_16x16x32_bf16 v[192:195], v[244:247], v[80:83], v[192:195]
    s_waitcnt lgkmcnt(4)
    v_mfma_f32_16x16x32_bf16 v[176:179], v[248:251], v[224:227], v[176:179]
    buffer_load_dwordx4 v[244:247], v3, s[4:7], s24 offen offset:3072 sc1
    v_mfma_f32_16x16x32_bf16 v[180:183], v[248:251], v[228:231], v[180:183]
    ds_read_b128 v[80:83], v3 offset:16384
    ds_read_b128 v[84:87], v3 offset:17408
    v_mfma_f32_16x16x32_bf16 v[184:187], v[248:251], v[232:235], v[184:187]
    s_add_u32 s24, s24, 4096
    v_mfma_f32_16x16x32_bf16 v[188:191], v[248:251], v[236:239], v[188:191]
    v_mfma_f32_16x16x32_bf16 v[204:207], v[252:255], v[236:239], v[204:207]
    buffer_load_dwordx4 v[248:251], v3, s[4:7], s24 offen offset:0 sc1
    v_mfma_f32_16x16x32_bf16 v[200:203], v[252:255], v[232:235], v[200:203]
    ds_read_b128 v[88:91], v3 offset:18432
    ds_read_b128 v[92:95], v3 offset:19456
    v_mfma_f32_16x16x32_bf16 v[196:199], v[252:255], v[228:231], v[196:199]
    v_mfma_f32_16x16x32_bf16 v[192:195], v[252:255], v[224:227], v[192:195]
    s_waitcnt lgkmcnt(4)
    v_mfma_f32_16x16x32_bf16 v[176:179], v[136:139], v[64:67], v[176:179]
    buffer_load_dwordx4 v[252:255], v3, s[4:7], s24 offen offset:1024 sc1
    v_mfma_f32_16x16x32_bf16 v[180:183], v[136:139], v[68:71], v[180:183]
    ds_read_b128 v[224:227], v3 offset:20480
    ds_read_b128 v[228:231], v3 offset:21504
    v_mfma_f32_16x16x32_bf16 v[184:187], v[136:139], v[72:75], v[184:187]
    ds_read_b128 v[232:235], v3 offset:22528
    ds_read_b128 v[236:239], v3 offset:23552
    v_mfma_f32_16x16x32_bf16 v[188:191], v[136:139], v[76:79], v[188:191]
    v_mfma_f32_16x16x32_bf16 v[204:207], v[140:143], v[76:79], v[204:207]
    buffer_load_dwordx4 v[136:139], v3, s[4:7], s24 offen offset:2048 sc1
    v_mfma_f32_16x16x32_bf16 v[200:203], v[140:143], v[72:75], v[200:203]
    v_mfma_f32_16x16x32_bf16 v[196:199], v[140:143], v[68:71], v[196:199]
    v_mfma_f32_16x16x32_bf16 v[192:195], v[140:143], v[64:67], v[192:195]
    s_waitcnt lgkmcnt(4)
    v_mfma_f32_16x16x32_bf16 v[176:179], v[144:147], v[80:83], v[176:179]
    buffer_load_dwordx4 v[140:143], v3, s[4:7], s24 offen offset:3072 sc1
    v_mfma_f32_16x16x32_bf16 v[180:183], v[144:147], v[84:87], v[180:183]
    ds_read_b128 v[64:67], v3 offset:24576
    ds_read_b128 v[68:71], v3 offset:25600
    v_mfma_f32_16x16x32_bf16 v[184:187], v[144:147], v[88:91], v[184:187]
    s_add_u32 s24, s24, 4096
    v_mfma_f32_16x16x32_bf16 v[188:191], v[144:147], v[92:95], v[188:191]
    v_mfma_f32_16x16x32_bf16 v[204:207], v[148:151], v[92:95], v[204:207]
    buffer_load_dwordx4 v[144:147], v3, s[4:7], s24 offen offset:0 sc1
    v_mfma_f32_16x16x32_bf16 v[200:203], v[148:151], v[88:91], v[200:203]
    ds_read_b128 v[72:75], v3 offset:26624
    ds_read_b128 v[76:79], v3 offset:27648
    v_mfma_f32_16x16x32_bf16 v[196:199], v[148:151], v[84:87], v[196:199]
    v_mfma_f32_16x16x32_bf16 v[192:195], v[148:151], v[80:83], v[192:195]
    s_waitcnt lgkmcnt(4)
    v_mfma_f32_16x16x32_bf16 v[176:179], v[152:155], v[224:227], v[176:179]
    buffer_load_dwordx4 v[148:151], v3, s[4:7], s24 offen offset:1024 sc1
    v_mfma_f32_16x16x32_bf16 v[180:183], v[152:155], v[228:231], v[180:183]
    ds_read_b128 v[80:83], v3 offset:28672
    ds_read_b128 v[84:87], v3 offset:29696
    v_mfma_f32_16x16x32_bf16 v[184:187], v[152:155], v[232:235], v[184:187]
    ds_read_b128 v[88:91], v3 offset:30720
    ds_read_b128 v[92:95], v3 offset:31744
    v_mfma_f32_16x16x32_bf16 v[188:191], v[152:155], v[236:239], v[188:191]
    v_mfma_f32_16x16x32_bf16 v[204:207], v[156:159], v[236:239], v[204:207]
    buffer_load_dwordx4 v[152:155], v3, s[4:7], s24 offen offset:2048 sc1
    v_mfma_f32_16x16x32_bf16 v[200:203], v[156:159], v[232:235], v[200:203]
    v_mfma_f32_16x16x32_bf16 v[196:199], v[156:159], v[228:231], v[196:199]
    v_mfma_f32_16x16x32_bf16 v[192:195], v[156:159], v[224:227], v[192:195]
    s_waitcnt lgkmcnt(4)
    v_mfma_f32_16x16x32_bf16 v[176:179], v[96:99], v[64:67], v[176:179]
    buffer_load_dwordx4 v[156:159], v3, s[4:7], s24 offen offset:3072 sc1
    v_mfma_f32_16x16x32_bf16 v[180:183], v[96:99], v[68:71], v[180:183]
    ds_read_b128 v[224:227], v3 offset:32768
    ds_read_b128 v[228:231], v3 offset:33792
    v_mfma_f32_16x16x32_bf16 v[184:187], v[96:99], v[72:75], v[184:187]
    s_add_u32 s24, s24, 4096
    v_mfma_f32_16x16x32_bf16 v[188:191], v[96:99], v[76:79], v[188:191]
    v_mfma_f32_16x16x32_bf16 v[204:207], v[100:103], v[76:79], v[204:207]
    buffer_load_dwordx4 v[96:99], v3, s[4:7], s24 offen offset:0 sc1
    v_mfma_f32_16x16x32_bf16 v[200:203], v[100:103], v[72:75], v[200:203]
    ds_read_b128 v[232:235], v3 offset:34816
    ds_read_b128 v[236:239], v3 offset:35840
    v_mfma_f32_16x16x32_bf16 v[196:199], v[100:103], v[68:71], v[196:199]
    v_mfma_f32_16x16x32_bf16 v[192:195], v[100:103], v[64:67], v[192:195]
    s_waitcnt lgkmcnt(4)
    v_mfma_f32_16x16x32_bf16 v[176:179], v[104:107], v[80:83], v[176:179]
    buffer_load_dwordx4 v[100:103], v3, s[4:7], s24 offen offset:1024 sc1
    v_mfma_f32_16x16x32_bf16 v[180:183], v[104:107], v[84:87], v[180:183]
    ds_read_b128 v[64:67], v3 offset:36864
    ds_read_b128 v[68:71], v3 offset:37888
    v_mfma_f32_16x16x32_bf16 v[184:187], v[104:107], v[88:91], v[184:187]
    ds_read_b128 v[72:75], v3 offset:38912
    ds_read_b128 v[76:79], v3 offset:39936
    v_mfma_f32_16x16x32_bf16 v[188:191], v[104:107], v[92:95], v[188:191]
    v_mfma_f32_16x16x32_bf16 v[204:207], v[108:111], v[92:95], v[204:207]
    buffer_load_dwordx4 v[104:107], v3, s[4:7], s24 offen offset:2048 sc1
    v_mfma_f32_16x16x32_bf16 v[200:203], v[108:111], v[88:91], v[200:203]
    v_mfma_f32_16x16x32_bf16 v[196:199], v[108:111], v[84:87], v[196:199]
    v_mfma_f32_16x16x32_bf16 v[192:195], v[108:111], v[80:83], v[192:195]
    s_waitcnt lgkmcnt(4)
    v_mfma_f32_16x16x32_bf16 v[176:179], v[112:115], v[224:227], v[176:179]
    buffer_load_dwordx4 v[108:111], v3, s[4:7], s24 offen offset:3072 sc1
    v_mfma_f32_16x16x32_bf16 v[180:183], v[112:115], v[228:231], v[180:183]
    ds_read_b128 v[80:83], v3 offset:40960
    ds_read_b128 v[84:87], v3 offset:41984
    v_mfma_f32_16x16x32_bf16 v[184:187], v[112:115], v[232:235], v[184:187]
    s_add_u32 s24, s24, 4096
    v_mfma_f32_16x16x32_bf16 v[188:191], v[112:115], v[236:239], v[188:191]
    v_mfma_f32_16x16x32_bf16 v[204:207], v[116:119], v[236:239], v[204:207]
    buffer_load_dwordx4 v[112:115], v3, s[4:7], s24 offen offset:0 sc1
    v_mfma_f32_16x16x32_bf16 v[200:203], v[116:119], v[232:235], v[200:203]
    ds_read_b128 v[88:91], v3 offset:43008
    ds_read_b128 v[92:95], v3 offset:44032
    v_mfma_f32_16x16x32_bf16 v[196:199], v[116:119], v[228:231], v[196:199]
    v_mfma_f32_16x16x32_bf16 v[192:195], v[116:119], v[224:227], v[192:195]
    s_waitcnt lgkmcnt(4)
    v_mfma_f32_16x16x32_bf16 v[176:179], v[120:123], v[64:67], v[176:179]
    ds_read_b128 v[224:227], v3 offset:45056
    ds_read_b128 v[228:231], v3 offset:46080
    v_mfma_f32_16x16x32_bf16 v[180:183], v[120:123], v[68:71], v[180:183]
    ds_read_b128 v[232:235], v3 offset:47104
    ds_read_b128 v[236:239], v3 offset:48128
    v_mfma_f32_16x16x32_bf16 v[184:187], v[120:123], v[72:75], v[184:187]
    v_mfma_f32_16x16x32_bf16 v[188:191], v[120:123], v[76:79], v[188:191]
    v_mfma_f32_16x16x32_bf16 v[204:207], v[124:127], v[76:79], v[204:207]
    v_mfma_f32_16x16x32_bf16 v[200:203], v[124:127], v[72:75], v[200:203]
    v_mfma_f32_16x16x32_bf16 v[196:199], v[124:127], v[68:71], v[196:199]
    v_mfma_f32_16x16x32_bf16 v[192:195], v[124:127], v[64:67], v[192:195]
    s_waitcnt lgkmcnt(4)
    v_mfma_f32_16x16x32_bf16 v[176:179], v[128:131], v[80:83], v[176:179]
    ds_read_b128 v[64:67], v3 offset:49152
    ds_read_b128 v[68:71], v3 offset:50176
    v_mfma_f32_16x16x32_bf16 v[180:183], v[128:131], v[84:87], v[180:183]
    ds_read_b128 v[72:75], v3 offset:51200
    ds_read_b128 v[76:79], v3 offset:52224
    v_mfma_f32_16x16x32_bf16 v[184:187], v[128:131], v[88:91], v[184:187]
    v_mfma_f32_16x16x32_bf16 v[188:191], v[128:131], v[92:95], v[188:191]
    v_mfma_f32_16x16x32_bf16 v[204:207], v[132:135], v[92:95], v[204:207]
    v_mfma_f32_16x16x32_bf16 v[200:203], v[132:135], v[88:91], v[200:203]
    v_mfma_f32_16x16x32_bf16 v[196:199], v[132:135], v[84:87], v[196:199]
    v_mfma_f32_16x16x32_bf16 v[192:195], v[132:135], v[80:83], v[192:195]
    s_waitcnt lgkmcnt(4)
    v_mfma_f32_16x16x32_bf16 v[176:179], v[160:163], v[224:227], v[176:179]
    ds_read_b128 v[80:83], v3 offset:53248
    ds_read_b128 v[84:87], v3 offset:54272
    v_mfma_f32_16x16x32_bf16 v[180:183], v[160:163], v[228:231], v[180:183]
    ds_read_b128 v[88:91], v3 offset:55296
    ds_read_b128 v[92:95], v3 offset:56320
    v_mfma_f32_16x16x32_bf16 v[184:187], v[160:163], v[232:235], v[184:187]
    v_mfma_f32_16x16x32_bf16 v[188:191], v[160:163], v[236:239], v[188:191]
    v_mfma_f32_16x16x32_bf16 v[204:207], v[164:167], v[236:239], v[204:207]
    v_mfma_f32_16x16x32_bf16 v[200:203], v[164:167], v[232:235], v[200:203]
    v_mfma_f32_16x16x32_bf16 v[196:199], v[164:167], v[228:231], v[196:199]
    v_mfma_f32_16x16x32_bf16 v[192:195], v[164:167], v[224:227], v[192:195]
    s_waitcnt vmcnt(15) lgkmcnt(4)
    v_mfma_f32_16x16x32_bf16 v[176:179], v[168:171], v[64:67], v[176:179]
    ds_read_b128 v[224:227], v3 offset:57344
    ds_read_b128 v[228:231], v3 offset:58368
    v_mfma_f32_16x16x32_bf16 v[180:183], v[168:171], v[68:71], v[180:183]
    ds_read_b128 v[232:235], v3 offset:59392
    ds_read_b128 v[236:239], v3 offset:60416
    v_mfma_f32_16x16x32_bf16 v[184:187], v[168:171], v[72:75], v[184:187]
    v_mfma_f32_16x16x32_bf16 v[188:191], v[168:171], v[76:79], v[188:191]
    v_mfma_f32_16x16x32_bf16 v[204:207], v[172:175], v[76:79], v[204:207]
    v_mfma_f32_16x16x32_bf16 v[200:203], v[172:175], v[72:75], v[200:203]
    v_mfma_f32_16x16x32_bf16 v[196:199], v[172:175], v[68:71], v[196:199]
    v_mfma_f32_16x16x32_bf16 v[192:195], v[172:175], v[64:67], v[192:195]
    s_waitcnt vmcnt(13) lgkmcnt(4)
    v_mfma_f32_16x16x32_bf16 v[176:179], v[240:243], v[80:83], v[176:179]
    ds_read_b128 v[64:67], v3 offset:61440
    ds_read_b128 v[68:71], v3 offset:62464
    v_mfma_f32_16x16x32_bf16 v[180:183], v[240:243], v[84:87], v[180:183]
    ds_read_b128 v[72:75], v3 offset:63488
    ds_read_b128 v[76:79], v3 offset:64512
    v_mfma_f32_16x16x32_bf16 v[184:187], v[240:243], v[88:91], v[184:187]
    v_mfma_f32_16x16x32_bf16 v[188:191], v[240:243], v[92:95], v[188:191]
    v_mfma_f32_16x16x32_bf16 v[204:207], v[244:247], v[92:95], v[204:207]
    v_mfma_f32_16x16x32_bf16 v[200:203], v[244:247], v[88:91], v[200:203]
    v_mfma_f32_16x16x32_bf16 v[196:199], v[244:247], v[84:87], v[196:199]
    v_mfma_f32_16x16x32_bf16 v[192:195], v[244:247], v[80:83], v[192:195]
    s_waitcnt vmcnt(11) lgkmcnt(4)
    v_mfma_f32_16x16x32_bf16 v[176:179], v[248:251], v[224:227], v[176:179]
    ds_read_b128 v[80:83], v5 offset:16384
    ds_read_b128 v[84:87], v5 offset:17408
    v_mfma_f32_16x16x32_bf16 v[180:183], v[248:251], v[228:231], v[180:183]
    ds_read_b128 v[88:91], v5 offset:18432
    ds_read_b128 v[92:95], v5 offset:19456
    v_mfma_f32_16x16x32_bf16 v[184:187], v[248:251], v[232:235], v[184:187]
    v_mfma_f32_16x16x32_bf16 v[188:191], v[248:251], v[236:239], v[188:191]
    v_mfma_f32_16x16x32_bf16 v[204:207], v[252:255], v[236:239], v[204:207]
    v_mfma_f32_16x16x32_bf16 v[200:203], v[252:255], v[232:235], v[200:203]
    v_mfma_f32_16x16x32_bf16 v[196:199], v[252:255], v[228:231], v[196:199]
    v_mfma_f32_16x16x32_bf16 v[192:195], v[252:255], v[224:227], v[192:195]
    s_waitcnt vmcnt(9) lgkmcnt(4)
    v_mfma_f32_16x16x32_bf16 v[176:179], v[136:139], v[64:67], v[176:179]
    ds_read_b128 v[224:227], v5 offset:20480
    ds_read_b128 v[228:231], v5 offset:21504
    v_mfma_f32_16x16x32_bf16 v[180:183], v[136:139], v[68:71], v[180:183]
    ds_read_b128 v[232:235], v5 offset:22528
    ds_read_b128 v[236:239], v5 offset:23552
    v_mfma_f32_16x16x32_bf16 v[184:187], v[136:139], v[72:75], v[184:187]
    v_mfma_f32_16x16x32_bf16 v[188:191], v[136:139], v[76:79], v[188:191]
    v_mfma_f32_16x16x32_bf16 v[204:207], v[140:143], v[76:79], v[204:207]
    v_mfma_f32_16x16x32_bf16 v[200:203], v[140:143], v[72:75], v[200:203]
    v_mfma_f32_16x16x32_bf16 v[196:199], v[140:143], v[68:71], v[196:199]
    v_mfma_f32_16x16x32_bf16 v[192:195], v[140:143], v[64:67], v[192:195]
    s_waitcnt vmcnt(7) lgkmcnt(4)
    v_mfma_f32_16x16x32_bf16 v[176:179], v[144:147], v[80:83], v[176:179]
    ds_read_b64 v[64:65], v6 offset:0
    ds_read_b64 v[68:69], v6 offset:512
    v_mfma_f32_16x16x32_bf16 v[180:183], v[144:147], v[84:87], v[180:183]
    ds_read_b64 v[72:73], v6 offset:1024
    ds_read_b64 v[76:77], v6 offset:1536
    v_mfma_f32_16x16x32_bf16 v[184:187], v[144:147], v[88:91], v[184:187]
    v_mfma_f32_16x16x32_bf16 v[188:191], v[144:147], v[92:95], v[188:191]
    v_mfma_f32_16x16x32_bf16 v[204:207], v[148:151], v[92:95], v[204:207]
    v_mfma_f32_16x16x32_bf16 v[200:203], v[148:151], v[88:91], v[200:203]
    v_mfma_f32_16x16x32_bf16 v[196:199], v[148:151], v[84:87], v[196:199]
    v_mfma_f32_16x16x32_bf16 v[192:195], v[148:151], v[80:83], v[192:195]
    s_waitcnt vmcnt(5) lgkmcnt(4)
    v_mfma_f32_16x16x32_bf16 v[176:179], v[152:155], v[224:227], v[176:179]
    ds_read_b128 v[80:83], v4 offset:0
    ds_read_b128 v[84:87], v4 offset:1024
    v_mfma_f32_16x16x32_bf16 v[180:183], v[152:155], v[228:231], v[180:183]
    ds_read_b128 v[88:91], v4 offset:2048
    ds_read_b128 v[92:95], v4 offset:3072
    v_mfma_f32_16x16x32_bf16 v[184:187], v[152:155], v[232:235], v[184:187]
    v_mfma_f32_16x16x32_bf16 v[188:191], v[152:155], v[236:239], v[188:191]
    v_mfma_f32_16x16x32_bf16 v[204:207], v[156:159], v[236:239], v[204:207]
    v_mfma_f32_16x16x32_bf16 v[200:203], v[156:159], v[232:235], v[200:203]
    v_mfma_f32_16x16x32_bf16 v[196:199], v[156:159], v[228:231], v[196:199]
    v_mfma_f32_16x16x32_bf16 v[192:195], v[156:159], v[224:227], v[192:195]
    s_waitcnt vmcnt(3) lgkmcnt(4)
    v_mfma_f32_16x16x16_bf16 v[176:179], v[96:97], v[64:65], v[176:179]
    ds_read_b128 v[224:227], v4 offset:4096
    ds_read_b128 v[228:231], v4 offset:5120
    v_mfma_f32_16x16x16_bf16 v[180:183], v[96:97], v[68:69], v[180:183]
    ds_read_b128 v[232:235], v4 offset:6144
    ds_read_b128 v[236:239], v4 offset:7168
    v_mfma_f32_16x16x16_bf16 v[184:187], v[96:97], v[72:73], v[184:187]
    v_mfma_f32_16x16x16_bf16 v[188:191], v[96:97], v[76:77], v[188:191]
    v_mfma_f32_16x16x16_bf16 v[204:207], v[98:99], v[76:77], v[204:207]
    v_mfma_f32_16x16x16_bf16 v[200:203], v[98:99], v[72:73], v[200:203]
    v_mfma_f32_16x16x16_bf16 v[196:199], v[98:99], v[68:69], v[196:199]
    v_mfma_f32_16x16x16_bf16 v[192:195], v[98:99], v[64:65], v[192:195]
    s_waitcnt vmcnt(2) lgkmcnt(4)
    v_mfma_f32_16x16x32_bf16 v[176:179], v[100:103], v[80:83], v[176:179]
    v_mfma_f32_16x16x32_bf16 v[180:183], v[100:103], v[84:87], v[180:183]
    v_mfma_f32_16x16x32_bf16 v[184:187], v[100:103], v[88:91], v[184:187]
    v_mfma_f32_16x16x32_bf16 v[188:191], v[100:103], v[92:95], v[188:191]
    v_mfma_f32_16x16x32_bf16 v[204:207], v[104:107], v[92:95], v[204:207]
    v_mfma_f32_16x16x32_bf16 v[200:203], v[104:107], v[88:91], v[200:203]
    v_mfma_f32_16x16x32_bf16 v[196:199], v[104:107], v[84:87], v[196:199]
    v_mfma_f32_16x16x32_bf16 v[192:195], v[104:107], v[80:83], v[192:195]
    s_waitcnt vmcnt(0) lgkmcnt(0)
    v_mfma_f32_16x16x32_bf16 v[176:179], v[108:111], v[224:227], v[176:179]
    v_mfma_f32_16x16x32_bf16 v[180:183], v[108:111], v[228:231], v[180:183]
    v_mfma_f32_16x16x32_bf16 v[184:187], v[108:111], v[232:235], v[184:187]
    v_mfma_f32_16x16x32_bf16 v[188:191], v[108:111], v[236:239], v[188:191]
    v_mfma_f32_16x16x32_bf16 v[204:207], v[112:115], v[236:239], v[204:207]
    v_mfma_f32_16x16x32_bf16 v[200:203], v[112:115], v[232:235], v[200:203]
    v_mfma_f32_16x16x32_bf16 v[196:199], v[112:115], v[228:231], v[196:199]
    v_mfma_f32_16x16x32_bf16 v[192:195], v[112:115], v[224:227], v[192:195]
    s_setprio 0
    s_mov_b32 s25, 458752
    v_cvt_pk_bf16_f32 v16, v176, v177
    v_cvt_pk_bf16_f32 v17, v178, v179
    v_cvt_pk_bf16_f32 v18, v180, v181
    v_cvt_pk_bf16_f32 v19, v182, v183
    buffer_store_dwordx4 v[16:19], v9, s[4:7], s25 offen sc1
    ds_write_b128 v42, v[16:19] offset:7168
    v_cvt_pk_bf16_f32 v20, v184, v185
    v_cvt_pk_bf16_f32 v21, v186, v187
    v_cvt_pk_bf16_f32 v22, v188, v189
    v_cvt_pk_bf16_f32 v23, v190, v191
    buffer_store_dwordx4 v[20:23], v10, s[4:7], s25 offen sc1
    ds_write_b128 v43, v[20:23] offset:7168
    s_mov_b32 s25, 524288
    v_cvt_pk_bf16_f32 v24, v192, v193
    v_cvt_pk_bf16_f32 v25, v194, v195
    v_cvt_pk_bf16_f32 v26, v196, v197
    v_cvt_pk_bf16_f32 v27, v198, v199
    buffer_store_dwordx4 v[24:27], v9, s[4:7], s25 offen sc1
    ds_write_b128 v42, v[24:27] offset:8192
    v_cvt_pk_bf16_f32 v28, v200, v201
    v_cvt_pk_bf16_f32 v29, v202, v203
    v_cvt_pk_bf16_f32 v30, v204, v205
    v_cvt_pk_bf16_f32 v31, v206, v207
    buffer_store_dwordx4 v[28:31], v10, s[4:7], s25 offen sc1
    ds_write_b128 v43, v[28:31] offset:8192
    s_mul_i32 s31, s22, 1024
    s_add_u32 s31, s31, 524
    s_waitcnt vmcnt(0)
    s_mov_b64 exec, 1
    ds_add_rtn_u32 v14, v13, v12 offset:136
    s_mov_b64 exec, -1
    s_waitcnt lgkmcnt(0)
    v_readfirstlane_b32 s3, v14
    s_nop 0
    s_cmp_lg_u32 s3, 3
    s_cbranch_scc1 L_arr_50
    s_mov_b32 s1, 1
    s_atomic_add s1, s[44:45], s31
L_arr_50:
    s_mul_i32 s33, s22, 9
    s_add_u32 s33, s33, s88
    s_lshl_b32 s33, s33, 16
    s_lshl_b32 s34, s23, 13
    s_add_u32 s33, s33, s34
    s_add_u32 s33, s33, 22020096
    s_mov_b32 s12, s54
    s_and_b32 s13, s55, 0xffff
    s_mov_b32 s14, 2359296
    s_mov_b32 s15, 0x20000
    s_mul_i32 s31, s22, 1024
    s_add_u32 s31, s31, 12
    s_add_u32 s31, s31, s90
    s_lshl_b32 s32, s88, 10
    s_add_u32 s32, s32, 73728
    v_add_u32 v148, s32, v3
    s_lshl_b32 s34, s23, 10
    s_mov_b32 s26, 0
L_poll_51:
    s_mov_b32 s3, 0
    s_atomic_add s3, s[44:45], s31 glc
    s_waitcnt lgkmcnt(0)
    s_cmp_ge_u32 s3, 8
    s_cbranch_scc1 L_pdone_52
    s_add_u32 s26, s26, 1
    s_cmp_lt_u32 s26, 40000
    s_cbranch_scc1 L_poll_51
L_pdone_52:
    ds_read_b128 v[96:99], v148
    s_add_u32 s34, s34, 1024
    s_and_b32 s34, s34, 8191
    s_add_u32 s32, s33, s34
    buffer_load_dwordx4 v[100:103], v3, s[4:7], s32 offen sc1
    s_add_u32 s34, s34, 1024
    s_and_b32 s34, s34, 8191
    s_add_u32 s32, s33, s34
    buffer_load_dwordx4 v[104:107], v3, s[4:7], s32 offen sc1
    s_add_u32 s34, s34, 1024
    s_and_b32 s34, s34, 8191
    s_add_u32 s32, s33, s34
    buffer_load_dwordx4 v[108:111], v3, s[4:7], s32 offen sc1
    s_add_u32 s34, s34, 1024
    s_and_b32 s34, s34, 8191
    s_add_u32 s32, s33, s34
    buffer_load_dwordx4 v[112:115], v3, s[4:7], s32 offen sc1
    s_add_u32 s34, s34, 1024
    s_and_b32 s34, s34, 8191
    s_add_u32 s32, s33, s34
    buffer_load_dwordx4 v[116:119], v3, s[4:7], s32 offen sc1
    s_add_u32 s34, s34, 1024
    s_and_b32 s34, s34, 8191
    s_add_u32 s32, s33, s34
    buffer_load_dwordx4 v[120:123], v3, s[4:7], s32 offen sc1
    s_add_u32 s34, s34, 1024
    s_and_b32 s34, s34, 8191
    s_add_u32 s32, s33, s34
    buffer_load_dwordx4 v[124:127], v3, s[4:7], s32 offen sc1
    v_lshlrev_b32 v140, 16, v208
    v_and_b32 v141, s28, v208
    v_lshlrev_b32 v149, 16, v212
    v_and_b32 v150, s28, v212
    v_add_f32 v140, v140, v149
    v_add_f32 v141, v141, v150
    v_lshlrev_b32 v142, 16, v209
    v_and_b32 v143, s28, v209
    v_lshlrev_b32 v149, 16, v213
    v_and_b32 v150, s28, v213
    v_add_f32 v142, v142, v149
    v_add_f32 v143, v143, v150
    v_lshlrev_b32 v144, 16, v210
    v_and_b32 v145, s28, v210
    v_lshlrev_b32 v149, 16, v214
    v_and_b32 v150, s28, v214
    v_add_f32 v144, v144, v149
    v_add_f32 v145, v145, v150
    v_lshlrev_b32 v146, 16, v211
    v_and_b32 v147, s28, v211
    v_lshlrev_b32 v149, 16, v215
    v_and_b32 v150, s28, v215
    v_add_f32 v146, v146, v149
    v_add_f32 v147, v147, v150
    s_waitcnt lgkmcnt(0)
    v_mfma_f32_16x16x32_bf16 v[140:143], v[32:35], v[96:99], v[140:143]
    v_mfma_f32_16x16x32_bf16 v[144:147], v[36:39], v[96:99], v[144:147]
    s_waitcnt vmcnt(6)
    v_mfma_f32_16x16x32_bf16 v[140:143], v[32:35], v[100:103], v[140:143]
    v_mfma_f32_16x16x32_bf16 v[144:147], v[36:39], v[100:103], v[144:147]
    s_waitcnt vmcnt(5)
    v_mfma_f32_16x16x32_bf16 v[140:143], v[32:35], v[104:107], v[140:143]
    v_mfma_f32_16x16x32_bf16 v[144:147], v[36:39], v[104:107], v[144:147]
    s_waitcnt vmcnt(4)
    v_mfma_f32_16x16x32_bf16 v[140:143], v[32:35], v[108:111], v[140:143]
    v_mfma_f32_16x16x32_bf16 v[144:147], v[36:39], v[108:111], v[144:147]
    s_waitcnt vmcnt(3)
    v_mfma_f32_16x16x32_bf16 v[140:143], v[32:35], v[112:115], v[140:143]
    v_mfma_f32_16x16x32_bf16 v[144:147], v[36:39], v[112:115], v[144:147]
    s_waitcnt vmcnt(2)
    v_mfma_f32_16x16x32_bf16 v[140:143], v[32:35], v[116:119], v[140:143]
    v_mfma_f32_16x16x32_bf16 v[144:147], v[36:39], v[116:119], v[144:147]
    s_waitcnt vmcnt(1)
    v_mfma_f32_16x16x32_bf16 v[140:143], v[32:35], v[120:123], v[140:143]
    v_mfma_f32_16x16x32_bf16 v[144:147], v[36:39], v[120:123], v[144:147]
    s_waitcnt vmcnt(0)
    v_mfma_f32_16x16x32_bf16 v[140:143], v[32:35], v[124:127], v[140:143]
    v_mfma_f32_16x16x32_bf16 v[144:147], v[36:39], v[124:127], v[144:147]
    s_nop 6
    v_cvt_pk_bf16_f32 v208, v140, v141
    v_cvt_pk_bf16_f32 v209, v142, v143
    v_cvt_pk_bf16_f32 v210, v144, v145
    v_cvt_pk_bf16_f32 v211, v146, v147
    buffer_store_dwordx4 v[208:211], v40, s[12:15], 0 offen sc1
    s_branch L_fin
L_grp_b:
    s_lshl2_add_u32 s27, s23, s21
    s_lshl2_add_u32 s31, s22, s21
    s_lshl_b32 s26, s31, 7
    s_getpc_b64 s[96:97]
L_pc:
    s_add_u32 s96, s96, L_table-L_pc
    s_addc_u32 s97, s97, 0
    s_barrier
    s_waitcnt lgkmcnt(0)
    s_mov_b32 s4, s58
    s_and_b32 s5, s59, 0xffff
    s_mov_b32 s6, 268435456
    s_mov_b32 s7, 0x20000
    s_add_u32 s44, s58, 48234496
    s_addc_u32 s45, s59, 0
    s_add_u32 s96, s96, s26
    s_addc_u32 s97, s97, 0
    s_load_dwordx16 s[60:75], s[96:97], 0
    s_load_dwordx16 s[76:91], s[96:97], 64
    s_xor_b32 s35, s21, 3
    s_or_b32 s35, s35, s2
    s_cbranch_scc1 L_nolead1
    s_setprio 3
    v_mul_u32_u24 v20, 256, v0
    v_mov_b32 v24, 0
    v_mov_b32 v25, 0
    v_mov_b32 v26, 0
    v_mov_b32 v27, 0
    s_mov_b32 s34, 48234496
    buffer_store_dwordx4 v[24:27], v20, s[4:7], s34 offen sc1
    s_mov_b32 s34, 48250880
    buffer_store_dwordx4 v[24:27], v20, s[4:7], s34 offen sc1
L_nolead1:
    s_cmp_lg_u32 s35, 0
    s_cbranch_scc1 L_nolead2
    s_mov_b32 s12, s56
    s_and_b32 s13, s57, 0xffff
    s_mov_b32 s14, 256
    s_mov_b32 s15, 0x20000
    s_waitcnt vmcnt(0)
    s_mov_b64 exec, 1
    buffer_store_dword v12, off, s[12:15], 0 sc1
    s_mov_b64 exec, -1
L_nolead2:
    s_setprio 1
    s_cmp_ge_u32 s22, 18
    s_cbranch_scc1 L_nofold
    v_lshrrev_b32 v22, 2, v0
    v_and_b32 v23, 3, v0
    v_lshlrev_b32 v43, 4, v1
    v_lshl_add_u32 v43, v2, 2, v43
    v_lshrrev_b32 v16, 2, v22
    v_and_b32 v17, 3, v22
    v_lshl_add_u32 v16, v16, 3, v17
    v_lshlrev_b32 v17, 4, v23
    v_mov_b32 v21, 0x40000000
    v_cmp_eq_u32 vcc, 3, v23
    s_nop 1
    v_cndmask_b32 v17, v17, v21, vcc
    v_mul_u32_u24 v18, 3456, v16
    v_add_u32 v40, v18, v17
    v_add_u32 v19, 0, v16
    v_cmp_gt_u32 vcc, 18, v19
    v_mul_u32_u24 v19, 36, v19
    v_add_u32 v19, v19, v17
    v_cndmask_b32 v41, v21, v19, vcc
    v_add_u32 v19, 4, v16
    v_cmp_gt_u32 vcc, 18, v19
    v_mul_u32_u24 v19, 36, v19
    v_add_u32 v19, v19, v17
    v_cndmask_b32 v42, v21, v19, vcc
    s_mov_b32 s12, s40
    s_and_b32 s13, s41, 0xffff
    s_mov_b32 s14, 20736
    s_mov_b32 s15, 0x20000
    s_mul_i32 s31, s22, 110592
    s_mul_i32 s32, s27, 36
    s_add_u32 s31, s31, s32
    s_add_u32 s32, s31, 13824
    s_mul_i32 s33, s27, 648
    buffer_load_dwordx4 v[88:91], v41, s[12:15], s33 offen
    buffer_load_dwordx4 v[92:95], v42, s[12:15], s33 offen
    s_mov_b32 s12, s38
    s_and_b32 s13, s39, 0xffff
    s_mov_b32 s14, 1990656
    s_mov_b32 s15, 0x20000
    buffer_load_dwordx4 v[64:67], v40, s[12:15], s31 offen offset:1152
    buffer_load_dwordx4 v[68:71], v40, s[12:15], s32 offen offset:1152
    buffer_load_dwordx4 v[72:75], v40, s[12:15], s31 offen offset:0
    buffer_load_dwordx4 v[76:79], v40, s[12:15], s32 offen offset:0
    buffer_load_dwordx4 v[80:83], v40, s[12:15], s31 offen offset:2304
    buffer_load_dwordx4 v[84:87], v40, s[12:15], s32 offen offset:2304
    v_mov_b32 v22, 0x3f80
    v_lshlrev_b32 v16, 3, v2
    v_sub_u32 v16, v1, v16
    v_and_b32 v17, 1, v16
    v_lshlrev_b32 v17, 4, v17
    v_lshlrev_b32 v17, v17, v22
    v_ashrrev_i32 v16, 1, v16
    v_cmp_eq_u32 vcc, 0, v16
    s_nop 1
    v_cndmask_b32 v96, 0, v17, vcc
    v_cmp_eq_u32 vcc, 1, v16
    s_nop 1
    v_cndmask_b32 v97, 0, v17, vcc
    v_cmp_eq_u32 vcc, 2, v16
    s_nop 1
    v_cndmask_b32 v98, 0, v17, vcc
    v_cmp_eq_u32 vcc, 3, v16
    s_nop 1
    v_cndmask_b32 v99, 0, v17, vcc
    v_bfe_u32 v19, v1, 2, 1
    v_add_u32 v19, 16, v19
    v_and_b32 v20, 3, v1
    v_cmp_eq_u32 vcc, 0, v20
    s_nop 1
    v_cndmask_b32 v21, 63, v19, vcc
    v_lshlrev_b32 v16, 3, v2
    v_sub_u32 v16, v21, v16
    v_and_b32 v17, 1, v16
    v_lshlrev_b32 v17, 4, v17
    v_lshlrev_b32 v17, v17, v22
    v_ashrrev_i32 v16, 1, v16
    v_cmp_eq_u32 vcc, 0, v16
    s_nop 1
    v_cndmask_b32 v100, 0, v17, vcc
    v_cmp_eq_u32 vcc, 1, v16
    s_nop 1
    v_cndmask_b32 v101, 0, v17, vcc
    v_cmp_eq_u32 vcc, 2, v16
    s_nop 1
    v_cndmask_b32 v102, 0, v17, vcc
    v_cmp_eq_u32 vcc, 3, v16
    s_nop 1
    v_cndmask_b32 v103, 0, v17, vcc
    v_cmp_eq_u32 vcc, 1, v20
    s_nop 1
    v_cndmask_b32 v21, 63, v19, vcc
    v_lshlrev_b32 v16, 3, v2
    v_sub_u32 v16, v21, v16
    v_and_b32 v17, 1, v16
    v_lshlrev_b32 v17, 4, v17
    v_lshlrev_b32 v17, v17, v22
    v_ashrrev_i32 v16, 1, v16
    v_cmp_eq_u32 vcc, 0, v16
    s_nop 1
    v_cndmask_b32 v104, 0, v17, vcc
    v_cmp_eq_u32 vcc, 1, v16
    s_nop 1
    v_cndmask_b32 v105, 0, v17, vcc
    v_cmp_eq_u32 vcc, 2, v16
    s_nop 1
    v_cndmask_b32 v106, 0, v17, vcc
    v_cmp_eq_u32 vcc, 3, v16
    s_nop 1
    v_cndmask_b32 v107, 0, v17, vcc
    v_cmp_eq_u32 vcc, 2, v20
    s_nop 1
    v_cndmask_b32 v21, 63, v19, vcc
    v_lshlrev_b32 v16, 3, v2
    v_sub_u32 v16, v21, v16
    v_and_b32 v17, 1, v16
    v_lshlrev_b32 v17, 4, v17
    v_lshlrev_b32 v17, v17, v22
    v_ashrrev_i32 v16, 1, v16
    v_cmp_eq_u32 vcc, 0, v16
    s_nop 1
    v_cndmask_b32 v108, 0, v17, vcc
    v_cmp_eq_u32 vcc, 1, v16
    s_nop 1
    v_cndmask_b32 v109, 0, v17, vcc
    v_cmp_eq_u32 vcc, 2, v16
    s_nop 1
    v_cndmask_b32 v110, 0, v17, vcc
    v_cmp_eq_u32 vcc, 3, v16
    s_nop 1
    v_cndmask_b32 v111, 0, v17, vcc
    s_waitcnt lgkmcnt(0)
    s_lshr_b32 s31, s83, 28
    s_cmp_eq_u32 s31, 1
    s_cselect_b32 s12, s52, s50
    s_cselect_b32 s13, s53, s51
    s_mov_b32 s14, 5308416
    s_cmp_eq_u32 s31, 2
    s_cselect_b32 s12, s42, s12
    s_cselect_b32 s13, s43, s13
    s_cselect_b32 s14, 663552, s14
    s_and_b32 s13, s13, 0xffff
    s_mov_b32 s15, 0x20000
    v_and_b32 v16, 1, v2
    v_mul_lo_u32 v16, v16, s78
    v_lshrrev_b32 v17, 1, v2
    v_mul_lo_u32 v17, v17, s79
    v_lshlrev_b32 v18, 3, v1
    v_add3_u32 v45, v16, v17, v18
    s_mul_i32 s31, s23, s77
    s_add_u32 s31, s31, s76
    s_add_u32 s32, s31, s81
    buffer_load_dwordx2 v[176:177], v45, s[12:15], s31 offen
    s_add_u32 s31, s31, s80
    buffer_load_dwordx2 v[178:179], v45, s[12:15], s31 offen
    s_add_u32 s31, s31, s80
    buffer_load_dwordx2 v[180:181], v45, s[12:15], s31 offen
    s_add_u32 s31, s31, s80
    buffer_load_dwordx2 v[182:183], v45, s[12:15], s31 offen
    buffer_load_dwordx2 v[184:185], v45, s[12:15], s32 offen
    s_add_u32 s32, s32, s80
    buffer_load_dwordx2 v[186:187], v45, s[12:15], s32 offen
    s_add_u32 s32, s32, s80
    buffer_load_dwordx2 v[188:189], v45, s[12:15], s32 offen
    s_add_u32 s32, s32, s80
    buffer_load_dwordx2 v[190:191], v45, s[12:15], s32 offen
    s_waitcnt vmcnt(8)
    ds_bpermute_b32 v88, v43, v88
    ds_bpermute_b32 v89, v43, v89
    ds_bpermute_b32 v90, v43, v90
    ds_bpermute_b32 v91, v43, v91
    ds_bpermute_b32 v92, v43, v92
    ds_bpermute_b32 v93, v43, v93
    ds_bpermute_b32 v94, v43, v94
    ds_bpermute_b32 v95, v43, v95
    ds_bpermute_b32 v64, v43, v64
    ds_bpermute_b32 v65, v43, v65
    ds_bpermute_b32 v66, v43, v66
    ds_bpermute_b32 v67, v43, v67
    ds_bpermute_b32 v68, v43, v68
    ds_bpermute_b32 v69, v43, v69
    ds_bpermute_b32 v70, v43, v70
    ds_bpermute_b32 v71, v43, v71
    ds_bpermute_b32 v72, v43, v72
    ds_bpermute_b32 v73, v43, v73
    ds_bpermute_b32 v74, v43, v74
    ds_bpermute_b32 v75, v43, v75
    ds_bpermute_b32 v76, v43, v76
    ds_bpermute_b32 v77, v43, v77
    ds_bpermute_b32 v78, v43, v78
    ds_bpermute_b32 v79, v43, v79
    ds_bpermute_b32 v80, v43, v80
    ds_bpermute_b32 v81, v43, v81
    ds_bpermute_b32 v82, v43, v82
    ds_bpermute_b32 v83, v43, v83
    ds_bpermute_b32 v84, v43, v84
    ds_bpermute_b32 v85, v43, v85
    ds_bpermute_b32 v86, v43, v86
    ds_bpermute_b32 v87, v43, v87
    s_waitcnt lgkmcnt(15)
    v_mfma_f32_16x16x32_bf16 v[128:131], v[88:91], v[96:99], 0
    v_mfma_f32_16x16x32_bf16 v[132:135], v[92:95], v[96:99], 0
    v_mfma_f32_16x16x32_bf16 v[136:139], v[88:91], v[100:103], 0
    v_mfma_f32_16x16x32_bf16 v[140:143], v[92:95], v[100:103], 0
    v_mfma_f32_16x16x32_bf16 v[144:147], v[88:91], v[104:107], 0
    v_mfma_f32_16x16x32_bf16 v[148:151], v[92:95], v[104:107], 0
    s_nop 2
    v_cvt_pk_bf16_f32 v112, v128, v129
    v_cvt_pk_bf16_f32 v113, v130, v131
    v_cvt_pk_bf16_f32 v114, v132, v133
    v_cvt_pk_bf16_f32 v115, v134, v135
    v_cvt_pk_bf16_f32 v116, v136, v137
    v_cvt_pk_bf16_f32 v117, v138, v139
    v_cvt_pk_bf16_f32 v118, v140, v141
    v_cvt_pk_bf16_f32 v119, v142, v143
    v_cvt_pk_bf16_f32 v120, v144, v145
    v_cvt_pk_bf16_f32 v121, v146, v147
    v_cvt_pk_bf16_f32 v122, v148, v149
    v_cvt_pk_bf16_f32 v123, v150, v151
    s_waitcnt lgkmcnt(0)
    v_mfma_f32_16x16x32_bf16 v[128:131], v[64:67], v[112:115], 0
    v_mfma_f32_16x16x32_bf16 v[136:139], v[72:75], v[112:115], 0
    v_mfma_f32_16x16x32_bf16 v[144:147], v[80:83], v[96:99], 0
    v_mfma_f32_16x16x32_bf16 v[152:155], v[64:67], v[116:119], 0
    v_mfma_f32_16x16x32_bf16 v[152:155], v[72:75], v[120:123], v[152:155]
    v_mfma_f32_16x16x32_bf16 v[152:155], v[80:83], v[108:111], v[152:155]
    v_mfma_f32_16x16x32_bf16 v[132:135], v[68:71], v[112:115], 0
    v_mfma_f32_16x16x32_bf16 v[140:143], v[76:79], v[112:115], 0
    v_mfma_f32_16x16x32_bf16 v[148:151], v[84:87], v[96:99], 0
    v_mfma_f32_16x16x32_bf16 v[156:159], v[68:71], v[116:119], 0
    v_mfma_f32_16x16x32_bf16 v[156:159], v[76:79], v[120:123], v[156:159]
    v_mfma_f32_16x16x32_bf16 v[156:159], v[84:87], v[108:111], v[156:159]
    v_cvt_pk_bf16_f32 v160, v128, v129
    v_cvt_pk_bf16_f32 v161, v130, v131
    s_nop 0
    v_cvt_pk_bf16_f32 v162, v132, v133
    v_cvt_pk_bf16_f32 v163, v134, v135
    v_cvt_pk_bf16_f32 v164, v136, v137
    v_cvt_pk_bf16_f32 v165, v138, v139
    v_cvt_pk_bf16_f32 v166, v140, v141
    v_cvt_pk_bf16_f32 v167, v142, v143
    v_cvt_pk_bf16_f32 v168, v144, v145
    v_cvt_pk_bf16_f32 v169, v146, v147
    v_cvt_pk_bf16_f32 v170, v148, v149
    v_cvt_pk_bf16_f32 v171, v150, v151
    v_cvt_pk_bf16_f32 v172, v152, v153
    v_cvt_pk_bf16_f32 v173, v154, v155
    v_cvt_pk_bf16_f32 v174, v156, v157
    v_cvt_pk_bf16_f32 v175, v158, v159
    s_lshr_b32 s32, s22, 1
    s_mul_i32 s31, s27, 9
    s_add_u32 s31, s31, s32
    s_mul_i32 s31, s31, 7168
    s_add_u32 s31, s31, 262144
    s_and_b32 s33, s22, 1
    s_lshl_b32 s32, s33, 12
    s_add_u32 s32, s32, s31
    v_lshrrev_b32 v16, 3, v1
    v_cmp_eq_u32 vcc, s33, v16
    v_mov_b32 v17, 0x40000000
    s_nop 0
    v_cndmask_b32 v16, v17, v3, vcc
    buffer_store_dwordx4 v[160:163], v3, s[4:7], s32 offen offset:0 sc1
    buffer_store_dwordx4 v[164:167], v3, s[4:7], s32 offen offset:1024 sc1
    buffer_store_dwordx4 v[168:171], v3, s[4:7], s32 offen offset:2048 sc1
    buffer_store_dwordx4 v[172:175], v16, s[4:7], s31 offen offset:3072 sc1
    s_branch L_earlydone
L_nofold:
    s_waitcnt lgkmcnt(0)
    s_lshr_b32 s31, s75, 28
    s_cmp_eq_u32 s31, 1
    s_cselect_b32 s12, s52, s50
    s_cselect_b32 s13, s53, s51
    s_mov_b32 s14, 5308416
    s_cmp_eq_u32 s31, 2
    s_cselect_b32 s12, s42, s12
    s_cselect_b32 s13, s43, s13
    s_cselect_b32 s14, 663552, s14
    s_cmp_ge_u32 s31, 3
    s_cselect_b32 s12, s48, s12
    s_cselect_b32 s13, s49, s13
    s_cselect_b32 s14, 663552, s14
    s_and_b32 s13, s13, 0xffff
    s_mov_b32 s15, 0x20000
    v_and_b32 v16, 1, v2
    v_mul_lo_u32 v16, v16, s70
    v_lshrrev_b32 v17, 1, v2
    v_mul_lo_u32 v17, v17, s71
    v_lshlrev_b32 v18, 3, v1
    v_add3_u32 v45, v16, v17, v18
    s_mul_i32 s31, s23, s69
    s_add_u32 s31, s31, s68
    s_add_u32 s32, s31, s73
    s_cmp_lt_u32 s75, 0x40000000
    s_cbranch_scc1 L_noxl_53
    v_and_b32 v18, 7, v0
    v_lshlrev_b32 v18, 1, v18
    v_add3_u32 v18, v16, v17, v18
    buffer_load_ushort v96, v18, s[12:15], s31 offen offset:128
    s_add_u32 s31, s31, s72
    buffer_load_ushort v97, v18, s[12:15], s31 offen offset:128
    s_add_u32 s31, s31, s72
    buffer_load_ushort v98, v18, s[12:15], s31 offen offset:128
    s_add_u32 s31, s31, s72
    buffer_load_ushort v99, v18, s[12:15], s31 offen offset:128
    buffer_load_ushort v100, v18, s[12:15], s32 offen offset:128
    s_add_u32 s32, s32, s72
    buffer_load_ushort v101, v18, s[12:15], s32 offen offset:128
    s_add_u32 s32, s32, s72
    buffer_load_ushort v102, v18, s[12:15], s32 offen offset:128
    s_add_u32 s32, s32, s72
    buffer_load_ushort v103, v18, s[12:15], s32 offen offset:128
    s_branch L_xl_54
L_noxl_53:
    buffer_load_dwordx2 v[96:97], v45, s[12:15], s31 offen
    s_add_u32 s31, s31, s72
    buffer_load_dwordx2 v[98:99], v45, s[12:15], s31 offen
    s_add_u32 s31, s31, s72
    buffer_load_dwordx2 v[100:101], v45, s[12:15], s31 offen
    s_add_u32 s31, s31, s72
    buffer_load_dwordx2 v[102:103], v45, s[12:15], s31 offen
    buffer_load_dwordx2 v[104:105], v45, s[12:15], s32 offen
    s_add_u32 s32, s32, s72
    buffer_load_dwordx2 v[106:107], v45, s[12:15], s32 offen
    s_add_u32 s32, s32, s72
    buffer_load_dwordx2 v[108:109], v45, s[12:15], s32 offen
    s_add_u32 s32, s32, s72
    buffer_load_dwordx2 v[110:111], v45, s[12:15], s32 offen
L_xl_54:
    s_waitcnt lgkmcnt(0)
    s_lshr_b32 s31, s83, 28
    s_cmp_eq_u32 s31, 1
    s_cselect_b32 s12, s52, s50
    s_cselect_b32 s13, s53, s51
    s_mov_b32 s14, 5308416
    s_cmp_eq_u32 s31, 2
    s_cselect_b32 s12, s42, s12
    s_cselect_b32 s13, s43, s13
    s_cselect_b32 s14, 663552, s14
    s_and_b32 s13, s13, 0xffff
    s_mov_b32 s15, 0x20000
    v_and_b32 v16, 1, v2
    v_mul_lo_u32 v16, v16, s78
    v_lshrrev_b32 v17, 1, v2
    v_mul_lo_u32 v17, v17, s79
    v_lshlrev_b32 v18, 3, v1
    v_add3_u32 v45, v16, v17, v18
    s_mul_i32 s31, s23, s77
    s_add_u32 s31, s31, s76
    s_add_u32 s32, s31, s81
    buffer_load_dwordx2 v[176:177], v45, s[12:15], s31 offen
    s_add_u32 s31, s31, s80
    buffer_load_dwordx2 v[178:179], v45, s[12:15], s31 offen
    s_add_u32 s31, s31, s80
    buffer_load_dwordx2 v[180:181], v45, s[12:15], s31 offen
    s_add_u32 s31, s31, s80
    buffer_load_dwordx2 v[182:183], v45, s[12:15], s31 offen
    buffer_load_dwordx2 v[184:185], v45, s[12:15], s32 offen
    s_add_u32 s32, s32, s80
    buffer_load_dwordx2 v[186:187], v45, s[12:15], s32 offen
    s_add_u32 s32, s32, s80
    buffer_load_dwordx2 v[188:189], v45, s[12:15], s32 offen
    s_add_u32 s32, s32, s80
    buffer_load_dwordx2 v[190:191], v45, s[12:15], s32 offen
    s_mul_i32 s31, s23, 1504256
    s_add_u32 s31, s31, s74
    s_and_b32 s32, s75, 0xfffffff
    s_mov_b32 s33, 0x05040100
    s_mov_b32 s34, 0x07060302
    s_waitcnt vmcnt(8)
    s_cmp_lt_u32 s75, 0x40000000
    s_cbranch_scc1 L_noxs_55
    v_lshl_or_b32 v224, v97, 16, v96
    v_lshl_or_b32 v225, v99, 16, v98
    v_lshl_or_b32 v226, v101, 16, v100
    v_lshl_or_b32 v227, v103, 16, v102
    v_lshl_add_u32 v16, v2, 3, v1
    v_lshlrev_b32 v16, 4, v16
    v_add_u32 v16, 4096, v16
    v_mov_b32 v17, 0x40000000
    v_cmp_gt_u32 vcc, 8, v1
    s_nop 1
    v_cndmask_b32 v16, v17, v16, vcc
    buffer_store_dwordx4 v[224:227], v16, s[4:7], s31 offen sc1
    s_branch L_xs_56
L_noxs_55:
    v_perm_b32 v224, v98, v96, s33
    v_perm_b32 v225, v102, v100, s33
    v_perm_b32 v226, v106, v104, s33
    v_perm_b32 v227, v110, v108, s33
    buffer_store_dwordx4 v[224:227], v3, s[4:7], s31 offen sc1
    s_add_u32 s31, s31, s32
    v_perm_b32 v228, v98, v96, s34
    v_perm_b32 v229, v102, v100, s34
    v_perm_b32 v230, v106, v104, s34
    v_perm_b32 v231, v110, v108, s34
    buffer_store_dwordx4 v[228:231], v3, s[4:7], s31 offen sc1
    s_add_u32 s31, s31, s32
    v_perm_b32 v232, v99, v97, s33
    v_perm_b32 v233, v103, v101, s33
    v_perm_b32 v234, v107, v105, s33
    v_perm_b32 v235, v111, v109, s33
    buffer_store_dwordx4 v[232:235], v3, s[4:7], s31 offen sc1
    s_add_u32 s31, s31, s32
    v_perm_b32 v236, v99, v97, s34
    v_perm_b32 v237, v103, v101, s34
    v_perm_b32 v238, v107, v105, s34
    v_perm_b32 v239, v111, v109, s34
    buffer_store_dwordx4 v[236:239], v3, s[4:7], s31 offen sc1
L_xs_56:
L_earlydone:
    s_mov_b32 s12, s56
    s_and_b32 s13, s57, 0xffff
    s_mov_b32 s14, 256
    s_mov_b32 s15, 0x20000
    buffer_load_dword v44, off, s[12:15], 0 sc1
    s_waitcnt vmcnt(0)
    v_readfirstlane_b32 s3, v44
    s_nop 0
    s_cmp_ge_u32 s3, 1
    s_cbranch_scc1 L_rdy_57
    s_mov_b32 s12, s56
    s_and_b32 s13, s57, 0xffff
    s_mov_b32 s14, 256
    s_mov_b32 s15, 0x20000
    s_mov_b32 s26, 0
L_poll_58:
    buffer_load_dword v14, off, s[12:15], 0 sc1
    s_waitcnt vmcnt(0)
    v_readfirstlane_b32 s3, v14
    s_nop 0
    s_cmp_ge_u32 s3, 1
    s_cbranch_scc1 L_pdone_59
    s_sleep 2
    s_add_u32 s26, s26, 1
    s_cmp_lt_u32 s26, 40000
    s_cbranch_scc1 L_poll_58
L_pdone_59:
L_rdy_57:
    s_mov_b64 exec, 1
    ds_add_u32 v13, v12 offset:60
    s_mov_b64 exec, -1
    s_mul_i32 s31, s27, 256
    s_add_u32 s31, s31, 24580
    s_mul_i32 s32, s23, 1024
    s_add_u32 s32, s32, 8
    s_waitcnt lgkmcnt(0)
    s_cmp_ge_u32 s22, 18
    s_cselect_b32 s31, s32, s31
    s_cselect_b32 s32, s75, 0x30000000
    s_cmp_lt_u32 s32, 0x30000000
    s_cbranch_scc1 L_nosig_60
    s_mov_b32 s1, 1
    s_atomic_add s1, s[44:45], s31
    s_cmp_lt_u32 s22, 18
    s_cbranch_scc1 L_nosig_60
    s_add_u32 s31, s31, 256
    s_mov_b32 s1, 1
    s_atomic_add s1, s[44:45], s31
    s_add_u32 s31, s31, 256
    s_mov_b32 s1, 1
    s_atomic_add s1, s[44:45], s31
    s_add_u32 s31, s31, 256
    s_mov_b32 s1, 1
    s_atomic_add s1, s[44:45], s31
L_nosig_60:
    s_mov_b32 s8, s36
    s_and_b32 s9, s37, 0xffff
    s_mov_b32 s10, 2359296
    s_mov_b32 s11, 0x20000
    v_add_u32 v4, 65536, v3
    v_add_u32 v5, 131072, v3
    v_lshlrev_b32 v6, 3, v0
    v_add_u32 v6, 155648, v6
    s_lshl_b32 s31, s21, 12
    s_add_u32 s31, s31, 0
    v_add_u32 v7, s31, v3
    s_lshr_b32 s31, s21, 1
    s_lshl_b32 s31, s31, 12
    s_and_b32 s32, s21, 1
    s_lshl_b32 s32, s32, 3
    s_add_u32 s31, s31, s32
    s_add_u32 s31, s31, 32768
    v_add_u32 v8, s31, v3
    v_lshrrev_b32 v16, 2, v1
    v_lshlrev_b32 v16, 13, v16
    v_lshl_add_u32 v16, v2, 6, v16
    v_and_b32 v17, 3, v0
    v_lshl_add_u32 v16, v17, 4, v16
    s_lshl_b32 s31, s23, 10
    s_lshl_b32 s32, s21, 8
    s_add_u32 s31, s31, s32
    s_mul_i32 s32, s22, 589824
    s_add_u32 s31, s31, s32
    s_add_u32 s31, s31, 22020096
    v_add_u32 v9, s31, v16
    v_add_u32 v10, 32768, v9
    s_mul_i32 s92, s23, 1504256
    s_add_u32 s92, s92, 10334208
    s_lshl_b32 s31, s21, 10
    s_add_u32 s94, s92, s31
    s_add_u32 s93, s31, 73728
    s_mul_i32 s31, s27, 256
    s_add_u32 s31, s31, 24580
    s_mov_b32 s26, 0
L_poll_61:
    s_mov_b32 s3, 0
    s_atomic_add s3, s[44:45], s31 glc
    s_waitcnt lgkmcnt(0)
    s_cmp_ge_u32 s3, 18
    s_cbranch_scc1 L_pdone_62
    s_sleep 2
    s_add_u32 s26, s26, 1
    s_cmp_lt_u32 s26, 40000
    s_cbranch_scc1 L_poll_61
L_pdone_62:
    s_mov_b32 s26, 0
L_lw_63:
    ds_read_b32 v14, v13 offset:28
    s_waitcnt lgkmcnt(0)
    v_readfirstlane_b32 s3, v14
    s_nop 0
    s_cmp_ge_u32 s3, 4
    s_cbranch_scc1 L_lwdone_64
    s_sleep 4
    s_add_u32 s26, s26, 1
    s_cmp_lt_u32 s26, 1000000
    s_cbranch_scc1 L_lw_63
L_lwdone_64:
    s_and_b32 s31, s23, 3
    s_mul_i32 s31, s31, 2
    s_lshr_b32 s32, s23, 2
    s_mul_i32 s32, s32, 1
    s_add_u32 s31, s31, s32
    s_mul_i32 s32, s22, 1
    s_add_u32 s31, s31, s32
    s_mul_i32 s32, s31, 7282
    s_lshr_b32 s32, s32, 16
    s_mul_i32 s32, s32, 9
    s_sub_u32 s33, s31, s32
    s_mul_i32 s16, s27, 64512
    s_add_u32 s16, s16, 262144
    s_add_u32 s17, s16, 64512
    s_mul_i32 s33, s33, 7168
    s_add_u32 s24, s16, s33
    buffer_load_dwordx4 v[96:99], v3, s[4:7], s24 offen offset:0 sc1
    buffer_load_dwordx4 v[100:103], v3, s[4:7], s24 offen offset:1024 sc1
    buffer_load_dwordx4 v[104:107], v3, s[4:7], s24 offen offset:2048 sc1
    buffer_load_dwordx4 v[108:111], v3, s[4:7], s24 offen offset:3072 sc1
    s_add_u32 s24, s24, 4096
    buffer_load_dwordx4 v[112:115], v3, s[4:7], s24 offen offset:0 sc1
    buffer_load_dwordx4 v[116:119], v3, s[4:7], s24 offen offset:1024 sc1
    buffer_load_dwordx4 v[120:123], v3, s[4:7], s24 offen offset:2048 sc1
    s_add_u32 s24, s24, 3072
    s_cmp_eq_u32 s24, s17
    s_cselect_b32 s24, s16, s24
    buffer_load_dwordx4 v[124:127], v3, s[4:7], s24 offen offset:0 sc1
    buffer_load_dwordx4 v[128:131], v3, s[4:7], s24 offen offset:1024 sc1
    buffer_load_dwordx4 v[132:135], v3, s[4:7], s24 offen offset:2048 sc1
    buffer_load_dwordx4 v[136:139], v3, s[4:7], s24 offen offset:3072 sc1
    s_add_u32 s24, s24, 4096
    buffer_load_dwordx4 v[140:143], v3, s[4:7], s24 offen offset:0 sc1
    buffer_load_dwordx4 v[144:147], v3, s[4:7], s24 offen offset:1024 sc1
    buffer_load_dwordx4 v[148:151], v3, s[4:7], s24 offen offset:2048 sc1
    s_add_u32 s24, s24, 3072
    s_cmp_eq_u32 s24, s17
    s_cselect_b32 s24, s16, s24
    buffer_load_dwordx4 v[152:155], v3, s[4:7], s24 offen offset:0 sc1
    buffer_load_dwordx4 v[156:159], v3, s[4:7], s24 offen offset:1024 sc1
    buffer_load_dwordx4 v[160:163], v3, s[4:7], s24 offen offset:2048 sc1
    buffer_load_dwordx4 v[164:167], v3, s[4:7], s24 offen offset:3072 sc1
    s_add_u32 s24, s24, 4096
    buffer_load_dwordx4 v[168:171], v3, s[4:7], s24 offen offset:0 sc1
    buffer_load_dwordx4 v[172:175], v3, s[4:7], s24 offen offset:1024 sc1
    s_mul_i32 s31, s23, 1504256
    s_add_u32 s31, s31, s82
    s_and_b32 s32, s83, 0xfffffff
    s_mov_b32 s33, 0x05040100
    s_mov_b32 s34, 0x07060302
    v_perm_b32 v224, v178, v176, s33
    v_perm_b32 v225, v182, v180, s33
    v_perm_b32 v226, v186, v184, s33
    v_perm_b32 v227, v190, v188, s33
    buffer_store_dwordx4 v[224:227], v3, s[4:7], s31 offen sc1
    s_add_u32 s31, s31, s32
    v_perm_b32 v228, v178, v176, s34
    v_perm_b32 v229, v182, v180, s34
    v_perm_b32 v230, v186, v184, s34
    v_perm_b32 v231, v190, v188, s34
    buffer_store_dwordx4 v[228:231], v3, s[4:7], s31 offen sc1
    s_add_u32 s31, s31, s32
    v_perm_b32 v232, v179, v177, s33
    v_perm_b32 v233, v183, v181, s33
    v_perm_b32 v234, v187, v185, s33
    v_perm_b32 v235, v191, v189, s33
    buffer_store_dwordx4 v[232:235], v3, s[4:7], s31 offen sc1
    s_add_u32 s31, s31, s32
    v_perm_b32 v236, v179, v177, s34
    v_perm_b32 v237, v183, v181, s34
    v_perm_b32 v238, v187, v185, s34
    v_perm_b32 v239, v191, v189, s34
    buffer_store_dwordx4 v[236:239], v3, s[4:7], s31 offen sc1
    s_mul_i32 s31, s23, 1024
    s_add_u32 s31, s31, 8200
    s_waitcnt vmcnt(0)
    s_mov_b64 exec, 1
    ds_add_rtn_u32 v14, v13, v12 offset:36
    s_mov_b64 exec, -1
    s_waitcnt lgkmcnt(0)
    v_readfirstlane_b32 s3, v14
    s_nop 0
    s_cmp_lg_u32 s3, 3
    s_cbranch_scc1 L_arr_65
    s_mov_b32 s1, 1
    s_atomic_add s1, s[44:45], s31
    s_add_u32 s31, s31, 256
    s_mov_b32 s1, 1
    s_atomic_add s1, s[44:45], s31
    s_add_u32 s31, s31, 256
    s_mov_b32 s1, 1
    s_atomic_add s1, s[44:45], s31
    s_add_u32 s31, s31, 256
    s_mov_b32 s1, 1
    s_atomic_add s1, s[44:45], s31
L_arr_65:
    s_mov_b32 s26, 0
L_lw_66:
    ds_read_b32 v14, v13 offset:28
    s_waitcnt lgkmcnt(0)
    v_readfirstlane_b32 s3, v14
    s_nop 0
    s_cmp_ge_u32 s3, 4
    s_cbranch_scc1 L_lwdone_67
    s_add_u32 s26, s26, 1
    s_cmp_lt_u32 s26, 1000000
    s_cbranch_scc1 L_lw_66
L_lwdone_67:
    ds_read_b128 v[64:67], v3 offset:0
    ds_read_b128 v[68:71], v3 offset:18432
    ds_read_b128 v[72:75], v3 offset:36864
    ds_read_b128 v[76:79], v3 offset:55296
    s_setprio 2
    s_waitcnt lgkmcnt(0)
    v_mfma_f32_16x16x32_bf16 v[176:179], v[96:99], v[64:67], 0
    ds_read_b128 v[80:83], v3 offset:1024
    v_mfma_f32_16x16x32_bf16 v[180:183], v[96:99], v[68:71], 0
    ds_read_b128 v[84:87], v3 offset:19456
    v_mfma_f32_16x16x32_bf16 v[184:187], v[96:99], v[72:75], 0
    ds_read_b128 v[88:91], v3 offset:37888
    v_mfma_f32_16x16x32_bf16 v[188:191], v[96:99], v[76:79], 0
    v_mfma_f32_16x16x32_bf16 v[204:207], v[100:103], v[76:79], 0
    s_setprio 3
    s_mov_b32 s26, 0
L_lw_68:
    ds_read_b32 v14, v13 offset:16
    s_waitcnt lgkmcnt(0)
    v_readfirstlane_b32 s3, v14
    s_nop 0
    s_cmp_ge_u32 s3, 4
    s_cbranch_scc1 L_lwdone_69
    s_sleep 4
    s_add_u32 s26, s26, 1
    s_cmp_lt_u32 s26, 1000000
    s_cbranch_scc1 L_lw_68
L_lwdone_69:
    s_setprio 2
    buffer_load_dwordx4 v[96:99], v3, s[4:7], s24 offen offset:2048 sc1
    v_mfma_f32_16x16x32_bf16 v[200:203], v[100:103], v[72:75], 0
    ds_read_b128 v[92:95], v3 offset:56320
    v_mfma_f32_16x16x32_bf16 v[196:199], v[100:103], v[68:71], 0
    s_add_u32 s24, s24, 3072
    s_cmp_eq_u32 s24, s17
    s_cselect_b32 s24, s16, s24
    v_mfma_f32_16x16x32_bf16 v[192:195], v[100:103], v[64:67], 0
    v_mfma_f32_16x16x32_bf16 v[208:211], v[64:67], v[104:107], 0
    buffer_load_dwordx4 v[100:103], v3, s[4:7], s24 offen offset:0 sc1
    v_mfma_f32_16x16x32_bf16 v[212:215], v[68:71], v[104:107], 0
    v_mfma_f32_16x16x32_bf16 v[216:219], v[72:75], v[104:107], 0
    v_mfma_f32_16x16x32_bf16 v[220:223], v[76:79], v[104:107], 0
    v_mfma_f32_16x16x32_bf16 v[236:239], v[108:111], v[76:79], 0
    buffer_load_dwordx4 v[104:107], v3, s[4:7], s24 offen offset:1024 sc1
    v_mfma_f32_16x16x32_bf16 v[232:235], v[108:111], v[72:75], 0
    v_mfma_f32_16x16x32_bf16 v[228:231], v[108:111], v[68:71], 0
    v_mfma_f32_16x16x32_bf16 v[224:227], v[108:111], v[64:67], 0
    s_waitcnt lgkmcnt(0)
    v_mfma_f32_16x16x32_bf16 v[240:243], v[108:111], v[80:83], 0
    ds_read_b128 v[64:67], v3 offset:2048
    v_mfma_f32_16x16x32_bf16 v[244:247], v[108:111], v[84:87], 0
    ds_read_b128 v[68:71], v3 offset:20480
    v_mfma_f32_16x16x32_bf16 v[248:251], v[108:111], v[88:91], 0
    ds_read_b128 v[72:75], v3 offset:38912
    v_mfma_f32_16x16x32_bf16 v[252:255], v[108:111], v[92:95], 0
    v_mfma_f32_16x16x32_bf16 v[188:191], v[112:115], v[92:95], v[188:191]
    buffer_load_dwordx4 v[108:111], v3, s[4:7], s24 offen offset:2048 sc1
    v_mfma_f32_16x16x32_bf16 v[184:187], v[112:115], v[88:91], v[184:187]
    ds_read_b128 v[76:79], v3 offset:57344
    v_mfma_f32_16x16x32_bf16 v[180:183], v[112:115], v[84:87], v[180:183]
    v_mfma_f32_16x16x32_bf16 v[176:179], v[112:115], v[80:83], v[176:179]
    v_mfma_f32_16x16x32_bf16 v[192:195], v[116:119], v[80:83], v[192:195]
    buffer_load_dwordx4 v[112:115], v3, s[4:7], s24 offen offset:3072 sc1
    v_mfma_f32_16x16x32_bf16 v[196:199], v[116:119], v[84:87], v[196:199]
    v_mfma_f32_16x16x32_bf16 v[200:203], v[116:119], v[88:91], v[200:203]
    s_add_u32 s24, s24, 4096
    v_mfma_f32_16x16x32_bf16 v[204:207], v[116:119], v[92:95], v[204:207]
    v_mfma_f32_16x16x32_bf16 v[220:223], v[92:95], v[120:123], v[220:223]
    buffer_load_dwordx4 v[116:119], v3, s[4:7], s24 offen offset:0 sc1
    v_mfma_f32_16x16x32_bf16 v[216:219], v[88:91], v[120:123], v[216:219]
    v_mfma_f32_16x16x32_bf16 v[212:215], v[84:87], v[120:123], v[212:215]
    v_mfma_f32_16x16x32_bf16 v[208:211], v[80:83], v[120:123], v[208:211]
    s_waitcnt lgkmcnt(0)
    v_mfma_f32_16x16x32_bf16 v[176:179], v[124:127], v[64:67], v[176:179]
    buffer_load_dwordx4 v[120:123], v3, s[4:7], s24 offen offset:1024 sc1
    v_mfma_f32_16x16x32_bf16 v[180:183], v[124:127], v[68:71], v[180:183]
    ds_read_b128 v[80:83], v3 offset:3072
    v_mfma_f32_16x16x32_bf16 v[184:187], v[124:127], v[72:75], v[184:187]
    ds_read_b128 v[84:87], v3 offset:21504
    v_mfma_f32_16x16x32_bf16 v[188:191], v[124:127], v[76:79], v[188:191]
    v_mfma_f32_16x16x32_bf16 v[204:207], v[128:131], v[76:79], v[204:207]
    buffer_load_dwordx4 v[124:127], v3, s[4:7], s24 offen offset:2048 sc1
    v_mfma_f32_16x16x32_bf16 v[200:203], v[128:131], v[72:75], v[200:203]
    ds_read_b128 v[88:91], v3 offset:39936
    v_mfma_f32_16x16x32_bf16 v[196:199], v[128:131], v[68:71], v[196:199]
    s_add_u32 s24, s24, 3072
    s_cmp_eq_u32 s24, s17
    s_cselect_b32 s24, s16, s24
    v_mfma_f32_16x16x32_bf16 v[192:195], v[128:131], v[64:67], v[192:195]
    v_mfma_f32_16x16x32_bf16 v[208:211], v[64:67], v[132:135], v[208:211]
    buffer_load_dwordx4 v[128:131], v3, s[4:7], s24 offen offset:0 sc1
    v_mfma_f32_16x16x32_bf16 v[212:215], v[68:71], v[132:135], v[212:215]
    ds_read_b128 v[92:95], v3 offset:58368
    v_mfma_f32_16x16x32_bf16 v[216:219], v[72:75], v[132:135], v[216:219]
    v_mfma_f32_16x16x32_bf16 v[220:223], v[76:79], v[132:135], v[220:223]
    v_mfma_f32_16x16x32_bf16 v[236:239], v[136:139], v[76:79], v[236:239]
    buffer_load_dwordx4 v[132:135], v3, s[4:7], s24 offen offset:1024 sc1
    v_mfma_f32_16x16x32_bf16 v[232:235], v[136:139], v[72:75], v[232:235]
    v_mfma_f32_16x16x32_bf16 v[228:231], v[136:139], v[68:71], v[228:231]
    v_mfma_f32_16x16x32_bf16 v[224:227], v[136:139], v[64:67], v[224:227]
    s_waitcnt lgkmcnt(0)
    v_mfma_f32_16x16x32_bf16 v[240:243], v[136:139], v[80:83], v[240:243]
    ds_read_b128 v[64:67], v3 offset:4096
    v_mfma_f32_16x16x32_bf16 v[244:247], v[136:139], v[84:87], v[244:247]
    ds_read_b128 v[68:71], v3 offset:22528
    v_mfma_f32_16x16x32_bf16 v[248:251], v[136:139], v[88:91], v[248:251]
    ds_read_b128 v[72:75], v3 offset:40960
    v_mfma_f32_16x16x32_bf16 v[252:255], v[136:139], v[92:95], v[252:255]
    v_mfma_f32_16x16x32_bf16 v[188:191], v[140:143], v[92:95], v[188:191]
    buffer_load_dwordx4 v[136:139], v3, s[4:7], s24 offen offset:2048 sc1
    v_mfma_f32_16x16x32_bf16 v[184:187], v[140:143], v[88:91], v[184:187]
    ds_read_b128 v[76:79], v3 offset:59392
    v_mfma_f32_16x16x32_bf16 v[180:183], v[140:143], v[84:87], v[180:183]
    v_mfma_f32_16x16x32_bf16 v[176:179], v[140:143], v[80:83], v[176:179]
    v_mfma_f32_16x16x32_bf16 v[192:195], v[144:147], v[80:83], v[192:195]
    buffer_load_dwordx4 v[140:143], v3, s[4:7], s24 offen offset:3072 sc1
    v_mfma_f32_16x16x32_bf16 v[196:199], v[144:147], v[84:87], v[196:199]
    v_mfma_f32_16x16x32_bf16 v[200:203], v[144:147], v[88:91], v[200:203]
    s_add_u32 s24, s24, 4096
    v_mfma_f32_16x16x32_bf16 v[204:207], v[144:147], v[92:95], v[204:207]
    v_mfma_f32_16x16x32_bf16 v[220:223], v[92:95], v[148:151], v[220:223]
    buffer_load_dwordx4 v[144:147], v3, s[4:7], s24 offen offset:0 sc1
    v_mfma_f32_16x16x32_bf16 v[216:219], v[88:91], v[148:151], v[216:219]
    v_mfma_f32_16x16x32_bf16 v[212:215], v[84:87], v[148:151], v[212:215]
    v_mfma_f32_16x16x32_bf16 v[208:211], v[80:83], v[148:151], v[208:211]
    s_waitcnt lgkmcnt(0)
    v_mfma_f32_16x16x32_bf16 v[176:179], v[152:155], v[64:67], v[176:179]
    buffer_load_dwordx4 v[148:151], v3, s[4:7], s24 offen offset:1024 sc1
    v_mfma_f32_16x16x32_bf16 v[180:183], v[152:155], v[68:71], v[180:183]
    ds_read_b128 v[80:83], v3 offset:5120
    v_mfma_f32_16x16x32_bf16 v[184:187], v[152:155], v[72:75], v[184:187]
    ds_read_b128 v[84:87], v3 offset:23552
    v_mfma_f32_16x16x32_bf16 v[188:191], v[152:155], v[76:79], v[188:191]
    v_mfma_f32_16x16x32_bf16 v[204:207], v[156:159], v[76:79], v[204:207]
    buffer_load_dwordx4 v[152:155], v3, s[4:7], s24 offen offset:2048 sc1
    v_mfma_f32_16x16x32_bf16 v[200:203], v[156:159], v[72:75], v[200:203]
    ds_read_b128 v[88:91], v3 offset:41984
    v_mfma_f32_16x16x32_bf16 v[196:199], v[156:159], v[68:71], v[196:199]
    s_add_u32 s24, s24, 3072
    s_cmp_eq_u32 s24, s17
    s_cselect_b32 s24, s16, s24
    v_mfma_f32_16x16x32_bf16 v[192:195], v[156:159], v[64:67], v[192:195]
    v_mfma_f32_16x16x32_bf16 v[208:211], v[64:67], v[160:163], v[208:211]
    buffer_load_dwordx4 v[156:159], v3, s[4:7], s24 offen offset:0 sc1
    v_mfma_f32_16x16x32_bf16 v[212:215], v[68:71], v[160:163], v[212:215]
    ds_read_b128 v[92:95], v3 offset:60416
    v_mfma_f32_16x16x32_bf16 v[216:219], v[72:75], v[160:163], v[216:219]
    v_mfma_f32_16x16x32_bf16 v[220:223], v[76:79], v[160:163], v[220:223]
    v_mfma_f32_16x16x32_bf16 v[236:239], v[164:167], v[76:79], v[236:239]
    buffer_load_dwordx4 v[160:163], v3, s[4:7], s24 offen offset:1024 sc1
    v_mfma_f32_16x16x32_bf16 v[232:235], v[164:167], v[72:75], v[232:235]
    v_mfma_f32_16x16x32_bf16 v[228:231], v[164:167], v[68:71], v[228:231]
    v_mfma_f32_16x16x32_bf16 v[224:227], v[164:167], v[64:67], v[224:227]
    s_waitcnt lgkmcnt(0)
    v_mfma_f32_16x16x32_bf16 v[240:243], v[164:167], v[80:83], v[240:243]
    ds_read_b128 v[64:67], v3 offset:6144
    v_mfma_f32_16x16x32_bf16 v[244:247], v[164:167], v[84:87], v[244:247]
    ds_read_b128 v[68:71], v3 offset:24576
    v_mfma_f32_16x16x32_bf16 v[248:251], v[164:167], v[88:91], v[248:251]
    ds_read_b128 v[72:75], v3 offset:43008
    v_mfma_f32_16x16x32_bf16 v[252:255], v[164:167], v[92:95], v[252:255]
    v_mfma_f32_16x16x32_bf16 v[188:191], v[168:171], v[92:95], v[188:191]
    buffer_load_dwordx4 v[164:167], v3, s[4:7], s24 offen offset:2048 sc1
    v_mfma_f32_16x16x32_bf16 v[184:187], v[168:171], v[88:91], v[184:187]
    ds_read_b128 v[76:79], v3 offset:61440
    v_mfma_f32_16x16x32_bf16 v[180:183], v[168:171], v[84:87], v[180:183]
    v_mfma_f32_16x16x32_bf16 v[176:179], v[168:171], v[80:83], v[176:179]
    s_waitcnt vmcnt(17)
    v_mfma_f32_16x16x32_bf16 v[192:195], v[172:175], v[80:83], v[192:195]
    buffer_load_dwordx4 v[168:171], v3, s[4:7], s24 offen offset:3072 sc1
    v_mfma_f32_16x16x32_bf16 v[196:199], v[172:175], v[84:87], v[196:199]
    v_mfma_f32_16x16x32_bf16 v[200:203], v[172:175], v[88:91], v[200:203]
    s_add_u32 s24, s24, 4096
    v_mfma_f32_16x16x32_bf16 v[204:207], v[172:175], v[92:95], v[204:207]
    v_mfma_f32_16x16x32_bf16 v[220:223], v[92:95], v[96:99], v[220:223]
    buffer_load_dwordx4 v[172:175], v3, s[4:7], s24 offen offset:0 sc1
    v_mfma_f32_16x16x32_bf16 v[216:219], v[88:91], v[96:99], v[216:219]
    v_mfma_f32_16x16x32_bf16 v[212:215], v[84:87], v[96:99], v[212:215]
    v_mfma_f32_16x16x32_bf16 v[208:211], v[80:83], v[96:99], v[208:211]
    s_waitcnt vmcnt(17) lgkmcnt(0)
    v_mfma_f32_16x16x32_bf16 v[176:179], v[100:103], v[64:67], v[176:179]
    s_setprio 3
    s_mov_b32 s26, 0
L_lw_70:
    ds_read_b32 v14, v13 offset:4
    s_waitcnt lgkmcnt(0)
    v_readfirstlane_b32 s3, v14
    s_nop 0
    s_cmp_ge_u32 s3, 4
    s_cbranch_scc1 L_lwdone_71
    s_sleep 4
    s_add_u32 s26, s26, 1
    s_cmp_lt_u32 s26, 1000000
    s_cbranch_scc1 L_lw_70
L_lwdone_71:
    s_setprio 2
    buffer_load_dwordx4 v[96:99], v3, s[4:7], s24 offen offset:1024 sc1
    v_mfma_f32_16x16x32_bf16 v[180:183], v[100:103], v[68:71], v[180:183]
    ds_read_b128 v[80:83], v3 offset:7168
    v_mfma_f32_16x16x32_bf16 v[184:187], v[100:103], v[72:75], v[184:187]
    ds_read_b128 v[84:87], v3 offset:25600
    v_mfma_f32_16x16x32_bf16 v[188:191], v[100:103], v[76:79], v[188:191]
    v_mfma_f32_16x16x32_bf16 v[204:207], v[104:107], v[76:79], v[204:207]
    buffer_load_dwordx4 v[100:103], v3, s[4:7], s24 offen offset:2048 sc1
    v_mfma_f32_16x16x32_bf16 v[200:203], v[104:107], v[72:75], v[200:203]
    ds_read_b128 v[88:91], v3 offset:44032
    v_mfma_f32_16x16x32_bf16 v[196:199], v[104:107], v[68:71], v[196:199]
    s_add_u32 s24, s24, 3072
    s_cmp_eq_u32 s24, s17
    s_cselect_b32 s24, s16, s24
    v_mfma_f32_16x16x32_bf16 v[192:195], v[104:107], v[64:67], v[192:195]
    s_waitcnt vmcnt(17)
    v_mfma_f32_16x16x32_bf16 v[208:211], v[64:67], v[108:111], v[208:211]
    buffer_load_dwordx4 v[104:107], v3, s[4:7], s24 offen offset:0 sc1
    v_mfma_f32_16x16x32_bf16 v[212:215], v[68:71], v[108:111], v[212:215]
    ds_read_b128 v[92:95], v3 offset:62464
    v_mfma_f32_16x16x32_bf16 v[216:219], v[72:75], v[108:111], v[216:219]
    v_mfma_f32_16x16x32_bf16 v[220:223], v[76:79], v[108:111], v[220:223]
    v_mfma_f32_16x16x32_bf16 v[236:239], v[112:115], v[76:79], v[236:239]
    buffer_load_dwordx4 v[108:111], v3, s[4:7], s24 offen offset:1024 sc1
    v_mfma_f32_16x16x32_bf16 v[232:235], v[112:115], v[72:75], v[232:235]
    v_mfma_f32_16x16x32_bf16 v[228:231], v[112:115], v[68:71], v[228:231]
    v_mfma_f32_16x16x32_bf16 v[224:227], v[112:115], v[64:67], v[224:227]
    s_waitcnt vmcnt(18) lgkmcnt(0)
    v_mfma_f32_16x16x32_bf16 v[240:243], v[112:115], v[80:83], v[240:243]
    ds_read_b128 v[64:67], v3 offset:8192
    v_mfma_f32_16x16x32_bf16 v[244:247], v[112:115], v[84:87], v[244:247]
    ds_read_b128 v[68:71], v3 offset:26624
    v_mfma_f32_16x16x32_bf16 v[248:251], v[112:115], v[88:91], v[248:251]
    ds_read_b128 v[72:75], v3 offset:45056
    v_mfma_f32_16x16x32_bf16 v[252:255], v[112:115], v[92:95], v[252:255]
    v_mfma_f32_16x16x32_bf16 v[188:191], v[116:119], v[92:95], v[188:191]
    buffer_load_dwordx4 v[112:115], v3, s[4:7], s24 offen offset:2048 sc1
    v_mfma_f32_16x16x32_bf16 v[184:187], v[116:119], v[88:91], v[184:187]
    ds_read_b128 v[76:79], v3 offset:63488
    v_mfma_f32_16x16x32_bf16 v[180:183], v[116:119], v[84:87], v[180:183]
    v_mfma_f32_16x16x32_bf16 v[176:179], v[116:119], v[80:83], v[176:179]
    s_waitcnt vmcnt(17)
    v_mfma_f32_16x16x32_bf16 v[192:195], v[120:123], v[80:83], v[192:195]
    buffer_load_dwordx4 v[116:119], v3, s[4:7], s24 offen offset:3072 sc1
    v_mfma_f32_16x16x32_bf16 v[196:199], v[120:123], v[84:87], v[196:199]
    v_mfma_f32_16x16x32_bf16 v[200:203], v[120:123], v[88:91], v[200:203]
    s_add_u32 s24, s24, 4096
    v_mfma_f32_16x16x32_bf16 v[204:207], v[120:123], v[92:95], v[204:207]
    v_mfma_f32_16x16x32_bf16 v[220:223], v[92:95], v[124:127], v[220:223]
    buffer_load_dwordx4 v[120:123], v3, s[4:7], s24 offen offset:0 sc1
    v_mfma_f32_16x16x32_bf16 v[216:219], v[88:91], v[124:127], v[216:219]
    v_mfma_f32_16x16x32_bf16 v[212:215], v[84:87], v[124:127], v[212:215]
    v_mfma_f32_16x16x32_bf16 v[208:211], v[80:83], v[124:127], v[208:211]
    s_waitcnt vmcnt(17) lgkmcnt(0)
    v_mfma_f32_16x16x32_bf16 v[176:179], v[128:131], v[64:67], v[176:179]
    buffer_load_dwordx4 v[124:127], v3, s[4:7], s24 offen offset:1024 sc1
    v_mfma_f32_16x16x32_bf16 v[180:183], v[128:131], v[68:71], v[180:183]
    ds_read_b128 v[80:83], v3 offset:9216
    v_mfma_f32_16x16x32_bf16 v[184:187], v[128:131], v[72:75], v[184:187]
    ds_read_b128 v[84:87], v3 offset:27648
    v_mfma_f32_16x16x32_bf16 v[188:191], v[128:131], v[76:79], v[188:191]
    v_mfma_f32_16x16x32_bf16 v[204:207], v[132:135], v[76:79], v[204:207]
    buffer_load_dwordx4 v[128:131], v3, s[4:7], s24 offen offset:2048 sc1
    v_mfma_f32_16x16x32_bf16 v[200:203], v[132:135], v[72:75], v[200:203]
    ds_read_b128 v[88:91], v3 offset:46080
    v_mfma_f32_16x16x32_bf16 v[196:199], v[132:135], v[68:71], v[196:199]
    s_add_u32 s24, s24, 3072
    s_cmp_eq_u32 s24, s17
    s_cselect_b32 s24, s16, s24
    v_mfma_f32_16x16x32_bf16 v[192:195], v[132:135], v[64:67], v[192:195]
    s_waitcnt vmcnt(17)
    v_mfma_f32_16x16x32_bf16 v[208:211], v[64:67], v[136:139], v[208:211]
    buffer_load_dwordx4 v[132:135], v3, s[4:7], s24 offen offset:0 sc1
    v_mfma_f32_16x16x32_bf16 v[212:215], v[68:71], v[136:139], v[212:215]
    ds_read_b128 v[92:95], v3 offset:64512
    v_mfma_f32_16x16x32_bf16 v[216:219], v[72:75], v[136:139], v[216:219]
    v_mfma_f32_16x16x32_bf16 v[220:223], v[76:79], v[136:139], v[220:223]
    v_mfma_f32_16x16x32_bf16 v[236:239], v[140:143], v[76:79], v[236:239]
    buffer_load_dwordx4 v[136:139], v3, s[4:7], s24 offen offset:1024 sc1
    v_mfma_f32_16x16x32_bf16 v[232:235], v[140:143], v[72:75], v[232:235]
    v_mfma_f32_16x16x32_bf16 v[228:231], v[140:143], v[68:71], v[228:231]
    v_mfma_f32_16x16x32_bf16 v[224:227], v[140:143], v[64:67], v[224:227]
    s_waitcnt vmcnt(18) lgkmcnt(0)
    v_mfma_f32_16x16x32_bf16 v[240:243], v[140:143], v[80:83], v[240:243]
    ds_read_b128 v[64:67], v3 offset:10240
    v_mfma_f32_16x16x32_bf16 v[244:247], v[140:143], v[84:87], v[244:247]
    ds_read_b128 v[68:71], v3 offset:28672
    v_mfma_f32_16x16x32_bf16 v[248:251], v[140:143], v[88:91], v[248:251]
    ds_read_b128 v[72:75], v3 offset:47104
    v_mfma_f32_16x16x32_bf16 v[252:255], v[140:143], v[92:95], v[252:255]
    v_mfma_f32_16x16x32_bf16 v[188:191], v[144:147], v[92:95], v[188:191]
    buffer_load_dwordx4 v[140:143], v3, s[4:7], s24 offen offset:2048 sc1
    v_mfma_f32_16x16x32_bf16 v[184:187], v[144:147], v[88:91], v[184:187]
    ds_read_b128 v[76:79], v4 offset:0
    v_mfma_f32_16x16x32_bf16 v[180:183], v[144:147], v[84:87], v[180:183]
    v_mfma_f32_16x16x32_bf16 v[176:179], v[144:147], v[80:83], v[176:179]
    s_waitcnt vmcnt(17)
    v_mfma_f32_16x16x32_bf16 v[192:195], v[148:151], v[80:83], v[192:195]
    buffer_load_dwordx4 v[144:147], v3, s[4:7], s24 offen offset:3072 sc1
    v_mfma_f32_16x16x32_bf16 v[196:199], v[148:151], v[84:87], v[196:199]
    v_mfma_f32_16x16x32_bf16 v[200:203], v[148:151], v[88:91], v[200:203]
    s_add_u32 s24, s24, 4096
    v_mfma_f32_16x16x32_bf16 v[204:207], v[148:151], v[92:95], v[204:207]
    v_mfma_f32_16x16x32_bf16 v[220:223], v[92:95], v[152:155], v[220:223]
    buffer_load_dwordx4 v[148:151], v3, s[4:7], s24 offen offset:0 sc1
    v_mfma_f32_16x16x32_bf16 v[216:219], v[88:91], v[152:155], v[216:219]
    v_mfma_f32_16x16x32_bf16 v[212:215], v[84:87], v[152:155], v[212:215]
    v_mfma_f32_16x16x32_bf16 v[208:211], v[80:83], v[152:155], v[208:211]
    s_waitcnt vmcnt(17) lgkmcnt(0)
    v_mfma_f32_16x16x32_bf16 v[176:179], v[156:159], v[64:67], v[176:179]
    buffer_load_dwordx4 v[152:155], v3, s[4:7], s24 offen offset:1024 sc1
    v_mfma_f32_16x16x32_bf16 v[180:183], v[156:159], v[68:71], v[180:183]
    ds_read_b128 v[80:83], v3 offset:11264
    v_mfma_f32_16x16x32_bf16 v[184:187], v[156:159], v[72:75], v[184:187]
    ds_read_b128 v[84:87], v3 offset:29696
    v_mfma_f32_16x16x32_bf16 v[188:191], v[156:159], v[76:79], v[188:191]
    v_mfma_f32_16x16x32_bf16 v[204:207], v[160:163], v[76:79], v[204:207]
    buffer_load_dwordx4 v[156:159], v3, s[4:7], s24 offen offset:2048 sc1
    v_mfma_f32_16x16x32_bf16 v[200:203], v[160:163], v[72:75], v[200:203]
    ds_read_b128 v[88:91], v3 offset:48128
    v_mfma_f32_16x16x32_bf16 v[196:199], v[160:163], v[68:71], v[196:199]
    s_add_u32 s24, s24, 3072
    s_cmp_eq_u32 s24, s17
    s_cselect_b32 s24, s16, s24
    v_mfma_f32_16x16x32_bf16 v[192:195], v[160:163], v[64:67], v[192:195]
    s_waitcnt vmcnt(17)
    v_mfma_f32_16x16x32_bf16 v[208:211], v[64:67], v[164:167], v[208:211]
    buffer_load_dwordx4 v[160:163], v3, s[4:7], s24 offen offset:0 sc1
    v_mfma_f32_16x16x32_bf16 v[212:215], v[68:71], v[164:167], v[212:215]
    ds_read_b128 v[92:95], v4 offset:1024
    v_mfma_f32_16x16x32_bf16 v[216:219], v[72:75], v[164:167], v[216:219]
    v_mfma_f32_16x16x32_bf16 v[220:223], v[76:79], v[164:167], v[220:223]
    v_mfma_f32_16x16x32_bf16 v[236:239], v[168:171], v[76:79], v[236:239]
    buffer_load_dwordx4 v[164:167], v3, s[4:7], s24 offen offset:1024 sc1
    v_mfma_f32_16x16x32_bf16 v[232:235], v[168:171], v[72:75], v[232:235]
    v_mfma_f32_16x16x32_bf16 v[228:231], v[168:171], v[68:71], v[228:231]
    v_mfma_f32_16x16x32_bf16 v[224:227], v[168:171], v[64:67], v[224:227]
    s_waitcnt vmcnt(18) lgkmcnt(0)
    v_mfma_f32_16x16x32_bf16 v[240:243], v[168:171], v[80:83], v[240:243]
    ds_read_b128 v[64:67], v3 offset:12288
    v_mfma_f32_16x16x32_bf16 v[244:247], v[168:171], v[84:87], v[244:247]
    ds_read_b128 v[68:71], v3 offset:30720
    v_mfma_f32_16x16x32_bf16 v[248:251], v[168:171], v[88:91], v[248:251]
    ds_read_b128 v[72:75], v3 offset:49152
    v_mfma_f32_16x16x32_bf16 v[252:255], v[168:171], v[92:95], v[252:255]
    v_mfma_f32_16x16x32_bf16 v[188:191], v[172:175], v[92:95], v[188:191]
    buffer_load_dwordx4 v[168:171], v3, s[4:7], s24 offen offset:2048 sc1
    v_mfma_f32_16x16x32_bf16 v[184:187], v[172:175], v[88:91], v[184:187]
    ds_read_b128 v[76:79], v4 offset:2048
    v_mfma_f32_16x16x32_bf16 v[180:183], v[172:175], v[84:87], v[180:183]
    v_mfma_f32_16x16x32_bf16 v[176:179], v[172:175], v[80:83], v[176:179]
    s_waitcnt vmcnt(17)
    v_mfma_f32_16x16x32_bf16 v[192:195], v[96:99], v[80:83], v[192:195]
    buffer_load_dwordx4 v[172:175], v3, s[4:7], s24 offen offset:3072 sc1
    v_mfma_f32_16x16x32_bf16 v[196:199], v[96:99], v[84:87], v[196:199]
    v_mfma_f32_16x16x32_bf16 v[200:203], v[96:99], v[88:91], v[200:203]
    s_add_u32 s24, s24, 4096
    v_mfma_f32_16x16x32_bf16 v[204:207], v[96:99], v[92:95], v[204:207]
    v_mfma_f32_16x16x32_bf16 v[220:223], v[92:95], v[100:103], v[220:223]
    buffer_load_dwordx4 v[96:99], v3, s[4:7], s24 offen offset:0 sc1
    v_mfma_f32_16x16x32_bf16 v[216:219], v[88:91], v[100:103], v[216:219]
    v_mfma_f32_16x16x32_bf16 v[212:215], v[84:87], v[100:103], v[212:215]
    v_mfma_f32_16x16x32_bf16 v[208:211], v[80:83], v[100:103], v[208:211]
    s_waitcnt vmcnt(17) lgkmcnt(0)
    v_mfma_f32_16x16x32_bf16 v[176:179], v[104:107], v[64:67], v[176:179]
    buffer_load_dwordx4 v[100:103], v3, s[4:7], s24 offen offset:1024 sc1
    v_mfma_f32_16x16x32_bf16 v[180:183], v[104:107], v[68:71], v[180:183]
    ds_read_b128 v[80:83], v3 offset:13312
    v_mfma_f32_16x16x32_bf16 v[184:187], v[104:107], v[72:75], v[184:187]
    ds_read_b128 v[84:87], v3 offset:31744
    v_mfma_f32_16x16x32_bf16 v[188:191], v[104:107], v[76:79], v[188:191]
    v_mfma_f32_16x16x32_bf16 v[204:207], v[108:111], v[76:79], v[204:207]
    s_lshr_b32 s31, s91, 28
    s_cmp_eq_u32 s31, 1
    s_cselect_b32 s12, s52, s50
    s_cselect_b32 s13, s53, s51
    s_mov_b32 s14, 5308416
    s_cmp_eq_u32 s31, 2
    s_cselect_b32 s12, s42, s12
    s_cselect_b32 s13, s43, s13
    s_cselect_b32 s14, 663552, s14
    s_and_b32 s13, s13, 0xffff
    s_mov_b32 s15, 0x20000
    v_and_b32 v16, 1, v2
    v_mul_lo_u32 v16, v16, s86
    v_lshrrev_b32 v17, 1, v2
    v_mul_lo_u32 v17, v17, s87
    v_lshlrev_b32 v18, 3, v1
    v_add3_u32 v45, v16, v17, v18
    s_mul_i32 s31, s23, s85
    s_add_u32 s31, s31, s84
    s_add_u32 s32, s31, s89
    buffer_load_dwordx2 v[24:25], v45, s[12:15], s31 offen
    s_add_u32 s31, s31, s88
    buffer_load_dwordx2 v[26:27], v45, s[12:15], s31 offen
    s_add_u32 s31, s31, s88
    buffer_load_dwordx2 v[28:29], v45, s[12:15], s31 offen
    s_add_u32 s31, s31, s88
    buffer_load_dwordx2 v[30:31], v45, s[12:15], s31 offen
    buffer_load_dwordx2 v[32:33], v45, s[12:15], s32 offen
    s_add_u32 s32, s32, s88
    buffer_load_dwordx2 v[34:35], v45, s[12:15], s32 offen
    s_add_u32 s32, s32, s88
    buffer_load_dwordx2 v[36:37], v45, s[12:15], s32 offen
    s_add_u32 s32, s32, s88
    buffer_load_dwordx2 v[38:39], v45, s[12:15], s32 offen
    s_cmp_ge_u32 s66, 67108864
    s_cbranch_scc1 L_opt_72
    s_lshr_b32 s31, s67, 28
    s_cmp_eq_u32 s31, 1
    s_cselect_b32 s12, s52, s50
    s_cselect_b32 s13, s53, s51
    s_mov_b32 s14, 5308416
    s_cmp_eq_u32 s31, 2
    s_cselect_b32 s12, s42, s12
    s_cselect_b32 s13, s43, s13
    s_cselect_b32 s14, 663552, s14
    s_and_b32 s13, s13, 0xffff
    s_mov_b32 s15, 0x20000
    v_and_b32 v16, 1, v2
    v_mul_lo_u32 v16, v16, s62
    v_lshrrev_b32 v17, 1, v2
    v_mul_lo_u32 v17, v17, s63
    v_lshlrev_b32 v18, 3, v1
    v_add3_u32 v45, v16, v17, v18
    s_mul_i32 s31, s23, s61
    s_add_u32 s31, s31, s60
    s_add_u32 s32, s31, s65
    buffer_load_dwordx2 v[48:49], v45, s[12:15], s31 offen
    s_add_u32 s31, s31, s64
    buffer_load_dwordx2 v[50:51], v45, s[12:15], s31 offen
    s_add_u32 s31, s31, s64
    buffer_load_dwordx2 v[52:53], v45, s[12:15], s31 offen
    s_add_u32 s31, s31, s64
    buffer_load_dwordx2 v[54:55], v45, s[12:15], s31 offen
    buffer_load_dwordx2 v[56:57], v45, s[12:15], s32 offen
    s_add_u32 s32, s32, s64
    buffer_load_dwordx2 v[58:59], v45, s[12:15], s32 offen
    s_add_u32 s32, s32, s64
    buffer_load_dwordx2 v[60:61], v45, s[12:15], s32 offen
    s_add_u32 s32, s32, s64
    buffer_load_dwordx2 v[62:63], v45, s[12:15], s32 offen
L_opt_72:
    buffer_load_dwordx4 v[104:107], v3, s[4:7], s24 offen offset:2048 sc1
    v_mfma_f32_16x16x32_bf16 v[200:203], v[108:111], v[72:75], v[200:203]
    ds_read_b128 v[88:91], v3 offset:50176
    v_mfma_f32_16x16x32_bf16 v[196:199], v[108:111], v[68:71], v[196:199]
    ds_read_b128 v[92:95], v4 offset:3072
    v_mfma_f32_16x16x32_bf16 v[192:195], v[108:111], v[64:67], v[192:195]
    s_waitcnt vmcnt(25)
    v_mfma_f32_16x16x32_bf16 v[208:211], v[64:67], v[112:115], v[208:211]
    v_mfma_f32_16x16x32_bf16 v[212:215], v[68:71], v[112:115], v[212:215]
    v_mfma_f32_16x16x32_bf16 v[216:219], v[72:75], v[112:115], v[216:219]
    v_mfma_f32_16x16x32_bf16 v[220:223], v[76:79], v[112:115], v[220:223]
    v_mfma_f32_16x16x32_bf16 v[236:239], v[116:119], v[76:79], v[236:239]
    v_mfma_f32_16x16x32_bf16 v[232:235], v[116:119], v[72:75], v[232:235]
    v_mfma_f32_16x16x32_bf16 v[228:231], v[116:119], v[68:71], v[228:231]
    v_mfma_f32_16x16x32_bf16 v[224:227], v[116:119], v[64:67], v[224:227]
    s_waitcnt vmcnt(24) lgkmcnt(0)
    v_mfma_f32_16x16x32_bf16 v[240:243], v[116:119], v[80:83], v[240:243]
    ds_read_b128 v[64:67], v3 offset:14336
    v_mfma_f32_16x16x32_bf16 v[244:247], v[116:119], v[84:87], v[244:247]
    ds_read_b128 v[68:71], v3 offset:32768
    v_mfma_f32_16x16x32_bf16 v[248:251], v[116:119], v[88:91], v[248:251]
    ds_read_b128 v[72:75], v3 offset:51200
    v_mfma_f32_16x16x32_bf16 v[252:255], v[116:119], v[92:95], v[252:255]
    v_mfma_f32_16x16x32_bf16 v[188:191], v[120:123], v[92:95], v[188:191]
    ds_read_b128 v[76:79], v4 offset:4096
    v_mfma_f32_16x16x32_bf16 v[184:187], v[120:123], v[88:91], v[184:187]
    v_mfma_f32_16x16x32_bf16 v[180:183], v[120:123], v[84:87], v[180:183]
    v_mfma_f32_16x16x32_bf16 v[176:179], v[120:123], v[80:83], v[176:179]
    s_waitcnt vmcnt(22)
    v_mfma_f32_16x16x32_bf16 v[192:195], v[124:127], v[80:83], v[192:195]
    v_mfma_f32_16x16x32_bf16 v[196:199], v[124:127], v[84:87], v[196:199]
    v_mfma_f32_16x16x32_bf16 v[200:203], v[124:127], v[88:91], v[200:203]
    v_mfma_f32_16x16x32_bf16 v[204:207], v[124:127], v[92:95], v[204:207]
    v_mfma_f32_16x16x32_bf16 v[220:223], v[92:95], v[128:131], v[220:223]
    v_mfma_f32_16x16x32_bf16 v[216:219], v[88:91], v[128:131], v[216:219]
    v_mfma_f32_16x16x32_bf16 v[212:215], v[84:87], v[128:131], v[212:215]
    v_mfma_f32_16x16x32_bf16 v[208:211], v[80:83], v[128:131], v[208:211]
    s_waitcnt vmcnt(20) lgkmcnt(0)
    v_mfma_f32_16x16x32_bf16 v[176:179], v[132:135], v[64:67], v[176:179]
    ds_read_b128 v[80:83], v3 offset:15360
    v_mfma_f32_16x16x32_bf16 v[180:183], v[132:135], v[68:71], v[180:183]
    ds_read_b128 v[84:87], v3 offset:33792
    v_mfma_f32_16x16x32_bf16 v[184:187], v[132:135], v[72:75], v[184:187]
    ds_read_b128 v[88:91], v3 offset:52224
    v_mfma_f32_16x16x32_bf16 v[188:191], v[132:135], v[76:79], v[188:191]
    v_mfma_f32_16x16x32_bf16 v[204:207], v[136:139], v[76:79], v[204:207]
    ds_read_b128 v[92:95], v4 offset:5120
    v_mfma_f32_16x16x32_bf16 v[200:203], v[136:139], v[72:75], v[200:203]
    v_mfma_f32_16x16x32_bf16 v[196:199], v[136:139], v[68:71], v[196:199]
    v_mfma_f32_16x16x32_bf16 v[192:195], v[136:139], v[64:67], v[192:195]
    s_waitcnt vmcnt(18)
    v_mfma_f32_16x16x32_bf16 v[208:211], v[64:67], v[140:143], v[208:211]
    v_mfma_f32_16x16x32_bf16 v[212:215], v[68:71], v[140:143], v[212:215]
    v_mfma_f32_16x16x32_bf16 v[216:219], v[72:75], v[140:143], v[216:219]
    v_mfma_f32_16x16x32_bf16 v[220:223], v[76:79], v[140:143], v[220:223]
    v_mfma_f32_16x16x32_bf16 v[236:239], v[144:147], v[76:79], v[236:239]
    v_mfma_f32_16x16x32_bf16 v[232:235], v[144:147], v[72:75], v[232:235]
    v_mfma_f32_16x16x32_bf16 v[228:231], v[144:147], v[68:71], v[228:231]
    v_mfma_f32_16x16x32_bf16 v[224:227], v[144:147], v[64:67], v[224:227]
    s_waitcnt vmcnt(17) lgkmcnt(0)
    v_mfma_f32_16x16x32_bf16 v[240:243], v[144:147], v[80:83], v[240:243]
    ds_read_b128 v[64:67], v3 offset:16384
    v_mfma_f32_16x16x32_bf16 v[244:247], v[144:147], v[84:87], v[244:247]
    ds_read_b128 v[68:71], v3 offset:34816
    v_mfma_f32_16x16x32_bf16 v[248:251], v[144:147], v[88:91], v[248:251]
    ds_read_b128 v[72:75], v3 offset:53248
    v_mfma_f32_16x16x32_bf16 v[252:255], v[144:147], v[92:95], v[252:255]
    v_mfma_f32_16x16x32_bf16 v[188:191], v[148:151], v[92:95], v[188:191]
    ds_read_b128 v[76:79], v4 offset:6144
    v_mfma_f32_16x16x32_bf16 v[184:187], v[148:151], v[88:91], v[184:187]
    v_mfma_f32_16x16x32_bf16 v[180:183], v[148:151], v[84:87], v[180:183]
    v_mfma_f32_16x16x32_bf16 v[176:179], v[148:151], v[80:83], v[176:179]
    s_waitcnt vmcnt(15)
    v_mfma_f32_16x16x32_bf16 v[192:195], v[152:155], v[80:83], v[192:195]
    v_mfma_f32_16x16x32_bf16 v[196:199], v[152:155], v[84:87], v[196:199]
    v_mfma_f32_16x16x32_bf16 v[200:203], v[152:155], v[88:91], v[200:203]
    v_mfma_f32_16x16x32_bf16 v[204:207], v[152:155], v[92:95], v[204:207]
    v_mfma_f32_16x16x32_bf16 v[220:223], v[92:95], v[156:159], v[220:223]
    v_mfma_f32_16x16x32_bf16 v[216:219], v[88:91], v[156:159], v[216:219]
    v_mfma_f32_16x16x32_bf16 v[212:215], v[84:87], v[156:159], v[212:215]
    v_mfma_f32_16x16x32_bf16 v[208:211], v[80:83], v[156:159], v[208:211]
    s_waitcnt vmcnt(13) lgkmcnt(0)
    v_mfma_f32_16x16x32_bf16 v[176:179], v[160:163], v[64:67], v[176:179]
    ds_read_b128 v[80:83], v3 offset:17408
    v_mfma_f32_16x16x32_bf16 v[180:183], v[160:163], v[68:71], v[180:183]
    ds_read_b128 v[84:87], v3 offset:35840
    v_mfma_f32_16x16x32_bf16 v[184:187], v[160:163], v[72:75], v[184:187]
    ds_read_b128 v[88:91], v3 offset:54272
    v_mfma_f32_16x16x32_bf16 v[188:191], v[160:163], v[76:79], v[188:191]
    v_mfma_f32_16x16x32_bf16 v[204:207], v[164:167], v[76:79], v[204:207]
    ds_read_b128 v[92:95], v4 offset:7168
    v_mfma_f32_16x16x32_bf16 v[200:203], v[164:167], v[72:75], v[200:203]
    v_mfma_f32_16x16x32_bf16 v[196:199], v[164:167], v[68:71], v[196:199]
    v_mfma_f32_16x16x32_bf16 v[192:195], v[164:167], v[64:67], v[192:195]
    s_waitcnt vmcnt(11)
    v_mfma_f32_16x16x32_bf16 v[208:211], v[64:67], v[168:171], v[208:211]
    v_mfma_f32_16x16x32_bf16 v[212:215], v[68:71], v[168:171], v[212:215]
    v_mfma_f32_16x16x32_bf16 v[216:219], v[72:75], v[168:171], v[216:219]
    v_mfma_f32_16x16x32_bf16 v[220:223], v[76:79], v[168:171], v[220:223]
    v_mfma_f32_16x16x32_bf16 v[236:239], v[172:175], v[76:79], v[236:239]
    v_mfma_f32_16x16x32_bf16 v[232:235], v[172:175], v[72:75], v[232:235]
    v_mfma_f32_16x16x32_bf16 v[228:231], v[172:175], v[68:71], v[228:231]
    v_mfma_f32_16x16x32_bf16 v[224:227], v[172:175], v[64:67], v[224:227]
    s_waitcnt vmcnt(10) lgkmcnt(0)
    v_mfma_f32_16x16x32_bf16 v[240:243], v[172:175], v[80:83], v[240:243]
    v_mfma_f32_16x16x32_bf16 v[244:247], v[172:175], v[84:87], v[244:247]
    v_mfma_f32_16x16x32_bf16 v[248:251], v[172:175], v[88:91], v[248:251]
    v_mfma_f32_16x16x32_bf16 v[252:255], v[172:175], v[92:95], v[252:255]
    v_mfma_f32_16x16x32_bf16 v[188:191], v[96:99], v[92:95], v[188:191]
    v_mfma_f32_16x16x32_bf16 v[184:187], v[96:99], v[88:91], v[184:187]
    v_mfma_f32_16x16x32_bf16 v[180:183], v[96:99], v[84:87], v[180:183]
    v_mfma_f32_16x16x32_bf16 v[176:179], v[96:99], v[80:83], v[176:179]
    s_waitcnt vmcnt(0)
    v_mfma_f32_16x16x32_bf16 v[192:195], v[100:103], v[80:83], v[192:195]
    v_mfma_f32_16x16x32_bf16 v[196:199], v[100:103], v[84:87], v[196:199]
    v_mfma_f32_16x16x32_bf16 v[200:203], v[100:103], v[88:91], v[200:203]
    v_mfma_f32_16x16x32_bf16 v[204:207], v[100:103], v[92:95], v[204:207]
    v_mfma_f32_16x16x32_bf16 v[220:223], v[92:95], v[104:107], v[220:223]
    v_mfma_f32_16x16x32_bf16 v[216:219], v[88:91], v[104:107], v[216:219]
    v_mfma_f32_16x16x32_bf16 v[212:215], v[84:87], v[104:107], v[212:215]
    v_mfma_f32_16x16x32_bf16 v[208:211], v[80:83], v[104:107], v[208:211]
    s_mul_i32 s31, s23, 1504256
    s_add_u32 s31, s31, s90
    s_and_b32 s32, s91, 0xfffffff
    s_mov_b32 s33, 0x05040100
    s_mov_b32 s34, 0x07060302
    v_perm_b32 v16, v26, v24, s33
    v_perm_b32 v17, v30, v28, s33
    v_perm_b32 v18, v34, v32, s33
    v_perm_b32 v19, v38, v36, s33
    buffer_store_dwordx4 v[16:19], v3, s[4:7], s31 offen sc1
    s_add_u32 s31, s31, s32
    v_perm_b32 v20, v26, v24, s34
    v_perm_b32 v21, v30, v28, s34
    v_perm_b32 v22, v34, v32, s34
    v_perm_b32 v23, v38, v36, s34
    buffer_store_dwordx4 v[20:23], v3, s[4:7], s31 offen sc1
    s_add_u32 s31, s31, s32
    v_perm_b32 v16, v27, v25, s33
    v_perm_b32 v17, v31, v29, s33
    v_perm_b32 v18, v35, v33, s33
    v_perm_b32 v19, v39, v37, s33
    buffer_store_dwordx4 v[16:19], v3, s[4:7], s31 offen sc1
    s_add_u32 s31, s31, s32
    v_perm_b32 v20, v27, v25, s34
    v_perm_b32 v21, v31, v29, s34
    v_perm_b32 v22, v35, v33, s34
    v_perm_b32 v23, v39, v37, s34
    buffer_store_dwordx4 v[20:23], v3, s[4:7], s31 offen sc1
    s_cmp_ge_u32 s66, 67108864
    s_cbranch_scc1 L_opt_73
    s_mul_i32 s31, s23, 1504256
    s_add_u32 s31, s31, s66
    s_and_b32 s32, s67, 0xfffffff
    s_mov_b32 s33, 0x05040100
    s_mov_b32 s34, 0x07060302
    v_perm_b32 v16, v50, v48, s33
    v_perm_b32 v17, v54, v52, s33
    v_perm_b32 v18, v58, v56, s33
    v_perm_b32 v19, v62, v60, s33
    buffer_store_dwordx4 v[16:19], v3, s[4:7], s31 offen sc1
    s_add_u32 s31, s31, s32
    v_perm_b32 v20, v50, v48, s34
    v_perm_b32 v21, v54, v52, s34
    v_perm_b32 v22, v58, v56, s34
    v_perm_b32 v23, v62, v60, s34
    buffer_store_dwordx4 v[20:23], v3, s[4:7], s31 offen sc1
    s_add_u32 s31, s31, s32
    v_perm_b32 v16, v51, v49, s33
    v_perm_b32 v17, v55, v53, s33
    v_perm_b32 v18, v59, v57, s33
    v_perm_b32 v19, v63, v61, s33
    buffer_store_dwordx4 v[16:19], v3, s[4:7], s31 offen sc1
    s_add_u32 s31, s31, s32
    v_perm_b32 v20, v51, v49, s34
    v_perm_b32 v21, v55, v53, s34
    v_perm_b32 v22, v59, v57, s34
    v_perm_b32 v23, v63, v61, s34
    buffer_store_dwordx4 v[20:23], v3, s[4:7], s31 offen sc1
L_opt_73:
    s_setprio 0
    s_setprio 2
    v_cmp_gt_u32 vcc, 2, v2
    s_nop 1
    v_cndmask_b32 v224, v240, v224, vcc
    v_cndmask_b32 v225, v241, v225, vcc
    v_cndmask_b32 v226, v242, v226, vcc
    v_cndmask_b32 v228, v244, v228, vcc
    v_cndmask_b32 v229, v245, v229, vcc
    v_cndmask_b32 v230, v246, v230, vcc
    v_cndmask_b32 v232, v248, v232, vcc
    v_cndmask_b32 v233, v249, v233, vcc
    v_cndmask_b32 v234, v250, v234, vcc
    v_cndmask_b32 v236, v252, v236, vcc
    v_cndmask_b32 v237, v253, v237, vcc
    v_cndmask_b32 v238, v254, v238, vcc
    v_mov_b32 v240, v224
    v_mov_b32 v241, v225
    v_mov_b32 v242, v226
    v_mov_b32 v244, v228
    v_mov_b32 v245, v229
    v_mov_b32 v246, v230
    v_mov_b32 v248, v232
    v_mov_b32 v249, v233
    v_mov_b32 v250, v234
    v_mov_b32 v252, v236
    v_mov_b32 v253, v237
    v_mov_b32 v254, v238
    v_permlane32_swap_b32 v224, v240
    v_permlane32_swap_b32 v225, v241
    v_permlane32_swap_b32 v226, v242
    v_permlane32_swap_b32 v228, v244
    v_permlane32_swap_b32 v229, v245
    v_permlane32_swap_b32 v230, v246
    v_permlane32_swap_b32 v232, v248
    v_permlane32_swap_b32 v233, v249
    v_permlane32_swap_b32 v234, v250
    v_permlane32_swap_b32 v236, v252
    v_permlane32_swap_b32 v237, v253
    v_permlane32_swap_b32 v238, v254
    v_add_f32 v224, v224, v240
    v_add_f32 v225, v225, v241
    v_add_f32 v226, v226, v242
    v_add_f32 v228, v228, v244
    v_add_f32 v229, v229, v245
    v_add_f32 v230, v230, v246
    v_add_f32 v232, v232, v248
    v_add_f32 v233, v233, v249
    v_add_f32 v234, v234, v250
    v_add_f32 v236, v236, v252
    v_add_f32 v237, v237, v253
    v_add_f32 v238, v238, v254
    v_cmp_gt_u32 vcc, 2, v2
    s_nop 1
    v_cndmask_b32 v46, 0, 1.0, vcc
    v_mov_b32 v47, 0x3fb8aa3b
    v_max3_f32 v104, v176, v177, v178
    v_min3_f32 v108, v176, v177, v178
    v_max3_f32 v104, v104, v179, v224
    v_min3_f32 v108, v108, v179, v224
    v_max3_f32 v105, v180, v181, v182
    v_min3_f32 v109, v180, v181, v182
    v_max3_f32 v105, v105, v183, v228
    v_min3_f32 v109, v109, v183, v228
    v_max3_f32 v106, v184, v185, v186
    v_min3_f32 v110, v184, v185, v186
    v_max3_f32 v106, v106, v187, v232
    v_min3_f32 v110, v110, v187, v232
    v_max3_f32 v107, v188, v189, v190
    v_min3_f32 v111, v188, v189, v190
    v_max3_f32 v107, v107, v191, v236
    v_min3_f32 v111, v111, v191, v236
    v_permlane16_swap_b32 v104, v105
    v_permlane16_swap_b32 v106, v107
    v_permlane16_swap_b32 v108, v109
    v_permlane16_swap_b32 v110, v111
    v_max_f32 v104, v104, v105
    v_max_f32 v106, v106, v107
    v_min_f32 v108, v108, v109
    v_min_f32 v110, v110, v111
    v_permlane32_swap_b32 v104, v106
    s_nop 0
    v_permlane32_swap_b32 v108, v110
    v_max_f32 v104, v104, v106
    v_min_f32 v108, v108, v110
    v_mul_f32 v104, v47, v104
    v_mul_f32 v108, v47, v108
    v_mov_b32 v106, v104
    v_mov_b32 v110, v108
    s_nop 0
    v_permlane32_swap_b32 v104, v106
    v_permlane32_swap_b32 v108, v110
    v_mov_b32 v105, v104
    v_mov_b32 v107, v106
    v_mov_b32 v109, v108
    v_mov_b32 v111, v110
    v_permlane16_swap_b32 v104, v105
    v_permlane16_swap_b32 v106, v107
    v_permlane16_swap_b32 v108, v109
    v_permlane16_swap_b32 v110, v111
    v_fma_f32 v64, v176, v47, -v104
    v_fma_f32 v69, -v176, v47, v108
    v_fma_f32 v65, v177, v47, -v104
    v_fma_f32 v70, -v177, v47, v108
    v_fma_f32 v66, v178, v47, -v104
    v_fma_f32 v71, -v178, v47, v108
    v_fma_f32 v67, v179, v47, -v104
    v_fma_f32 v72, -v179, v47, v108
    v_fma_f32 v68, v224, v47, -v104
    v_fma_f32 v73, -v224, v47, v108
    v_exp_f32 v64, v64
    v_exp_f32 v65, v65
    v_exp_f32 v66, v66
    v_exp_f32 v67, v67
    v_exp_f32 v68, v68
    v_exp_f32 v69, v69
    v_exp_f32 v70, v70
    v_exp_f32 v71, v71
    v_exp_f32 v72, v72
    v_exp_f32 v73, v73
    v_add_f32 v104, v64, v65
    v_add_f32 v16, v66, v67
    v_fmac_f32 v104, v46, v68
    v_add_f32 v104, v104, v16
    v_add_f32 v108, v69, v70
    v_add_f32 v16, v71, v72
    v_fmac_f32 v108, v46, v73
    v_add_f32 v108, v108, v16
    v_fma_f32 v74, v180, v47, -v105
    v_fma_f32 v79, -v180, v47, v109
    v_fma_f32 v75, v181, v47, -v105
    v_fma_f32 v80, -v181, v47, v109
    v_fma_f32 v76, v182, v47, -v105
    v_fma_f32 v81, -v182, v47, v109
    v_fma_f32 v77, v183, v47, -v105
    v_fma_f32 v82, -v183, v47, v109
    v_fma_f32 v78, v228, v47, -v105
    v_fma_f32 v83, -v228, v47, v109
    v_exp_f32 v74, v74
    v_exp_f32 v75, v75
    v_exp_f32 v76, v76
    v_exp_f32 v77, v77
    v_exp_f32 v78, v78
    v_exp_f32 v79, v79
    v_exp_f32 v80, v80
    v_exp_f32 v81, v81
    v_exp_f32 v82, v82
    v_exp_f32 v83, v83
    v_add_f32 v105, v74, v75
    v_add_f32 v16, v76, v77
    v_fmac_f32 v105, v46, v78
    v_add_f32 v105, v105, v16
    v_add_f32 v109, v79, v80
    v_add_f32 v16, v81, v82
    v_fmac_f32 v109, v46, v83
    v_add_f32 v109, v109, v16
    v_fma_f32 v84, v184, v47, -v106
    v_fma_f32 v89, -v184, v47, v110
    v_fma_f32 v85, v185, v47, -v106
    v_fma_f32 v90, -v185, v47, v110
    v_fma_f32 v86, v186, v47, -v106
    v_fma_f32 v91, -v186, v47, v110
    v_fma_f32 v87, v187, v47, -v106
    v_fma_f32 v92, -v187, v47, v110
    v_fma_f32 v88, v232, v47, -v106
    v_fma_f32 v93, -v232, v47, v110
    v_exp_f32 v84, v84
    v_exp_f32 v85, v85
    v_exp_f32 v86, v86
    v_exp_f32 v87, v87
    v_exp_f32 v88, v88
    v_exp_f32 v89, v89
    v_exp_f32 v90, v90
    v_exp_f32 v91, v91
    v_exp_f32 v92, v92
    v_exp_f32 v93, v93
    v_add_f32 v106, v84, v85
    v_add_f32 v16, v86, v87
    v_fmac_f32 v106, v46, v88
    v_add_f32 v106, v106, v16
    v_add_f32 v110, v89, v90
    v_add_f32 v16, v91, v92
    v_fmac_f32 v110, v46, v93
    v_add_f32 v110, v110, v16
    v_fma_f32 v94, v188, v47, -v107
    v_fma_f32 v99, -v188, v47, v111
    v_fma_f32 v95, v189, v47, -v107
    v_fma_f32 v100, -v189, v47, v111
    v_fma_f32 v96, v190, v47, -v107
    v_fma_f32 v101, -v190, v47, v111
    v_fma_f32 v97, v191, v47, -v107
    v_fma_f32 v102, -v191, v47, v111
    v_fma_f32 v98, v236, v47, -v107
    v_fma_f32 v103, -v236, v47, v111
    v_exp_f32 v94, v94
    v_exp_f32 v95, v95
    v_exp_f32 v96, v96
    v_exp_f32 v97, v97
    v_exp_f32 v98, v98
    v_exp_f32 v99, v99
    v_exp_f32 v100, v100
    v_exp_f32 v101, v101
    v_exp_f32 v102, v102
    v_exp_f32 v103, v103
    v_add_f32 v107, v94, v95
    v_add_f32 v16, v96, v97
    v_fmac_f32 v107, v46, v98
    v_add_f32 v107, v107, v16
    v_add_f32 v111, v99, v100
    v_add_f32 v16, v101, v102
    v_fmac_f32 v111, v46, v103
    v_add_f32 v111, v111, v16
    s_mul_i32 s35, s23, 1024
    s_add_u32 s35, s35, 16392
    s_waitcnt vmcnt(0)
    s_mov_b64 exec, 1
    ds_add_rtn_u32 v14, v13, v12 offset:44
    s_mov_b64 exec, -1
    s_waitcnt lgkmcnt(0)
    v_readfirstlane_b32 s3, v14
    s_nop 0
    s_cmp_lg_u32 s3, 3
    s_cbranch_scc1 L_arr_74
    s_mov_b32 s1, 1
    s_atomic_add s1, s[44:45], s35
L_arr_74:
    v_permlane16_swap_b32 v104, v105
    v_permlane16_swap_b32 v106, v107
    v_permlane16_swap_b32 v108, v109
    v_permlane16_swap_b32 v110, v111
    v_add_f32 v104, v104, v105
    v_add_f32 v106, v106, v107
    v_add_f32 v108, v108, v109
    v_add_f32 v110, v110, v111
    v_permlane32_swap_b32 v104, v106
    s_nop 0
    v_permlane32_swap_b32 v108, v110
    v_add_f32 v104, v104, v106
    v_add_f32 v108, v108, v110
    v_rcp_f32 v104, v104
    v_rcp_f32 v108, v108
    v_mov_b32 v106, v104
    v_mov_b32 v110, v108
    s_nop 0
    v_permlane32_swap_b32 v104, v106
    v_permlane32_swap_b32 v108, v110
    v_mov_b32 v105, v104
    v_mov_b32 v107, v106
    v_mov_b32 v109, v108
    v_mov_b32 v111, v110
    v_permlane16_swap_b32 v104, v105
    v_permlane16_swap_b32 v106, v107
    v_permlane16_swap_b32 v108, v109
    v_permlane16_swap_b32 v110, v111
    v_mul_f32 v64, v104, v64
    v_mul_f32 v69, v108, v69
    v_mul_f32 v65, v104, v65
    v_mul_f32 v70, v108, v70
    v_mul_f32 v66, v104, v66
    v_mul_f32 v71, v108, v71
    v_mul_f32 v67, v104, v67
    v_mul_f32 v72, v108, v72
    v_mul_f32 v68, v104, v68
    v_mul_f32 v73, v108, v73
    v_mul_f32 v74, v105, v74
    v_mul_f32 v79, v109, v79
    v_mul_f32 v75, v105, v75
    v_mul_f32 v80, v109, v80
    v_mul_f32 v76, v105, v76
    v_mul_f32 v81, v109, v81
    v_mul_f32 v77, v105, v77
    v_mul_f32 v82, v109, v82
    v_mul_f32 v78, v105, v78
    v_mul_f32 v83, v109, v83
    v_mul_f32 v84, v106, v84
    v_mul_f32 v89, v110, v89
    v_mul_f32 v85, v106, v85
    v_mul_f32 v90, v110, v90
    v_mul_f32 v86, v106, v86
    v_mul_f32 v91, v110, v91
    v_mul_f32 v87, v106, v87
    v_mul_f32 v92, v110, v92
    v_mul_f32 v88, v106, v88
    v_mul_f32 v93, v110, v93
    v_mul_f32 v94, v107, v94
    v_mul_f32 v99, v111, v99
    v_mul_f32 v95, v107, v95
    v_mul_f32 v100, v111, v100
    v_mul_f32 v96, v107, v96
    v_mul_f32 v101, v111, v101
    v_mul_f32 v97, v107, v97
    v_mul_f32 v102, v111, v102
    v_mul_f32 v98, v107, v98
    v_mul_f32 v103, v111, v103
    s_mul_i32 s31, s21, 1280
    s_add_u32 s31, s31, 157696
    v_mul_u32_u24 v16, 80, v1
    v_add_u32 v16, s31, v16
    v_lshl_add_u32 v40, v2, 3, v16
    v_and_b32 v17, 1, v2
    v_lshl_add_u32 v41, v17, 3, v16
    v_lshrrev_b32 v16, 2, v0
    v_mul_u32_u24 v16, 80, v16
    v_add_u32 v16, s31, v16
    v_and_b32 v17, 3, v0
    v_lshl_add_u32 v42, v17, 3, v16
    v_and_b32 v17, 1, v0
    v_lshl_add_u32 v43, v17, 3, v16
    v_cvt_pk_bf16_f32 v16, v64, v65
    v_cvt_pk_bf16_f32 v17, v66, v67
    v_cvt_pk_bf16_f32 v18, v69, v70
    v_cvt_pk_bf16_f32 v19, v71, v72
    v_cvt_pk_bf16_f32 v20, v68, v73
    v_cvt_pk_bf16_f32 v21, v226, 1.0
    ds_write_b64 v40, v[16:17]
    ds_write_b64 v40, v[18:19] offset:32
    ds_write_b64 v41, v[20:21] offset:64
    ds_read_b64_tr_b16 v[136:137], v42
    ds_read_b64_tr_b16 v[138:139], v42 offset:32
    ds_read_b64_tr_b16 v[140:141], v43 offset:64
    v_cvt_pk_bf16_f32 v148, v208, v209
    v_cvt_pk_bf16_f32 v149, v210, v211
    v_cvt_pk_bf16_f32 v24, v74, v75
    v_cvt_pk_bf16_f32 v25, v76, v77
    v_cvt_pk_bf16_f32 v26, v79, v80
    v_cvt_pk_bf16_f32 v27, v81, v82
    v_cvt_pk_bf16_f32 v28, v78, v83
    v_cvt_pk_bf16_f32 v29, v230, 1.0
    ds_write_b64 v40, v[24:25]
    ds_write_b64 v40, v[26:27] offset:32
    ds_write_b64 v41, v[28:29] offset:64
    ds_read_b64_tr_b16 v[142:143], v42
    ds_read_b64_tr_b16 v[144:145], v42 offset:32
    ds_read_b64_tr_b16 v[146:147], v43 offset:64
    v_cvt_pk_bf16_f32 v150, v212, v213
    v_cvt_pk_bf16_f32 v151, v214, v215
    s_waitcnt lgkmcnt(6)
    v_mfma_f32_16x16x16_bf16 v[112:115], v[136:137], v[148:149], 0
    v_mfma_f32_16x16x16_bf16 v[124:127], v[136:137], v[140:141], 0
    v_mfma_f32_16x16x16_bf16 v[116:119], v[138:139], v[148:149], 0
    v_mfma_f32_16x16x16_bf16 v[128:131], v[138:139], v[140:141], 0
    v_mfma_f32_16x16x16_bf16 v[120:123], v[140:141], v[148:149], 0
    v_mfma_f32_16x16x16_bf16 v[132:135], v[140:141], v[140:141], 0
    v_cvt_pk_bf16_f32 v16, v84, v85
    v_cvt_pk_bf16_f32 v17, v86, v87
    v_cvt_pk_bf16_f32 v18, v89, v90
    v_cvt_pk_bf16_f32 v19, v91, v92
    v_cvt_pk_bf16_f32 v20, v88, v93
    v_cvt_pk_bf16_f32 v21, v234, 1.0
    ds_write_b64 v40, v[16:17]
    ds_write_b64 v40, v[18:19] offset:32
    ds_write_b64 v41, v[20:21] offset:64
    ds_read_b64_tr_b16 v[136:137], v42
    ds_read_b64_tr_b16 v[138:139], v42 offset:32
    ds_read_b64_tr_b16 v[140:141], v43 offset:64
    v_cvt_pk_bf16_f32 v148, v216, v217
    v_cvt_pk_bf16_f32 v149, v218, v219
    s_waitcnt lgkmcnt(6)
    v_mfma_f32_16x16x16_bf16 v[112:115], v[142:143], v[150:151], v[112:115]
    v_mfma_f32_16x16x16_bf16 v[124:127], v[142:143], v[146:147], v[124:127]
    v_mfma_f32_16x16x16_bf16 v[116:119], v[144:145], v[150:151], v[116:119]
    v_mfma_f32_16x16x16_bf16 v[128:131], v[144:145], v[146:147], v[128:131]
    v_mfma_f32_16x16x16_bf16 v[120:123], v[146:147], v[150:151], v[120:123]
    v_mfma_f32_16x16x16_bf16 v[132:135], v[146:147], v[146:147], v[132:135]
    v_cvt_pk_bf16_f32 v24, v94, v95
    v_cvt_pk_bf16_f32 v25, v96, v97
    v_cvt_pk_bf16_f32 v26, v99, v100
    v_cvt_pk_bf16_f32 v27, v101, v102
    v_cvt_pk_bf16_f32 v28, v98, v103
    v_cvt_pk_bf16_f32 v29, v238, 1.0
    ds_write_b64 v40, v[24:25]
    ds_write_b64 v40, v[26:27] offset:32
    ds_write_b64 v41, v[28:29] offset:64
    ds_read_b64_tr_b16 v[142:143], v42
    ds_read_b64_tr_b16 v[144:145], v42 offset:32
    ds_read_b64_tr_b16 v[146:147], v43 offset:64
    v_cvt_pk_bf16_f32 v150, v220, v221
    v_cvt_pk_bf16_f32 v151, v222, v223
    s_waitcnt lgkmcnt(6)
    v_mfma_f32_16x16x16_bf16 v[112:115], v[136:137], v[148:149], v[112:115]
    v_mfma_f32_16x16x16_bf16 v[124:127], v[136:137], v[140:141], v[124:127]
    v_mfma_f32_16x16x16_bf16 v[116:119], v[138:139], v[148:149], v[116:119]
    v_mfma_f32_16x16x16_bf16 v[128:131], v[138:139], v[140:141], v[128:131]
    v_mfma_f32_16x16x16_bf16 v[120:123], v[140:141], v[148:149], v[120:123]
    v_mfma_f32_16x16x16_bf16 v[132:135], v[140:141], v[140:141], v[132:135]
    s_waitcnt lgkmcnt(0)
    v_mfma_f32_16x16x16_bf16 v[112:115], v[142:143], v[150:151], v[112:115]
    v_mfma_f32_16x16x16_bf16 v[124:127], v[142:143], v[146:147], v[124:127]
    v_mfma_f32_16x16x16_bf16 v[116:119], v[144:145], v[150:151], v[116:119]
    v_mfma_f32_16x16x16_bf16 v[128:131], v[144:145], v[146:147], v[128:131]
    v_mfma_f32_16x16x16_bf16 v[120:123], v[146:147], v[150:151], v[120:123]
    v_mfma_f32_16x16x16_bf16 v[132:135], v[146:147], v[146:147], v[132:135]
    s_lshl_b32 s31, s27, 5
    s_add_u32 s31, s31, s22
    s_mul_i32 s31, s31, 2560
    s_add_u32 s31, s31, 41943040
    v_lshlrev_b32 v44, 3, v0
    v_cvt_pk_bf16_f32 v136, v112, v113
    v_cvt_pk_bf16_f32 v137, v114, v115
    v_cvt_pk_bf16_f32 v138, v116, v117
    v_cvt_pk_bf16_f32 v139, v118, v119
    v_cvt_pk_bf16_f32 v140, v124, v125
    v_cvt_pk_bf16_f32 v141, v126, v127
    v_cvt_pk_bf16_f32 v142, v128, v129
    v_cvt_pk_bf16_f32 v143, v130, v131
    v_cvt_pk_bf16_f32 v144, v120, v121
    v_cvt_pk_bf16_f32 v145, v132, v133
    buffer_store_dwordx4 v[136:139], v3, s[4:7], s31 offen offset:0 sc1
    buffer_store_dwordx4 v[140:143], v3, s[4:7], s31 offen offset:1024 sc1
    buffer_store_dwordx2 v[144:145], v44, s[4:7], s31 offen offset:2048 sc1
    v_max3_f32 v104, v192, v193, v194
    v_min3_f32 v108, v192, v193, v194
    v_max3_f32 v104, v104, v195, v225
    v_min3_f32 v108, v108, v195, v225
    v_max3_f32 v105, v196, v197, v198
    v_min3_f32 v109, v196, v197, v198
    v_max3_f32 v105, v105, v199, v229
    v_min3_f32 v109, v109, v199, v229
    v_max3_f32 v106, v200, v201, v202
    v_min3_f32 v110, v200, v201, v202
    v_max3_f32 v106, v106, v203, v233
    v_min3_f32 v110, v110, v203, v233
    v_max3_f32 v107, v204, v205, v206
    v_min3_f32 v111, v204, v205, v206
    v_max3_f32 v107, v107, v207, v237
    v_min3_f32 v111, v111, v207, v237
    v_permlane16_swap_b32 v104, v105
    v_permlane16_swap_b32 v106, v107
    v_permlane16_swap_b32 v108, v109
    v_permlane16_swap_b32 v110, v111
    v_max_f32 v104, v104, v105
    v_max_f32 v106, v106, v107
    v_min_f32 v108, v108, v109
    v_min_f32 v110, v110, v111
    v_permlane32_swap_b32 v104, v106
    s_nop 0
    v_permlane32_swap_b32 v108, v110
    v_max_f32 v104, v104, v106
    v_min_f32 v108, v108, v110
    v_mul_f32 v104, v47, v104
    v_mul_f32 v108, v47, v108
    v_mov_b32 v106, v104
    v_mov_b32 v110, v108
    s_nop 0
    v_permlane32_swap_b32 v104, v106
    v_permlane32_swap_b32 v108, v110
    v_mov_b32 v105, v104
    v_mov_b32 v107, v106
    v_mov_b32 v109, v108
    v_mov_b32 v111, v110
    v_permlane16_swap_b32 v104, v105
    v_permlane16_swap_b32 v106, v107
    v_permlane16_swap_b32 v108, v109
    v_permlane16_swap_b32 v110, v111
    v_fma_f32 v64, v192, v47, -v104
    v_fma_f32 v69, -v192, v47, v108
    v_fma_f32 v65, v193, v47, -v104
    v_fma_f32 v70, -v193, v47, v108
    v_fma_f32 v66, v194, v47, -v104
    v_fma_f32 v71, -v194, v47, v108
    v_fma_f32 v67, v195, v47, -v104
    v_fma_f32 v72, -v195, v47, v108
    v_fma_f32 v68, v225, v47, -v104
    v_fma_f32 v73, -v225, v47, v108
    v_exp_f32 v64, v64
    v_exp_f32 v65, v65
    v_exp_f32 v66, v66
    v_exp_f32 v67, v67
    v_exp_f32 v68, v68
    v_exp_f32 v69, v69
    v_exp_f32 v70, v70
    v_exp_f32 v71, v71
    v_exp_f32 v72, v72
    v_exp_f32 v73, v73
    v_add_f32 v104, v64, v65
    v_add_f32 v16, v66, v67
    v_fmac_f32 v104, v46, v68
    v_add_f32 v104, v104, v16
    v_add_f32 v108, v69, v70
    v_add_f32 v16, v71, v72
    v_fmac_f32 v108, v46, v73
    v_add_f32 v108, v108, v16
    v_fma_f32 v74, v196, v47, -v105
    v_fma_f32 v79, -v196, v47, v109
    v_fma_f32 v75, v197, v47, -v105
    v_fma_f32 v80, -v197, v47, v109
    v_fma_f32 v76, v198, v47, -v105
    v_fma_f32 v81, -v198, v47, v109
    v_fma_f32 v77, v199, v47, -v105
    v_fma_f32 v82, -v199, v47, v109
    v_fma_f32 v78, v229, v47, -v105
    v_fma_f32 v83, -v229, v47, v109
    v_exp_f32 v74, v74
    v_exp_f32 v75, v75
    v_exp_f32 v76, v76
    v_exp_f32 v77, v77
    v_exp_f32 v78, v78
    v_exp_f32 v79, v79
    v_exp_f32 v80, v80
    v_exp_f32 v81, v81
    v_exp_f32 v82, v82
    v_exp_f32 v83, v83
    v_add_f32 v105, v74, v75
    v_add_f32 v16, v76, v77
    v_fmac_f32 v105, v46, v78
    v_add_f32 v105, v105, v16
    v_add_f32 v109, v79, v80
    v_add_f32 v16, v81, v82
    v_fmac_f32 v109, v46, v83
    v_add_f32 v109, v109, v16
    v_fma_f32 v84, v200, v47, -v106
    v_fma_f32 v89, -v200, v47, v110
    v_fma_f32 v85, v201, v47, -v106
    v_fma_f32 v90, -v201, v47, v110
    v_fma_f32 v86, v202, v47, -v106
    v_fma_f32 v91, -v202, v47, v110
    v_fma_f32 v87, v203, v47, -v106
    v_fma_f32 v92, -v203, v47, v110
    v_fma_f32 v88, v233, v47, -v106
    v_fma_f32 v93, -v233, v47, v110
    v_exp_f32 v84, v84
    v_exp_f32 v85, v85
    v_exp_f32 v86, v86
    v_exp_f32 v87, v87
    v_exp_f32 v88, v88
    v_exp_f32 v89, v89
    v_exp_f32 v90, v90
    v_exp_f32 v91, v91
    v_exp_f32 v92, v92
    v_exp_f32 v93, v93
    v_add_f32 v106, v84, v85
    v_add_f32 v16, v86, v87
    v_fmac_f32 v106, v46, v88
    v_add_f32 v106, v106, v16
    v_add_f32 v110, v89, v90
    v_add_f32 v16, v91, v92
    v_fmac_f32 v110, v46, v93
    v_add_f32 v110, v110, v16
    v_fma_f32 v94, v204, v47, -v107
    v_fma_f32 v99, -v204, v47, v111
    v_fma_f32 v95, v205, v47, -v107
    v_fma_f32 v100, -v205, v47, v111
    v_fma_f32 v96, v206, v47, -v107
    v_fma_f32 v101, -v206, v47, v111
    v_fma_f32 v97, v207, v47, -v107
    v_fma_f32 v102, -v207, v47, v111
    v_fma_f32 v98, v237, v47, -v107
    v_fma_f32 v103, -v237, v47, v111
    v_exp_f32 v94, v94
    v_exp_f32 v95, v95
    v_exp_f32 v96, v96
    v_exp_f32 v97, v97
    v_exp_f32 v98, v98
    v_exp_f32 v99, v99
    v_exp_f32 v100, v100
    v_exp_f32 v101, v101
    v_exp_f32 v102, v102
    v_exp_f32 v103, v103
    v_add_f32 v107, v94, v95
    v_add_f32 v16, v96, v97
    v_fmac_f32 v107, v46, v98
    v_add_f32 v107, v107, v16
    v_add_f32 v111, v99, v100
    v_add_f32 v16, v101, v102
    v_fmac_f32 v111, v46, v103
    v_add_f32 v111, v111, v16
    s_mul_i32 s35, s27, 256
    s_add_u32 s35, s35, 24580
    s_waitcnt vmcnt(0)
    s_mov_b32 s1, 1
    s_atomic_add s1, s[44:45], s35
    v_permlane16_swap_b32 v104, v105
    v_permlane16_swap_b32 v106, v107
    v_permlane16_swap_b32 v108, v109
    v_permlane16_swap_b32 v110, v111
    v_add_f32 v104, v104, v105
    v_add_f32 v106, v106, v107
    v_add_f32 v108, v108, v109
    v_add_f32 v110, v110, v111
    v_permlane32_swap_b32 v104, v106
    s_nop 0
    v_permlane32_swap_b32 v108, v110
    v_add_f32 v104, v104, v106
    v_add_f32 v108, v108, v110
    v_rcp_f32 v104, v104
    v_rcp_f32 v108, v108
    v_mov_b32 v106, v104
    v_mov_b32 v110, v108
    s_nop 0
    v_permlane32_swap_b32 v104, v106
    v_permlane32_swap_b32 v108, v110
    v_mov_b32 v105, v104
    v_mov_b32 v107, v106
    v_mov_b32 v109, v108
    v_mov_b32 v111, v110
    v_permlane16_swap_b32 v104, v105
    v_permlane16_swap_b32 v106, v107
    v_permlane16_swap_b32 v108, v109
    v_permlane16_swap_b32 v110, v111
    v_mul_f32 v64, v104, v64
    v_mul_f32 v69, v108, v69
    v_mul_f32 v65, v104, v65
    v_mul_f32 v70, v108, v70
    v_mul_f32 v66, v104, v66
    v_mul_f32 v71, v108, v71
    v_mul_f32 v67, v104, v67
    v_mul_f32 v72, v108, v72
    v_mul_f32 v68, v104, v68
    v_mul_f32 v73, v108, v73
    v_mul_f32 v74, v105, v74
    v_mul_f32 v79, v109, v79
    v_mul_f32 v75, v105, v75
    v_mul_f32 v80, v109, v80
    v_mul_f32 v76, v105, v76
    v_mul_f32 v81, v109, v81
    v_mul_f32 v77, v105, v77
    v_mul_f32 v82, v109, v82
    v_mul_f32 v78, v105, v78
    v_mul_f32 v83, v109, v83
    v_mul_f32 v84, v106, v84
    v_mul_f32 v89, v110, v89
    v_mul_f32 v85, v106, v85
    v_mul_f32 v90, v110, v90
    v_mul_f32 v86, v106, v86
    v_mul_f32 v91, v110, v91
    v_mul_f32 v87, v106, v87
    v_mul_f32 v92, v110, v92
    v_mul_f32 v88, v106, v88
    v_mul_f32 v93, v110, v93
    v_mul_f32 v94, v107, v94
    v_mul_f32 v99, v111, v99
    v_mul_f32 v95, v107, v95
    v_mul_f32 v100, v111, v100
    v_mul_f32 v96, v107, v96
    v_mul_f32 v101, v111, v101
    v_mul_f32 v97, v107, v97
    v_mul_f32 v102, v111, v102
    v_mul_f32 v98, v107, v98
    v_mul_f32 v103, v111, v103
    v_mul_f32 v68, v46, v68
    v_mul_f32 v73, v46, v73
    v_cvt_pk_bf16_f32 v240, v64, v65
    v_cvt_pk_bf16_f32 v241, v66, v67
    v_cvt_pk_bf16_f32 v242, v69, v70
    v_cvt_pk_bf16_f32 v243, v71, v72
    v_cvt_pk_bf16_f32 v48, v68, v73
    v_mov_b32 v49, 0
    v_mul_f32 v78, v46, v78
    v_mul_f32 v83, v46, v83
    v_cvt_pk_bf16_f32 v244, v74, v75
    v_cvt_pk_bf16_f32 v245, v76, v77
    v_cvt_pk_bf16_f32 v246, v79, v80
    v_cvt_pk_bf16_f32 v247, v81, v82
    v_cvt_pk_bf16_f32 v50, v78, v83
    v_mov_b32 v51, 0
    v_mul_f32 v88, v46, v88
    v_mul_f32 v93, v46, v93
    v_cvt_pk_bf16_f32 v248, v84, v85
    v_cvt_pk_bf16_f32 v249, v86, v87
    v_cvt_pk_bf16_f32 v250, v89, v90
    v_cvt_pk_bf16_f32 v251, v91, v92
    v_cvt_pk_bf16_f32 v52, v88, v93
    v_mov_b32 v53, 0
    v_mul_f32 v98, v46, v98
    v_mul_f32 v103, v46, v103
    v_cvt_pk_bf16_f32 v252, v94, v95
    v_cvt_pk_bf16_f32 v253, v96, v97
    v_cvt_pk_bf16_f32 v254, v99, v100
    v_cvt_pk_bf16_f32 v255, v101, v102
    v_cvt_pk_bf16_f32 v54, v98, v103
    v_mov_b32 v55, 0
    s_cmp_lg_u32 s21, 0
    s_cbranch_scc1 L_now4
    s_mul_i32 s31, s23, 1024
    s_add_u32 s31, s31, 16392
    s_mov_b32 s26, 0
L_poll_75:
    s_mov_b32 s3, 0
    s_atomic_add s3, s[44:45], s31 glc
    s_waitcnt lgkmcnt(0)
    s_cmp_ge_u32 s3, 32
    s_cbranch_scc1 L_pdone_76
    s_sleep 4
    s_add_u32 s26, s26, 1
    s_cmp_lt_u32 s26, 40000
    s_cbranch_scc1 L_poll_75
L_pdone_76:
    s_mov_b64 exec, 1
    ds_add_u32 v13, v12 offset:40
    s_mov_b64 exec, -1
L_now4:
    s_mov_b32 s26, 0
L_lw_77:
    ds_read_b32 v14, v13 offset:8
    s_waitcnt lgkmcnt(0)
    v_readfirstlane_b32 s3, v14
    s_nop 0
    s_cmp_ge_u32 s3, 4
    s_cbranch_scc1 L_lwdone_78
    s_sleep 4
    s_add_u32 s26, s26, 1
    s_cmp_lt_u32 s26, 1000000
    s_cbranch_scc1 L_lw_77
L_lwdone_78:
    s_mul_i32 s24, s23, 1504256
    s_mul_i32 s31, s21, 137216
    s_add_u32 s24, s24, s31
    s_add_u32 s24, s24, 9785344
    buffer_load_dwordx4 v[96:99], v3, s[4:7], s24 offen offset:0 sc1
    buffer_load_dwordx4 v[100:103], v3, s[4:7], s24 offen offset:1024 sc1
    buffer_load_dwordx4 v[104:107], v3, s[4:7], s24 offen offset:2048 sc1
    buffer_load_dwordx4 v[108:111], v3, s[4:7], s24 offen offset:3072 sc1
    s_add_u32 s24, s24, 4096
    buffer_load_dwordx4 v[112:115], v3, s[4:7], s24 offen offset:0 sc1
    buffer_load_dwordx4 v[116:119], v3, s[4:7], s24 offen offset:1024 sc1
    buffer_load_dwordx4 v[120:123], v3, s[4:7], s24 offen offset:2048 sc1
    buffer_load_dwordx4 v[124:127], v3, s[4:7], s24 offen offset:3072 sc1
    s_add_u32 s24, s24, 4096
    buffer_load_dwordx4 v[128:131], v3, s[4:7], s24 offen offset:0 sc1
    buffer_load_dwordx4 v[132:135], v3, s[4:7], s24 offen offset:1024 sc1
    buffer_load_dwordx4 v[136:139], v3, s[4:7], s24 offen offset:2048 sc1
    buffer_load_dwordx4 v[140:143], v3, s[4:7], s24 offen offset:3072 sc1
    s_add_u32 s24, s24, 4096
    buffer_load_dwordx4 v[144:147], v3, s[4:7], s24 offen offset:0 sc1
    buffer_load_dwordx4 v[148:151], v3, s[4:7], s24 offen offset:1024 sc1
    buffer_load_dwordx4 v[152:155], v3, s[4:7], s24 offen offset:2048 sc1
    buffer_load_dwordx4 v[156:159], v3, s[4:7], s24 offen offset:3072 sc1
    s_setprio 0
    v_lshl_add_u32 v16, v1, 2, v13
    ds_read_b32 v160, v16 offset:256
    ds_read_b32 v161, v16 offset:320
    ds_read_b32 v162, v16 offset:384
    ds_read_b32 v163, v16 offset:448
    ds_read_b32 v164, v16 offset:512
    ds_read_b32 v165, v16 offset:576
    ds_read_b32 v166, v16 offset:640
    ds_read_b32 v167, v16 offset:704
    ds_read_b32 v168, v16 offset:768
    ds_read_b32 v169, v16 offset:832
    ds_read_b32 v170, v16 offset:896
    ds_read_b32 v171, v16 offset:960
    s_waitcnt lgkmcnt(0)
    ds_read_b128 v[64:67], v4 offset:8192
    ds_read_b128 v[68:71], v4 offset:26624
    ds_read_b128 v[72:75], v4 offset:45056
    ds_read_b128 v[76:79], v4 offset:63488
    s_barrier
    s_setprio 1
    s_waitcnt vmcnt(14) lgkmcnt(0)
    v_mfma_f32_16x16x32_bf16 v[176:179], v[96:99], v[64:67], 0
    ds_read_b128 v[80:83], v4 offset:9216
    v_mfma_f32_16x16x32_bf16 v[180:183], v[96:99], v[68:71], 0
    ds_read_b128 v[84:87], v4 offset:27648
    v_mfma_f32_16x16x32_bf16 v[184:187], v[96:99], v[72:75], 0
    s_add_u32 s24, s24, 4096
    v_mfma_f32_16x16x32_bf16 v[188:191], v[96:99], v[76:79], 0
    v_mfma_f32_16x16x32_bf16 v[204:207], v[100:103], v[76:79], 0
    buffer_load_dwordx4 v[96:99], v3, s[4:7], s24 offen offset:0 sc1
    v_mfma_f32_16x16x32_bf16 v[200:203], v[100:103], v[72:75], 0
    ds_read_b128 v[88:91], v4 offset:46080
    v_mfma_f32_16x16x32_bf16 v[196:199], v[100:103], v[68:71], 0
    ds_read_b128 v[92:95], v4 offset:64512
    v_mfma_f32_16x16x32_bf16 v[192:195], v[100:103], v[64:67], 0
    s_waitcnt vmcnt(13)
    v_mfma_f32_16x16x32_bf16 v[208:211], v[104:107], v[64:67], 0
    buffer_load_dwordx4 v[100:103], v3, s[4:7], s24 offen offset:1024 sc1
    v_mfma_f32_16x16x32_bf16 v[212:215], v[104:107], v[68:71], 0
    v_mfma_f32_16x16x32_bf16 v[216:219], v[104:107], v[72:75], 0
    v_mfma_f32_16x16x32_bf16 v[220:223], v[104:107], v[76:79], 0
    v_mfma_f32_16x16x32_bf16 v[236:239], v[108:111], v[76:79], 0
    buffer_load_dwordx4 v[104:107], v3, s[4:7], s24 offen offset:2048 sc1
    v_mfma_f32_16x16x32_bf16 v[232:235], v[108:111], v[72:75], 0
    v_mfma_f32_16x16x32_bf16 v[228:231], v[108:111], v[68:71], 0
    v_mfma_f32_16x16x32_bf16 v[224:227], v[108:111], v[64:67], 0
    s_waitcnt vmcnt(13) lgkmcnt(0)
    v_mfma_f32_16x16x32_bf16 v[176:179], v[112:115], v[80:83], v[176:179]
    buffer_load_dwordx4 v[108:111], v3, s[4:7], s24 offen offset:3072 sc1
    v_mfma_f32_16x16x32_bf16 v[180:183], v[112:115], v[84:87], v[180:183]
    ds_read_b128 v[64:67], v4 offset:10240
    v_mfma_f32_16x16x32_bf16 v[184:187], v[112:115], v[88:91], v[184:187]
    s_add_u32 s24, s24, 4096
    v_mfma_f32_16x16x32_bf16 v[188:191], v[112:115], v[92:95], v[188:191]
    v_mfma_f32_16x16x32_bf16 v[204:207], v[116:119], v[92:95], v[204:207]
    buffer_load_dwordx4 v[112:115], v3, s[4:7], s24 offen offset:0 sc1
    v_mfma_f32_16x16x32_bf16 v[200:203], v[116:119], v[88:91], v[200:203]
    ds_read_b128 v[68:71], v4 offset:28672
    v_mfma_f32_16x16x32_bf16 v[196:199], v[116:119], v[84:87], v[196:199]
    ds_read_b128 v[72:75], v4 offset:47104
    v_mfma_f32_16x16x32_bf16 v[192:195], v[116:119], v[80:83], v[192:195]
    s_waitcnt vmcnt(13)
    v_mfma_f32_16x16x32_bf16 v[208:211], v[120:123], v[80:83], v[208:211]
    buffer_load_dwordx4 v[116:119], v3, s[4:7], s24 offen offset:1024 sc1
    v_mfma_f32_16x16x32_bf16 v[212:215], v[120:123], v[84:87], v[212:215]
    ds_read_b128 v[76:79], v5 offset:0
    v_mfma_f32_16x16x32_bf16 v[216:219], v[120:123], v[88:91], v[216:219]
    v_mfma_f32_16x16x32_bf16 v[220:223], v[120:123], v[92:95], v[220:223]
    v_mfma_f32_16x16x32_bf16 v[236:239], v[124:127], v[92:95], v[236:239]
    buffer_load_dwordx4 v[120:123], v3, s[4:7], s24 offen offset:2048 sc1
    v_mfma_f32_16x16x32_bf16 v[232:235], v[124:127], v[88:91], v[232:235]
    v_mfma_f32_16x16x32_bf16 v[228:231], v[124:127], v[84:87], v[228:231]
    v_mfma_f32_16x16x32_bf16 v[224:227], v[124:127], v[80:83], v[224:227]
    s_waitcnt vmcnt(13) lgkmcnt(0)
    v_mfma_f32_16x16x32_bf16 v[176:179], v[128:131], v[64:67], v[176:179]
    buffer_load_dwordx4 v[124:127], v3, s[4:7], s24 offen offset:3072 sc1
    v_mfma_f32_16x16x32_bf16 v[180:183], v[128:131], v[68:71], v[180:183]
    ds_read_b128 v[80:83], v4 offset:11264
    v_mfma_f32_16x16x32_bf16 v[184:187], v[128:131], v[72:75], v[184:187]
    s_add_u32 s24, s24, 4096
    v_mfma_f32_16x16x32_bf16 v[188:191], v[128:131], v[76:79], v[188:191]
    v_mfma_f32_16x16x32_bf16 v[204:207], v[132:135], v[76:79], v[204:207]
    buffer_load_dwordx4 v[128:131], v3, s[4:7], s24 offen offset:0 sc1
    v_mfma_f32_16x16x32_bf16 v[200:203], v[132:135], v[72:75], v[200:203]
    ds_read_b128 v[84:87], v4 offset:29696
    v_mfma_f32_16x16x32_bf16 v[196:199], v[132:135], v[68:71], v[196:199]
    ds_read_b128 v[88:91], v4 offset:48128
    v_mfma_f32_16x16x32_bf16 v[192:195], v[132:135], v[64:67], v[192:195]
    s_waitcnt vmcnt(13)
    v_mfma_f32_16x16x32_bf16 v[208:211], v[136:139], v[64:67], v[208:211]
    buffer_load_dwordx4 v[132:135], v3, s[4:7], s24 offen offset:1024 sc1
    v_mfma_f32_16x16x32_bf16 v[212:215], v[136:139], v[68:71], v[212:215]
    ds_read_b128 v[92:95], v5 offset:1024
    v_mfma_f32_16x16x32_bf16 v[216:219], v[136:139], v[72:75], v[216:219]
    v_mfma_f32_16x16x32_bf16 v[220:223], v[136:139], v[76:79], v[220:223]
    v_mfma_f32_16x16x32_bf16 v[236:239], v[140:143], v[76:79], v[236:239]
    buffer_load_dwordx4 v[136:139], v3, s[4:7], s24 offen offset:2048 sc1
    v_mfma_f32_16x16x32_bf16 v[232:235], v[140:143], v[72:75], v[232:235]
    v_mfma_f32_16x16x32_bf16 v[228:231], v[140:143], v[68:71], v[228:231]
    v_mfma_f32_16x16x32_bf16 v[224:227], v[140:143], v[64:67], v[224:227]
    s_waitcnt vmcnt(13) lgkmcnt(0)
    v_mfma_f32_16x16x32_bf16 v[176:179], v[144:147], v[80:83], v[176:179]
    buffer_load_dwordx4 v[140:143], v3, s[4:7], s24 offen offset:3072 sc1
    v_mfma_f32_16x16x32_bf16 v[180:183], v[144:147], v[84:87], v[180:183]
    ds_read_b128 v[64:67], v4 offset:12288
    v_mfma_f32_16x16x32_bf16 v[184:187], v[144:147], v[88:91], v[184:187]
    s_add_u32 s24, s24, 4096
    v_mfma_f32_16x16x32_bf16 v[188:191], v[144:147], v[92:95], v[188:191]
    v_mfma_f32_16x16x32_bf16 v[204:207], v[148:151], v[92:95], v[204:207]
    buffer_load_dwordx4 v[144:147], v3, s[4:7], s24 offen offset:0 sc1
    v_mfma_f32_16x16x32_bf16 v[200:203], v[148:151], v[88:91], v[200:203]
    ds_read_b128 v[68:71], v4 offset:30720
    v_mfma_f32_16x16x32_bf16 v[196:199], v[148:151], v[84:87], v[196:199]
    ds_read_b128 v[72:75], v4 offset:49152
    v_mfma_f32_16x16x32_bf16 v[192:195], v[148:151], v[80:83], v[192:195]
    s_waitcnt vmcnt(13)
    v_mfma_f32_16x16x32_bf16 v[208:211], v[152:155], v[80:83], v[208:211]
    buffer_load_dwordx4 v[148:151], v3, s[4:7], s24 offen offset:1024 sc1
    v_mfma_f32_16x16x32_bf16 v[212:215], v[152:155], v[84:87], v[212:215]
    ds_read_b128 v[76:79], v5 offset:2048
    v_mfma_f32_16x16x32_bf16 v[216:219], v[152:155], v[88:91], v[216:219]
    v_mfma_f32_16x16x32_bf16 v[220:223], v[152:155], v[92:95], v[220:223]
    v_mfma_f32_16x16x32_bf16 v[236:239], v[156:159], v[92:95], v[236:239]
    buffer_load_dwordx4 v[152:155], v3, s[4:7], s24 offen offset:2048 sc1
    v_mfma_f32_16x16x32_bf16 v[232:235], v[156:159], v[88:91], v[232:235]
    v_mfma_f32_16x16x32_bf16 v[228:231], v[156:159], v[84:87], v[228:231]
    v_mfma_f32_16x16x32_bf16 v[224:227], v[156:159], v[80:83], v[224:227]
    s_waitcnt vmcnt(13) lgkmcnt(0)
    v_mfma_f32_16x16x32_bf16 v[176:179], v[96:99], v[64:67], v[176:179]
    buffer_load_dwordx4 v[156:159], v3, s[4:7], s24 offen offset:3072 sc1
    v_mfma_f32_16x16x32_bf16 v[180:183], v[96:99], v[68:71], v[180:183]
    ds_read_b128 v[80:83], v4 offset:13312
    v_mfma_f32_16x16x32_bf16 v[184:187], v[96:99], v[72:75], v[184:187]
    s_add_u32 s24, s24, 4096
    v_mfma_f32_16x16x32_bf16 v[188:191], v[96:99], v[76:79], v[188:191]
    v_mfma_f32_16x16x32_bf16 v[204:207], v[100:103], v[76:79], v[204:207]
    buffer_load_dwordx4 v[96:99], v3, s[4:7], s24 offen offset:0 sc1
    v_mfma_f32_16x16x32_bf16 v[200:203], v[100:103], v[72:75], v[200:203]
    ds_read_b128 v[84:87], v4 offset:31744
    v_mfma_f32_16x16x32_bf16 v[196:199], v[100:103], v[68:71], v[196:199]
    ds_read_b128 v[88:91], v4 offset:50176
    v_mfma_f32_16x16x32_bf16 v[192:195], v[100:103], v[64:67], v[192:195]
    s_waitcnt vmcnt(13)
    v_mfma_f32_16x16x32_bf16 v[208:211], v[104:107], v[64:67], v[208:211]
    buffer_load_dwordx4 v[100:103], v3, s[4:7], s24 offen offset:1024 sc1
    v_mfma_f32_16x16x32_bf16 v[212:215], v[104:107], v[68:71], v[212:215]
    ds_read_b128 v[92:95], v5 offset:3072
    v_mfma_f32_16x16x32_bf16 v[216:219], v[104:107], v[72:75], v[216:219]
    v_mfma_f32_16x16x32_bf16 v[220:223], v[104:107], v[76:79], v[220:223]
    v_mfma_f32_16x16x32_bf16 v[236:239], v[108:111], v[76:79], v[236:239]
    buffer_load_dwordx4 v[104:107], v3, s[4:7], s24 offen offset:2048 sc1
    v_mfma_f32_16x16x32_bf16 v[232:235], v[108:111], v[72:75], v[232:235]
    v_mfma_f32_16x16x32_bf16 v[228:231], v[108:111], v[68:71], v[228:231]
    v_mfma_f32_16x16x32_bf16 v[224:227], v[108:111], v[64:67], v[224:227]
    s_waitcnt vmcnt(13) lgkmcnt(0)
    v_mfma_f32_16x16x32_bf16 v[176:179], v[112:115], v[80:83], v[176:179]
    buffer_load_dwordx4 v[108:111], v3, s[4:7], s24 offen offset:3072 sc1
    v_mfma_f32_16x16x32_bf16 v[180:183], v[112:115], v[84:87], v[180:183]
    ds_read_b128 v[64:67], v4 offset:14336
    v_mfma_f32_16x16x32_bf16 v[184:187], v[112:115], v[88:91], v[184:187]
    s_add_u32 s24, s24, 4096
    v_mfma_f32_16x16x32_bf16 v[188:191], v[112:115], v[92:95], v[188:191]
    v_mfma_f32_16x16x32_bf16 v[204:207], v[116:119], v[92:95], v[204:207]
    buffer_load_dwordx4 v[112:115], v3, s[4:7], s24 offen offset:0 sc1
    v_mfma_f32_16x16x32_bf16 v[200:203], v[116:119], v[88:91], v[200:203]
    ds_read_b128 v[68:71], v4 offset:32768
    v_mfma_f32_16x16x32_bf16 v[196:199], v[116:119], v[84:87], v[196:199]
    ds_read_b128 v[72:75], v4 offset:51200
    v_mfma_f32_16x16x32_bf16 v[192:195], v[116:119], v[80:83], v[192:195]
    s_waitcnt vmcnt(13)
    v_mfma_f32_16x16x32_bf16 v[208:211], v[120:123], v[80:83], v[208:211]
    buffer_load_dwordx4 v[116:119], v3, s[4:7], s24 offen offset:1024 sc1
    v_mfma_f32_16x16x32_bf16 v[212:215], v[120:123], v[84:87], v[212:215]
    ds_read_b128 v[76:79], v5 offset:4096
    v_mfma_f32_16x16x32_bf16 v[216:219], v[120:123], v[88:91], v[216:219]
    v_mfma_f32_16x16x32_bf16 v[220:223], v[120:123], v[92:95], v[220:223]
    v_mfma_f32_16x16x32_bf16 v[236:239], v[124:127], v[92:95], v[236:239]
    buffer_load_dwordx4 v[120:123], v3, s[4:7], s24 offen offset:2048 sc1
    v_mfma_f32_16x16x32_bf16 v[232:235], v[124:127], v[88:91], v[232:235]
    v_mfma_f32_16x16x32_bf16 v[228:231], v[124:127], v[84:87], v[228:231]
    v_mfma_f32_16x16x32_bf16 v[224:227], v[124:127], v[80:83], v[224:227]
    s_waitcnt vmcnt(13) lgkmcnt(0)
    v_mfma_f32_16x16x32_bf16 v[176:179], v[128:131], v[64:67], v[176:179]
    buffer_load_dwordx4 v[124:127], v3, s[4:7], s24 offen offset:3072 sc1
    v_mfma_f32_16x16x32_bf16 v[180:183], v[128:131], v[68:71], v[180:183]
    ds_read_b128 v[80:83], v4 offset:15360
    v_mfma_f32_16x16x32_bf16 v[184:187], v[128:131], v[72:75], v[184:187]
    s_add_u32 s24, s24, 4096
    v_mfma_f32_16x16x32_bf16 v[188:191], v[128:131], v[76:79], v[188:191]
    v_mfma_f32_16x16x32_bf16 v[204:207], v[132:135], v[76:79], v[204:207]
    buffer_load_dwordx4 v[128:131], v3, s[4:7], s24 offen offset:0 sc1
    v_mfma_f32_16x16x32_bf16 v[200:203], v[132:135], v[72:75], v[200:203]
    ds_read_b128 v[84:87], v4 offset:33792
    v_mfma_f32_16x16x32_bf16 v[196:199], v[132:135], v[68:71], v[196:199]
    ds_read_b128 v[88:91], v4 offset:52224
    v_mfma_f32_16x16x32_bf16 v[192:195], v[132:135], v[64:67], v[192:195]
    s_waitcnt vmcnt(13)
    v_mfma_f32_16x16x32_bf16 v[208:211], v[136:139], v[64:67], v[208:211]
    buffer_load_dwordx4 v[132:135], v3, s[4:7], s24 offen offset:1024 sc1
    v_mfma_f32_16x16x32_bf16 v[212:215], v[136:139], v[68:71], v[212:215]
    ds_read_b128 v[92:95], v5 offset:5120
    v_mfma_f32_16x16x32_bf16 v[216:219], v[136:139], v[72:75], v[216:219]
    v_mfma_f32_16x16x32_bf16 v[220:223], v[136:139], v[76:79], v[220:223]
    v_mfma_f32_16x16x32_bf16 v[236:239], v[140:143], v[76:79], v[236:239]
    buffer_load_dwordx4 v[136:139], v3, s[4:7], s24 offen offset:2048 sc1
    v_mfma_f32_16x16x32_bf16 v[232:235], v[140:143], v[72:75], v[232:235]
    v_mfma_f32_16x16x32_bf16 v[228:231], v[140:143], v[68:71], v[228:231]
    v_mfma_f32_16x16x32_bf16 v[224:227], v[140:143], v[64:67], v[224:227]
    s_waitcnt vmcnt(13) lgkmcnt(0)
    v_mfma_f32_16x16x32_bf16 v[176:179], v[144:147], v[80:83], v[176:179]
    buffer_load_dwordx4 v[140:143], v3, s[4:7], s24 offen offset:3072 sc1
    v_mfma_f32_16x16x32_bf16 v[180:183], v[144:147], v[84:87], v[180:183]
    ds_read_b128 v[64:67], v4 offset:16384
    v_mfma_f32_16x16x32_bf16 v[184:187], v[144:147], v[88:91], v[184:187]
    s_add_u32 s24, s24, 4096
    v_mfma_f32_16x16x32_bf16 v[188:191], v[144:147], v[92:95], v[188:191]
    v_mfma_f32_16x16x32_bf16 v[204:207], v[148:151], v[92:95], v[204:207]
    buffer_load_dwordx4 v[144:147], v3, s[4:7], s24 offen offset:0 sc1
    v_mfma_f32_16x16x32_bf16 v[200:203], v[148:151], v[88:91], v[200:203]
    ds_read_b128 v[68:71], v4 offset:34816
    v_mfma_f32_16x16x32_bf16 v[196:199], v[148:151], v[84:87], v[196:199]
    ds_read_b128 v[72:75], v4 offset:53248
    v_mfma_f32_16x16x32_bf16 v[192:195], v[148:151], v[80:83], v[192:195]
    s_waitcnt vmcnt(13)
    v_mfma_f32_16x16x32_bf16 v[208:211], v[152:155], v[80:83], v[208:211]
    buffer_load_dwordx4 v[148:151], v3, s[4:7], s24 offen offset:1024 sc1
    v_mfma_f32_16x16x32_bf16 v[212:215], v[152:155], v[84:87], v[212:215]
    ds_read_b128 v[76:79], v5 offset:6144
    v_mfma_f32_16x16x32_bf16 v[216:219], v[152:155], v[88:91], v[216:219]
    v_mfma_f32_16x16x32_bf16 v[220:223], v[152:155], v[92:95], v[220:223]
    v_mfma_f32_16x16x32_bf16 v[236:239], v[156:159], v[92:95], v[236:239]
    buffer_load_dwordx4 v[152:155], v3, s[4:7], s24 offen offset:2048 sc1
    v_mfma_f32_16x16x32_bf16 v[232:235], v[156:159], v[88:91], v[232:235]
    v_mfma_f32_16x16x32_bf16 v[228:231], v[156:159], v[84:87], v[228:231]
    v_mfma_f32_16x16x32_bf16 v[224:227], v[156:159], v[80:83], v[224:227]
    s_waitcnt vmcnt(13) lgkmcnt(0)
    v_mfma_f32_16x16x32_bf16 v[176:179], v[96:99], v[64:67], v[176:179]
    buffer_load_dwordx4 v[156:159], v3, s[4:7], s24 offen offset:3072 sc1
    v_mfma_f32_16x16x32_bf16 v[180:183], v[96:99], v[68:71], v[180:183]
    ds_read_b128 v[80:83], v4 offset:17408
    v_mfma_f32_16x16x32_bf16 v[184:187], v[96:99], v[72:75], v[184:187]
    s_add_u32 s24, s24, 4096
    v_mfma_f32_16x16x32_bf16 v[188:191], v[96:99], v[76:79], v[188:191]
    v_mfma_f32_16x16x32_bf16 v[204:207], v[100:103], v[76:79], v[204:207]
    buffer_load_dwordx4 v[96:99], v3, s[4:7], s24 offen offset:0 sc1
    v_mfma_f32_16x16x32_bf16 v[200:203], v[100:103], v[72:75], v[200:203]
    ds_read_b128 v[84:87], v4 offset:35840
    v_mfma_f32_16x16x32_bf16 v[196:199], v[100:103], v[68:71], v[196:199]
    ds_read_b128 v[88:91], v4 offset:54272
    v_mfma_f32_16x16x32_bf16 v[192:195], v[100:103], v[64:67], v[192:195]
    s_waitcnt vmcnt(13)
    v_mfma_f32_16x16x32_bf16 v[208:211], v[104:107], v[64:67], v[208:211]
    buffer_load_dwordx4 v[100:103], v3, s[4:7], s24 offen offset:1024 sc1
    v_mfma_f32_16x16x32_bf16 v[212:215], v[104:107], v[68:71], v[212:215]
    ds_read_b128 v[92:95], v5 offset:7168
    v_mfma_f32_16x16x32_bf16 v[216:219], v[104:107], v[72:75], v[216:219]
    v_mfma_f32_16x16x32_bf16 v[220:223], v[104:107], v[76:79], v[220:223]
    v_mfma_f32_16x16x32_bf16 v[236:239], v[108:111], v[76:79], v[236:239]
    buffer_load_dwordx4 v[104:107], v3, s[4:7], s24 offen offset:2048 sc1
    v_mfma_f32_16x16x32_bf16 v[232:235], v[108:111], v[72:75], v[232:235]
    v_mfma_f32_16x16x32_bf16 v[228:231], v[108:111], v[68:71], v[228:231]
    v_mfma_f32_16x16x32_bf16 v[224:227], v[108:111], v[64:67], v[224:227]
    s_waitcnt vmcnt(13) lgkmcnt(0)
    v_mfma_f32_16x16x32_bf16 v[176:179], v[112:115], v[80:83], v[176:179]
    buffer_load_dwordx4 v[108:111], v3, s[4:7], s24 offen offset:3072 sc1
    v_mfma_f32_16x16x32_bf16 v[180:183], v[112:115], v[84:87], v[180:183]
    ds_read_b128 v[64:67], v4 offset:18432
    v_mfma_f32_16x16x32_bf16 v[184:187], v[112:115], v[88:91], v[184:187]
    s_add_u32 s24, s24, 4096
    v_mfma_f32_16x16x32_bf16 v[188:191], v[112:115], v[92:95], v[188:191]
    v_mfma_f32_16x16x32_bf16 v[204:207], v[116:119], v[92:95], v[204:207]
    buffer_load_dwordx4 v[112:115], v3, s[4:7], s24 offen offset:0 sc1
    v_mfma_f32_16x16x32_bf16 v[200:203], v[116:119], v[88:91], v[200:203]
    ds_read_b128 v[68:71], v4 offset:36864
    v_mfma_f32_16x16x32_bf16 v[196:199], v[116:119], v[84:87], v[196:199]
    ds_read_b128 v[72:75], v4 offset:55296
    v_mfma_f32_16x16x32_bf16 v[192:195], v[116:119], v[80:83], v[192:195]
    s_waitcnt vmcnt(13)
    v_mfma_f32_16x16x32_bf16 v[208:211], v[120:123], v[80:83], v[208:211]
    buffer_load_dwordx4 v[116:119], v3, s[4:7], s24 offen offset:1024 sc1
    v_mfma_f32_16x16x32_bf16 v[212:215], v[120:123], v[84:87], v[212:215]
    ds_read_b128 v[76:79], v5 offset:8192
    v_mfma_f32_16x16x32_bf16 v[216:219], v[120:123], v[88:91], v[216:219]
    v_mfma_f32_16x16x32_bf16 v[220:223], v[120:123], v[92:95], v[220:223]
    v_mfma_f32_16x16x32_bf16 v[236:239], v[124:127], v[92:95], v[236:239]
    buffer_load_dwordx4 v[120:123], v3, s[4:7], s24 offen offset:2048 sc1
    v_mfma_f32_16x16x32_bf16 v[232:235], v[124:127], v[88:91], v[232:235]
    v_mfma_f32_16x16x32_bf16 v[228:231], v[124:127], v[84:87], v[228:231]
    v_mfma_f32_16x16x32_bf16 v[224:227], v[124:127], v[80:83], v[224:227]
    s_waitcnt vmcnt(13) lgkmcnt(0)
    v_mfma_f32_16x16x32_bf16 v[176:179], v[128:131], v[64:67], v[176:179]
    buffer_load_dwordx4 v[124:127], v3, s[4:7], s24 offen offset:3072 sc1
    v_mfma_f32_16x16x32_bf16 v[180:183], v[128:131], v[68:71], v[180:183]
    ds_read_b128 v[80:83], v4 offset:19456
    v_mfma_f32_16x16x32_bf16 v[184:187], v[128:131], v[72:75], v[184:187]
    s_add_u32 s24, s24, 4096
    v_mfma_f32_16x16x32_bf16 v[188:191], v[128:131], v[76:79], v[188:191]
    v_mfma_f32_16x16x32_bf16 v[204:207], v[132:135], v[76:79], v[204:207]
    buffer_load_dwordx4 v[128:131], v3, s[4:7], s24 offen offset:0 sc1
    v_mfma_f32_16x16x32_bf16 v[200:203], v[132:135], v[72:75], v[200:203]
    ds_read_b128 v[84:87], v4 offset:37888
    v_mfma_f32_16x16x32_bf16 v[196:199], v[132:135], v[68:71], v[196:199]
    ds_read_b128 v[88:91], v4 offset:56320
    v_mfma_f32_16x16x32_bf16 v[192:195], v[132:135], v[64:67], v[192:195]
    s_waitcnt vmcnt(13)
    v_mfma_f32_16x16x32_bf16 v[208:211], v[136:139], v[64:67], v[208:211]
    buffer_load_dwordx4 v[132:135], v3, s[4:7], s24 offen offset:1024 sc1
    v_mfma_f32_16x16x32_bf16 v[212:215], v[136:139], v[68:71], v[212:215]
    ds_read_b128 v[92:95], v5 offset:9216
    v_mfma_f32_16x16x32_bf16 v[216:219], v[136:139], v[72:75], v[216:219]
    v_mfma_f32_16x16x32_bf16 v[220:223], v[136:139], v[76:79], v[220:223]
    v_mfma_f32_16x16x32_bf16 v[236:239], v[140:143], v[76:79], v[236:239]
    buffer_load_dwordx4 v[136:139], v3, s[4:7], s24 offen offset:2048 sc1
    v_mfma_f32_16x16x32_bf16 v[232:235], v[140:143], v[72:75], v[232:235]
    v_mfma_f32_16x16x32_bf16 v[228:231], v[140:143], v[68:71], v[228:231]
    v_mfma_f32_16x16x32_bf16 v[224:227], v[140:143], v[64:67], v[224:227]
    s_waitcnt vmcnt(13) lgkmcnt(0)
    v_mfma_f32_16x16x32_bf16 v[176:179], v[144:147], v[80:83], v[176:179]
    buffer_load_dwordx4 v[140:143], v3, s[4:7], s24 offen offset:3072 sc1
    v_mfma_f32_16x16x32_bf16 v[180:183], v[144:147], v[84:87], v[180:183]
    ds_read_b128 v[64:67], v4 offset:20480
    v_mfma_f32_16x16x32_bf16 v[184:187], v[144:147], v[88:91], v[184:187]
    s_add_u32 s24, s24, 4096
    v_mfma_f32_16x16x32_bf16 v[188:191], v[144:147], v[92:95], v[188:191]
    v_mfma_f32_16x16x32_bf16 v[204:207], v[148:151], v[92:95], v[204:207]
    buffer_load_dwordx4 v[144:147], v3, s[4:7], s24 offen offset:0 sc1
    v_mfma_f32_16x16x32_bf16 v[200:203], v[148:151], v[88:91], v[200:203]
    ds_read_b128 v[68:71], v4 offset:38912
    v_mfma_f32_16x16x32_bf16 v[196:199], v[148:151], v[84:87], v[196:199]
    ds_read_b128 v[72:75], v4 offset:57344
    v_mfma_f32_16x16x32_bf16 v[192:195], v[148:151], v[80:83], v[192:195]
    s_waitcnt vmcnt(13)
    v_mfma_f32_16x16x32_bf16 v[208:211], v[152:155], v[80:83], v[208:211]
    buffer_load_dwordx4 v[148:151], v3, s[4:7], s24 offen offset:1024 sc1
    v_mfma_f32_16x16x32_bf16 v[212:215], v[152:155], v[84:87], v[212:215]
    ds_read_b128 v[76:79], v5 offset:10240
    v_mfma_f32_16x16x32_bf16 v[216:219], v[152:155], v[88:91], v[216:219]
    v_mfma_f32_16x16x32_bf16 v[220:223], v[152:155], v[92:95], v[220:223]
    v_mfma_f32_16x16x32_bf16 v[236:239], v[156:159], v[92:95], v[236:239]
    buffer_load_dwordx4 v[152:155], v3, s[4:7], s24 offen offset:2048 sc1
    v_mfma_f32_16x16x32_bf16 v[232:235], v[156:159], v[88:91], v[232:235]
    v_mfma_f32_16x16x32_bf16 v[228:231], v[156:159], v[84:87], v[228:231]
    v_mfma_f32_16x16x32_bf16 v[224:227], v[156:159], v[80:83], v[224:227]
    s_waitcnt vmcnt(13) lgkmcnt(0)
    v_mfma_f32_16x16x32_bf16 v[176:179], v[96:99], v[64:67], v[176:179]
    buffer_load_dwordx4 v[156:159], v3, s[4:7], s24 offen offset:3072 sc1
    v_mfma_f32_16x16x32_bf16 v[180:183], v[96:99], v[68:71], v[180:183]
    ds_read_b128 v[80:83], v4 offset:21504
    v_mfma_f32_16x16x32_bf16 v[184:187], v[96:99], v[72:75], v[184:187]
    s_add_u32 s24, s24, 4096
    v_mfma_f32_16x16x32_bf16 v[188:191], v[96:99], v[76:79], v[188:191]
    v_mfma_f32_16x16x32_bf16 v[204:207], v[100:103], v[76:79], v[204:207]
    buffer_load_dwordx4 v[96:99], v3, s[4:7], s24 offen offset:0 sc1
    v_mfma_f32_16x16x32_bf16 v[200:203], v[100:103], v[72:75], v[200:203]
    ds_read_b128 v[84:87], v4 offset:39936
    v_mfma_f32_16x16x32_bf16 v[196:199], v[100:103], v[68:71], v[196:199]
    ds_read_b128 v[88:91], v4 offset:58368
    v_mfma_f32_16x16x32_bf16 v[192:195], v[100:103], v[64:67], v[192:195]
    s_waitcnt vmcnt(13)
    v_mfma_f32_16x16x32_bf16 v[208:211], v[104:107], v[64:67], v[208:211]
    buffer_load_dwordx4 v[100:103], v3, s[4:7], s24 offen offset:1024 sc1
    v_mfma_f32_16x16x32_bf16 v[212:215], v[104:107], v[68:71], v[212:215]
    ds_read_b128 v[92:95], v5 offset:11264
    v_mfma_f32_16x16x32_bf16 v[216:219], v[104:107], v[72:75], v[216:219]
    v_mfma_f32_16x16x32_bf16 v[220:223], v[104:107], v[76:79], v[220:223]
    v_mfma_f32_16x16x32_bf16 v[236:239], v[108:111], v[76:79], v[236:239]
    buffer_load_dwordx4 v[104:107], v3, s[4:7], s24 offen offset:2048 sc1
    v_mfma_f32_16x16x32_bf16 v[232:235], v[108:111], v[72:75], v[232:235]
    v_mfma_f32_16x16x32_bf16 v[228:231], v[108:111], v[68:71], v[228:231]
    v_mfma_f32_16x16x32_bf16 v[224:227], v[108:111], v[64:67], v[224:227]
    s_waitcnt vmcnt(13) lgkmcnt(0)
    v_mfma_f32_16x16x32_bf16 v[176:179], v[112:115], v[80:83], v[176:179]
    buffer_load_dwordx4 v[108:111], v3, s[4:7], s24 offen offset:3072 sc1
    v_mfma_f32_16x16x32_bf16 v[180:183], v[112:115], v[84:87], v[180:183]
    ds_read_b128 v[64:67], v4 offset:22528
    v_mfma_f32_16x16x32_bf16 v[184:187], v[112:115], v[88:91], v[184:187]
    s_add_u32 s24, s24, 4096
    v_mfma_f32_16x16x32_bf16 v[188:191], v[112:115], v[92:95], v[188:191]
    v_mfma_f32_16x16x32_bf16 v[204:207], v[116:119], v[92:95], v[204:207]
    buffer_load_dwordx4 v[112:115], v3, s[4:7], s24 offen offset:0 sc1
    v_mfma_f32_16x16x32_bf16 v[200:203], v[116:119], v[88:91], v[200:203]
    ds_read_b128 v[68:71], v4 offset:40960
    v_mfma_f32_16x16x32_bf16 v[196:199], v[116:119], v[84:87], v[196:199]
    ds_read_b128 v[72:75], v4 offset:59392
    v_mfma_f32_16x16x32_bf16 v[192:195], v[116:119], v[80:83], v[192:195]
    s_waitcnt vmcnt(13)
    v_mfma_f32_16x16x32_bf16 v[208:211], v[120:123], v[80:83], v[208:211]
    buffer_load_dwordx4 v[116:119], v3, s[4:7], s24 offen offset:1024 sc1
    v_mfma_f32_16x16x32_bf16 v[212:215], v[120:123], v[84:87], v[212:215]
    ds_read_b128 v[76:79], v5 offset:12288
    v_mfma_f32_16x16x32_bf16 v[216:219], v[120:123], v[88:91], v[216:219]
    v_mfma_f32_16x16x32_bf16 v[220:223], v[120:123], v[92:95], v[220:223]
    v_mfma_f32_16x16x32_bf16 v[236:239], v[124:127], v[92:95], v[236:239]
    buffer_load_dwordx4 v[120:123], v3, s[4:7], s24 offen offset:2048 sc1
    v_mfma_f32_16x16x32_bf16 v[232:235], v[124:127], v[88:91], v[232:235]
    v_mfma_f32_16x16x32_bf16 v[228:231], v[124:127], v[84:87], v[228:231]
    v_mfma_f32_16x16x32_bf16 v[224:227], v[124:127], v[80:83], v[224:227]
    s_waitcnt vmcnt(13) lgkmcnt(0)
    v_mfma_f32_16x16x32_bf16 v[176:179], v[128:131], v[64:67], v[176:179]
    buffer_load_dwordx4 v[124:127], v3, s[4:7], s24 offen offset:3072 sc1
    v_mfma_f32_16x16x32_bf16 v[180:183], v[128:131], v[68:71], v[180:183]
    ds_read_b128 v[80:83], v4 offset:23552
    v_mfma_f32_16x16x32_bf16 v[184:187], v[128:131], v[72:75], v[184:187]
    s_add_u32 s24, s24, 4096
    v_mfma_f32_16x16x32_bf16 v[188:191], v[128:131], v[76:79], v[188:191]
    v_mfma_f32_16x16x32_bf16 v[204:207], v[132:135], v[76:79], v[204:207]
    buffer_load_dwordx4 v[128:131], v3, s[4:7], s24 offen offset:0 sc1
    v_mfma_f32_16x16x32_bf16 v[200:203], v[132:135], v[72:75], v[200:203]
    ds_read_b128 v[84:87], v4 offset:41984
    v_mfma_f32_16x16x32_bf16 v[196:199], v[132:135], v[68:71], v[196:199]
    ds_read_b128 v[88:91], v4 offset:60416
    v_mfma_f32_16x16x32_bf16 v[192:195], v[132:135], v[64:67], v[192:195]
    s_waitcnt vmcnt(13)
    v_mfma_f32_16x16x32_bf16 v[208:211], v[136:139], v[64:67], v[208:211]
    buffer_load_dwordx4 v[132:135], v3, s[4:7], s24 offen offset:1024 sc1
    v_mfma_f32_16x16x32_bf16 v[212:215], v[136:139], v[68:71], v[212:215]
    ds_read_b128 v[92:95], v5 offset:13312
    v_mfma_f32_16x16x32_bf16 v[216:219], v[136:139], v[72:75], v[216:219]
    v_mfma_f32_16x16x32_bf16 v[220:223], v[136:139], v[76:79], v[220:223]
    v_mfma_f32_16x16x32_bf16 v[236:239], v[140:143], v[76:79], v[236:239]
    buffer_load_dwordx4 v[136:139], v3, s[4:7], s24 offen offset:2048 sc1
    v_mfma_f32_16x16x32_bf16 v[232:235], v[140:143], v[72:75], v[232:235]
    v_mfma_f32_16x16x32_bf16 v[228:231], v[140:143], v[68:71], v[228:231]
    v_mfma_f32_16x16x32_bf16 v[224:227], v[140:143], v[64:67], v[224:227]
    s_waitcnt vmcnt(13) lgkmcnt(0)
    v_mfma_f32_16x16x32_bf16 v[176:179], v[144:147], v[80:83], v[176:179]
    buffer_load_dwordx4 v[140:143], v3, s[4:7], s24 offen offset:3072 sc1
    v_mfma_f32_16x16x32_bf16 v[180:183], v[144:147], v[84:87], v[180:183]
    ds_read_b128 v[64:67], v4 offset:24576
    v_mfma_f32_16x16x32_bf16 v[184:187], v[144:147], v[88:91], v[184:187]
    s_add_u32 s24, s24, 4096
    v_mfma_f32_16x16x32_bf16 v[188:191], v[144:147], v[92:95], v[188:191]
    v_mfma_f32_16x16x32_bf16 v[204:207], v[148:151], v[92:95], v[204:207]
    buffer_load_dwordx4 v[144:147], v3, s[4:7], s24 offen offset:0 sc1
    v_mfma_f32_16x16x32_bf16 v[200:203], v[148:151], v[88:91], v[200:203]
    ds_read_b128 v[68:71], v4 offset:43008
    v_mfma_f32_16x16x32_bf16 v[196:199], v[148:151], v[84:87], v[196:199]
    ds_read_b128 v[72:75], v4 offset:61440
    v_mfma_f32_16x16x32_bf16 v[192:195], v[148:151], v[80:83], v[192:195]
    s_waitcnt vmcnt(13)
    v_mfma_f32_16x16x32_bf16 v[208:211], v[152:155], v[80:83], v[208:211]
    buffer_load_dwordx4 v[148:151], v3, s[4:7], s24 offen offset:1024 sc1
    v_mfma_f32_16x16x32_bf16 v[212:215], v[152:155], v[84:87], v[212:215]
    ds_read_b128 v[76:79], v5 offset:14336
    v_mfma_f32_16x16x32_bf16 v[216:219], v[152:155], v[88:91], v[216:219]
    v_mfma_f32_16x16x32_bf16 v[220:223], v[152:155], v[92:95], v[220:223]
    v_mfma_f32_16x16x32_bf16 v[236:239], v[156:159], v[92:95], v[236:239]
    buffer_load_dwordx4 v[152:155], v3, s[4:7], s24 offen offset:2048 sc1
    v_mfma_f32_16x16x32_bf16 v[232:235], v[156:159], v[88:91], v[232:235]
    v_mfma_f32_16x16x32_bf16 v[228:231], v[156:159], v[84:87], v[228:231]
    v_mfma_f32_16x16x32_bf16 v[224:227], v[156:159], v[80:83], v[224:227]
    s_waitcnt vmcnt(13) lgkmcnt(0)
    v_mfma_f32_16x16x32_bf16 v[176:179], v[96:99], v[64:67], v[176:179]
    buffer_load_dwordx4 v[156:159], v3, s[4:7], s24 offen offset:3072 sc1
    v_mfma_f32_16x16x32_bf16 v[180:183], v[96:99], v[68:71], v[180:183]
    ds_read_b128 v[80:83], v4 offset:25600
    v_mfma_f32_16x16x32_bf16 v[184:187], v[96:99], v[72:75], v[184:187]
    s_add_u32 s24, s24, 4096
    v_mfma_f32_16x16x32_bf16 v[188:191], v[96:99], v[76:79], v[188:191]
    v_mfma_f32_16x16x32_bf16 v[204:207], v[100:103], v[76:79], v[204:207]
    buffer_load_dwordx4 v[96:99], v3, s[4:7], s24 offen offset:0 sc1
    v_mfma_f32_16x16x32_bf16 v[200:203], v[100:103], v[72:75], v[200:203]
    ds_read_b128 v[84:87], v4 offset:44032
    v_mfma_f32_16x16x32_bf16 v[196:199], v[100:103], v[68:71], v[196:199]
    ds_read_b128 v[88:91], v4 offset:62464
    v_mfma_f32_16x16x32_bf16 v[192:195], v[100:103], v[64:67], v[192:195]
    s_waitcnt vmcnt(13)
    v_mfma_f32_16x16x32_bf16 v[208:211], v[104:107], v[64:67], v[208:211]
    buffer_load_dwordx4 v[100:103], v3, s[4:7], s24 offen offset:1024 sc1
    v_mfma_f32_16x16x32_bf16 v[212:215], v[104:107], v[68:71], v[212:215]
    ds_read_b128 v[92:95], v5 offset:15360
    v_mfma_f32_16x16x32_bf16 v[216:219], v[104:107], v[72:75], v[216:219]
    v_mfma_f32_16x16x32_bf16 v[220:223], v[104:107], v[76:79], v[220:223]
    v_mfma_f32_16x16x32_bf16 v[236:239], v[108:111], v[76:79], v[236:239]
    buffer_load_dwordx4 v[104:107], v3, s[4:7], s24 offen offset:2048 sc1
    v_mfma_f32_16x16x32_bf16 v[232:235], v[108:111], v[72:75], v[232:235]
    v_mfma_f32_16x16x32_bf16 v[228:231], v[108:111], v[68:71], v[228:231]
    v_mfma_f32_16x16x32_bf16 v[224:227], v[108:111], v[64:67], v[224:227]
    s_waitcnt vmcnt(13) lgkmcnt(0)
    v_mfma_f32_16x16x32_bf16 v[176:179], v[112:115], v[80:83], v[176:179]
    buffer_load_dwordx4 v[108:111], v3, s[4:7], s24 offen offset:3072 sc1
    v_mfma_f32_16x16x32_bf16 v[180:183], v[112:115], v[84:87], v[180:183]
    v_mfma_f32_16x16x32_bf16 v[184:187], v[112:115], v[88:91], v[184:187]
    s_add_u32 s24, s24, 4096
    v_mfma_f32_16x16x32_bf16 v[188:191], v[112:115], v[92:95], v[188:191]
    v_mfma_f32_16x16x32_bf16 v[204:207], v[116:119], v[92:95], v[204:207]
    buffer_load_dwordx4 v[112:115], v3, s[4:7], s24 offen offset:0 sc1
    v_mfma_f32_16x16x32_bf16 v[200:203], v[116:119], v[88:91], v[200:203]
    v_mfma_f32_16x16x32_bf16 v[196:199], v[116:119], v[84:87], v[196:199]
    v_mfma_f32_16x16x32_bf16 v[192:195], v[116:119], v[80:83], v[192:195]
    s_waitcnt vmcnt(13)
    v_mfma_f32_16x16x32_bf16 v[208:211], v[120:123], v[80:83], v[208:211]
    buffer_load_dwordx4 v[116:119], v3, s[4:7], s24 offen offset:1024 sc1
    v_mfma_f32_16x16x32_bf16 v[212:215], v[120:123], v[84:87], v[212:215]
    v_mfma_f32_16x16x32_bf16 v[216:219], v[120:123], v[88:91], v[216:219]
    v_mfma_f32_16x16x32_bf16 v[220:223], v[120:123], v[92:95], v[220:223]
    v_mfma_f32_16x16x32_bf16 v[236:239], v[124:127], v[92:95], v[236:239]
    buffer_load_dwordx4 v[120:123], v3, s[4:7], s24 offen offset:2048 sc1
    v_mfma_f32_16x16x32_bf16 v[232:235], v[124:127], v[88:91], v[232:235]
    v_mfma_f32_16x16x32_bf16 v[228:231], v[124:127], v[84:87], v[228:231]
    v_mfma_f32_16x16x32_bf16 v[224:227], v[124:127], v[80:83], v[224:227]
    buffer_load_dwordx4 v[124:127], v3, s[4:7], s24 offen offset:3072 sc1
    s_setprio 0
    s_barrier
    s_setprio 2
    s_mul_i32 s35, s27, 256
    s_add_u32 s35, s35, 24580
    s_mov_b32 s0, 0
    s_atomic_add s0, s[44:45], s35 glc
    v_mul_f32 v16, v176, v176
    v_mul_f32 v17, v177, v177
    v_mul_f32 v18, v178, v178
    v_mul_f32 v19, v179, v179
    v_fma_f32 v16, v16, v164, v160
    v_fma_f32 v17, v17, v164, v160
    v_fma_f32 v18, v18, v164, v160
    v_fma_f32 v19, v19, v164, v160
    v_mul_f32 v16, v16, v176
    v_mul_f32 v17, v17, v177
    v_mul_f32 v18, v18, v178
    v_mul_f32 v19, v19, v179
    v_exp_f32 v16, v16
    v_exp_f32 v17, v17
    v_exp_f32 v18, v18
    v_exp_f32 v19, v19
    v_fma_f32 v16, v16, v168, v168
    v_fma_f32 v17, v17, v168, v168
    v_fma_f32 v18, v18, v168, v168
    v_fma_f32 v19, v19, v168, v168
    v_rcp_f32 v16, v16
    v_rcp_f32 v17, v17
    v_rcp_f32 v18, v18
    v_rcp_f32 v19, v19
    v_mul_f32 v16, v16, v176
    v_mul_f32 v17, v17, v177
    v_mul_f32 v18, v18, v178
    v_mul_f32 v19, v19, v179
    v_cvt_pk_bf16_f32 v24, v16, v17
    v_cvt_pk_bf16_f32 v25, v18, v19
    v_mul_f32 v16, v192, v192
    v_mul_f32 v17, v193, v193
    v_mul_f32 v18, v194, v194
    v_mul_f32 v19, v195, v195
    v_fma_f32 v16, v16, v164, v160
    v_fma_f32 v17, v17, v164, v160
    v_fma_f32 v18, v18, v164, v160
    v_fma_f32 v19, v19, v164, v160
    v_mul_f32 v16, v16, v192
    v_mul_f32 v17, v17, v193
    v_mul_f32 v18, v18, v194
    v_mul_f32 v19, v19, v195
    v_exp_f32 v16, v16
    v_exp_f32 v17, v17
    v_exp_f32 v18, v18
    v_exp_f32 v19, v19
    v_fma_f32 v16, v16, v168, v168
    v_fma_f32 v17, v17, v168, v168
    v_fma_f32 v18, v18, v168, v168
    v_fma_f32 v19, v19, v168, v168
    v_rcp_f32 v16, v16
    v_rcp_f32 v17, v17
    v_rcp_f32 v18, v18
    v_rcp_f32 v19, v19
    v_mul_f32 v16, v16, v192
    v_mul_f32 v17, v17, v193
    v_mul_f32 v18, v18, v194
    v_mul_f32 v19, v19, v195
    v_cvt_pk_bf16_f32 v26, v16, v17
    v_cvt_pk_bf16_f32 v27, v18, v19
    ds_write_b128 v7, v[24:27] offset:40960
    v_mul_f32 v16, v180, v180
    v_mul_f32 v17, v181, v181
    v_mul_f32 v18, v182, v182
    v_mul_f32 v19, v183, v183
    v_fma_f32 v16, v16, v165, v161
    v_fma_f32 v17, v17, v165, v161
    v_fma_f32 v18, v18, v165, v161
    v_fma_f32 v19, v19, v165, v161
    v_mul_f32 v16, v16, v180
    v_mul_f32 v17, v17, v181
    v_mul_f32 v18, v18, v182
    v_mul_f32 v19, v19, v183
    v_exp_f32 v16, v16
    v_exp_f32 v17, v17
    v_exp_f32 v18, v18
    v_exp_f32 v19, v19
    v_fma_f32 v16, v16, v169, v169
    v_fma_f32 v17, v17, v169, v169
    v_fma_f32 v18, v18, v169, v169
    v_fma_f32 v19, v19, v169, v169
    v_rcp_f32 v16, v16
    v_rcp_f32 v17, v17
    v_rcp_f32 v18, v18
    v_rcp_f32 v19, v19
    v_mul_f32 v16, v16, v180
    v_mul_f32 v17, v17, v181
    v_mul_f32 v18, v18, v182
    v_mul_f32 v19, v19, v183
    v_cvt_pk_bf16_f32 v28, v16, v17
    v_cvt_pk_bf16_f32 v29, v18, v19
    v_mul_f32 v16, v196, v196
    v_mul_f32 v17, v197, v197
    v_mul_f32 v18, v198, v198
    v_mul_f32 v19, v199, v199
    v_fma_f32 v16, v16, v165, v161
    v_fma_f32 v17, v17, v165, v161
    v_fma_f32 v18, v18, v165, v161
    v_fma_f32 v19, v19, v165, v161
    v_mul_f32 v16, v16, v196
    v_mul_f32 v17, v17, v197
    v_mul_f32 v18, v18, v198
    v_mul_f32 v19, v19, v199
    v_exp_f32 v16, v16
    v_exp_f32 v17, v17
    v_exp_f32 v18, v18
    v_exp_f32 v19, v19
    v_fma_f32 v16, v16, v169, v169
    v_fma_f32 v17, v17, v169, v169
    v_fma_f32 v18, v18, v169, v169
    v_fma_f32 v19, v19, v169, v169
    v_rcp_f32 v16, v16
    v_rcp_f32 v17, v17
    v_rcp_f32 v18, v18
    v_rcp_f32 v19, v19
    v_mul_f32 v16, v16, v196
    v_mul_f32 v17, v17, v197
    v_mul_f32 v18, v18, v198
    v_mul_f32 v19, v19, v199
    v_cvt_pk_bf16_f32 v30, v16, v17
    v_cvt_pk_bf16_f32 v31, v18, v19
    ds_write_b128 v7, v[28:31] offset:41984
    s_waitcnt lgkmcnt(0)
    s_cmp_ge_u32 s0, 60
    s_cbranch_scc1 L_chkok_79
    s_mov_b32 s26, 0
L_poll_80:
    s_mov_b32 s3, 0
    s_atomic_add s3, s[44:45], s35 glc
    s_waitcnt lgkmcnt(0)
    s_cmp_ge_u32 s3, 60
    s_cbranch_scc1 L_pdone_81
    s_sleep 8
    s_add_u32 s26, s26, 1
    s_cmp_lt_u32 s26, 40000
    s_cbranch_scc1 L_poll_80
L_pdone_81:
L_chkok_79:
    s_mul_i32 s31, s27, 2560
    s_add_u32 s31, s31, 65536
    buffer_load_dwordx4 v[84:87], v3, s[4:7], s31 offen offset:0 sc1
    buffer_load_dwordx4 v[90:93], v3, s[4:7], s31 offen offset:1024 sc1
    buffer_load_dwordx2 v[88:89], v44, s[4:7], s31 offen offset:2048 sc1
    v_mul_f32 v16, v184, v184
    v_mul_f32 v17, v185, v185
    v_mul_f32 v18, v186, v186
    v_mul_f32 v19, v187, v187
    v_fma_f32 v16, v16, v166, v162
    v_fma_f32 v17, v17, v166, v162
    v_fma_f32 v18, v18, v166, v162
    v_fma_f32 v19, v19, v166, v162
    v_mul_f32 v16, v16, v184
    v_mul_f32 v17, v17, v185
    v_mul_f32 v18, v18, v186
    v_mul_f32 v19, v19, v187
    v_exp_f32 v16, v16
    v_exp_f32 v17, v17
    v_exp_f32 v18, v18
    v_exp_f32 v19, v19
    v_fma_f32 v16, v16, v170, v170
    v_fma_f32 v17, v17, v170, v170
    v_fma_f32 v18, v18, v170, v170
    v_fma_f32 v19, v19, v170, v170
    v_rcp_f32 v16, v16
    v_rcp_f32 v17, v17
    v_rcp_f32 v18, v18
    v_rcp_f32 v19, v19
    v_mul_f32 v16, v16, v184
    v_mul_f32 v17, v17, v185
    v_mul_f32 v18, v18, v186
    v_mul_f32 v19, v19, v187
    v_cvt_pk_bf16_f32 v24, v16, v17
    v_cvt_pk_bf16_f32 v25, v18, v19
    v_mul_f32 v16, v200, v200
    v_mul_f32 v17, v201, v201
    v_mul_f32 v18, v202, v202
    v_mul_f32 v19, v203, v203
    v_fma_f32 v16, v16, v166, v162
    v_fma_f32 v17, v17, v166, v162
    v_fma_f32 v18, v18, v166, v162
    v_fma_f32 v19, v19, v166, v162
    v_mul_f32 v16, v16, v200
    v_mul_f32 v17, v17, v201
    v_mul_f32 v18, v18, v202
    v_mul_f32 v19, v19, v203
    v_exp_f32 v16, v16
    v_exp_f32 v17, v17
    v_exp_f32 v18, v18
    v_exp_f32 v19, v19
    v_fma_f32 v16, v16, v170, v170
    v_fma_f32 v17, v17, v170, v170
    v_fma_f32 v18, v18, v170, v170
    v_fma_f32 v19, v19, v170, v170
    v_rcp_f32 v16, v16
    v_rcp_f32 v17, v17
    v_rcp_f32 v18, v18
    v_rcp_f32 v19, v19
    v_mul_f32 v16, v16, v200
    v_mul_f32 v17, v17, v201
    v_mul_f32 v18, v18, v202
    v_mul_f32 v19, v19, v203
    v_cvt_pk_bf16_f32 v26, v16, v17
    v_cvt_pk_bf16_f32 v27, v18, v19
    ds_write_b128 v7, v[24:27] offset:43008
    v_mul_f32 v16, v188, v188
    v_mul_f32 v17, v189, v189
    v_mul_f32 v18, v190, v190
    v_mul_f32 v19, v191, v191
    v_fma_f32 v16, v16, v167, v163
    v_fma_f32 v17, v17, v167, v163
    v_fma_f32 v18, v18, v167, v163
    v_fma_f32 v19, v19, v167, v163
    v_mul_f32 v16, v16, v188
    v_mul_f32 v17, v17, v189
    v_mul_f32 v18, v18, v190
    v_mul_f32 v19, v19, v191
    v_exp_f32 v16, v16
    v_exp_f32 v17, v17
    v_exp_f32 v18, v18
    v_exp_f32 v19, v19
    v_fma_f32 v16, v16, v171, v171
    v_fma_f32 v17, v17, v171, v171
    v_fma_f32 v18, v18, v171, v171
    v_fma_f32 v19, v19, v171, v171
    v_rcp_f32 v16, v16
    v_rcp_f32 v17, v17
    v_rcp_f32 v18, v18
    v_rcp_f32 v19, v19
    v_mul_f32 v16, v16, v188
    v_mul_f32 v17, v17, v189
    v_mul_f32 v18, v18, v190
    v_mul_f32 v19, v19, v191
    v_cvt_pk_bf16_f32 v28, v16, v17
    v_cvt_pk_bf16_f32 v29, v18, v19
    v_mul_f32 v16, v204, v204
    v_mul_f32 v17, v205, v205
    v_mul_f32 v18, v206, v206
    v_mul_f32 v19, v207, v207
    v_fma_f32 v16, v16, v167, v163
    v_fma_f32 v17, v17, v167, v163
    v_fma_f32 v18, v18, v167, v163
    v_fma_f32 v19, v19, v167, v163
    v_mul_f32 v16, v16, v204
    v_mul_f32 v17, v17, v205
    v_mul_f32 v18, v18, v206
    v_mul_f32 v19, v19, v207
    v_exp_f32 v16, v16
    v_exp_f32 v17, v17
    v_exp_f32 v18, v18
    v_exp_f32 v19, v19
    v_fma_f32 v16, v16, v171, v171
    v_fma_f32 v17, v17, v171, v171
    v_fma_f32 v18, v18, v171, v171
    v_fma_f32 v19, v19, v171, v171
    v_rcp_f32 v16, v16
    v_rcp_f32 v17, v17
    v_rcp_f32 v18, v18
    v_rcp_f32 v19, v19
    v_mul_f32 v16, v16, v204
    v_mul_f32 v17, v17, v205
    v_mul_f32 v18, v18, v206
    v_mul_f32 v19, v19, v207
    v_cvt_pk_bf16_f32 v30, v16, v17
    v_cvt_pk_bf16_f32 v31, v18, v19
    ds_write_b128 v7, v[28:31] offset:44032
    s_mov_b64 exec, 1
    ds_add_u32 v13, v12 offset:84
    s_mov_b64 exec, -1
    v_mul_f32 v16, v208, v208
    v_mul_f32 v17, v209, v209
    v_mul_f32 v18, v210, v210
    v_mul_f32 v19, v211, v211
    v_fma_f32 v16, v16, v164, v160
    v_fma_f32 v17, v17, v164, v160
    v_fma_f32 v18, v18, v164, v160
    v_fma_f32 v19, v19, v164, v160
    v_mul_f32 v16, v16, v208
    v_mul_f32 v17, v17, v209
    v_mul_f32 v18, v18, v210
    v_mul_f32 v19, v19, v211
    v_exp_f32 v16, v16
    v_exp_f32 v17, v17
    v_exp_f32 v18, v18
    v_exp_f32 v19, v19
    v_fma_f32 v16, v16, v168, v168
    v_fma_f32 v17, v17, v168, v168
    v_fma_f32 v18, v18, v168, v168
    v_fma_f32 v19, v19, v168, v168
    v_rcp_f32 v16, v16
    v_rcp_f32 v17, v17
    v_rcp_f32 v18, v18
    v_rcp_f32 v19, v19
    v_mul_f32 v16, v16, v208
    v_mul_f32 v17, v17, v209
    v_mul_f32 v18, v18, v210
    v_mul_f32 v19, v19, v211
    v_cvt_pk_bf16_f32 v24, v16, v17
    v_cvt_pk_bf16_f32 v25, v18, v19
    ds_write_b64 v8, v[24:25] offset:24576
    v_mul_f32 v16, v212, v212
    v_mul_f32 v17, v213, v213
    v_mul_f32 v18, v214, v214
    v_mul_f32 v19, v215, v215
    v_fma_f32 v16, v16, v165, v161
    v_fma_f32 v17, v17, v165, v161
    v_fma_f32 v18, v18, v165, v161
    v_fma_f32 v19, v19, v165, v161
    v_mul_f32 v16, v16, v212
    v_mul_f32 v17, v17, v213
    v_mul_f32 v18, v18, v214
    v_mul_f32 v19, v19, v215
    v_exp_f32 v16, v16
    v_exp_f32 v17, v17
    v_exp_f32 v18, v18
    v_exp_f32 v19, v19
    v_fma_f32 v16, v16, v169, v169
    v_fma_f32 v17, v17, v169, v169
    v_fma_f32 v18, v18, v169, v169
    v_fma_f32 v19, v19, v169, v169
    v_rcp_f32 v16, v16
    v_rcp_f32 v17, v17
    v_rcp_f32 v18, v18
    v_rcp_f32 v19, v19
    v_mul_f32 v16, v16, v212
    v_mul_f32 v17, v17, v213
    v_mul_f32 v18, v18, v214
    v_mul_f32 v19, v19, v215
    v_cvt_pk_bf16_f32 v26, v16, v17
    v_cvt_pk_bf16_f32 v27, v18, v19
    ds_write_b64 v8, v[26:27] offset:25600
    v_mul_f32 v16, v216, v216
    v_mul_f32 v17, v217, v217
    v_mul_f32 v18, v218, v218
    v_mul_f32 v19, v219, v219
    v_fma_f32 v16, v16, v166, v162
    v_fma_f32 v17, v17, v166, v162
    v_fma_f32 v18, v18, v166, v162
    v_fma_f32 v19, v19, v166, v162
    v_mul_f32 v16, v16, v216
    v_mul_f32 v17, v17, v217
    v_mul_f32 v18, v18, v218
    v_mul_f32 v19, v19, v219
    v_exp_f32 v16, v16
    v_exp_f32 v17, v17
    v_exp_f32 v18, v18
    v_exp_f32 v19, v19
    v_fma_f32 v16, v16, v170, v170
    v_fma_f32 v17, v17, v170, v170
    v_fma_f32 v18, v18, v170, v170
    v_fma_f32 v19, v19, v170, v170
    v_rcp_f32 v16, v16
    v_rcp_f32 v17, v17
    v_rcp_f32 v18, v18
    v_rcp_f32 v19, v19
    v_mul_f32 v16, v16, v216
    v_mul_f32 v17, v17, v217
    v_mul_f32 v18, v18, v218
    v_mul_f32 v19, v19, v219
    v_cvt_pk_bf16_f32 v24, v16, v17
    v_cvt_pk_bf16_f32 v25, v18, v19
    ds_write_b64 v8, v[24:25] offset:26624
    v_mul_f32 v16, v220, v220
    v_mul_f32 v17, v221, v221
    v_mul_f32 v18, v222, v222
    v_mul_f32 v19, v223, v223
    v_fma_f32 v16, v16, v167, v163
    v_fma_f32 v17, v17, v167, v163
    v_fma_f32 v18, v18, v167, v163
    v_fma_f32 v19, v19, v167, v163
    v_mul_f32 v16, v16, v220
    v_mul_f32 v17, v17, v221
    v_mul_f32 v18, v18, v222
    v_mul_f32 v19, v19, v223
    v_exp_f32 v16, v16
    v_exp_f32 v17, v17
    v_exp_f32 v18, v18
    v_exp_f32 v19, v19
    v_fma_f32 v16, v16, v171, v171
    v_fma_f32 v17, v17, v171, v171
    v_fma_f32 v18, v18, v171, v171
    v_fma_f32 v19, v19, v171, v171
    v_rcp_f32 v16, v16
    v_rcp_f32 v17, v17
    v_rcp_f32 v18, v18
    v_rcp_f32 v19, v19
    v_mul_f32 v16, v16, v220
    v_mul_f32 v17, v17, v221
    v_mul_f32 v18, v18, v222
    v_mul_f32 v19, v19, v223
    v_cvt_pk_bf16_f32 v26, v16, v17
    v_cvt_pk_bf16_f32 v27, v18, v19
    ds_write_b64 v8, v[26:27] offset:27648
    s_waitcnt vmcnt(0)
    v_mov_b32 v94, v89
    v_mov_b32 v95, 0
    v_mov_b32 v89, 0
    v_add_u32 v40, 114688, v8
    s_lshl_b32 s31, s21, 1
    v_add_u32 v41, s31, v6
    v_mfma_f32_16x16x32_bf16 v[32:35], v[84:87], v[240:243], 0
    v_mfma_f32_16x16x32_bf16 v[36:39], v[90:93], v[240:243], 0
    v_mfma_f32_16x16x16_bf16 v[32:35], v[88:89], v[48:49], v[32:35]
    v_mfma_f32_16x16x16_bf16 v[36:39], v[94:95], v[48:49], v[36:39]
    v_mfma_f32_16x16x32_bf16 v[56:59], v[84:87], v[244:247], 0
    v_mfma_f32_16x16x32_bf16 v[60:63], v[90:93], v[244:247], 0
    v_mfma_f32_16x16x16_bf16 v[56:59], v[88:89], v[50:51], v[56:59]
    v_mfma_f32_16x16x16_bf16 v[60:63], v[94:95], v[50:51], v[60:63]
    v_mfma_f32_16x16x32_bf16 v[64:67], v[84:87], v[248:251], 0
    v_mfma_f32_16x16x32_bf16 v[68:71], v[90:93], v[248:251], 0
    v_mfma_f32_16x16x16_bf16 v[64:67], v[88:89], v[52:53], v[64:67]
    v_mfma_f32_16x16x16_bf16 v[68:71], v[94:95], v[52:53], v[68:71]
    v_mfma_f32_16x16x32_bf16 v[72:75], v[84:87], v[252:255], 0
    v_mfma_f32_16x16x32_bf16 v[76:79], v[90:93], v[252:255], 0
    v_mfma_f32_16x16x16_bf16 v[72:75], v[88:89], v[54:55], v[72:75]
    v_mfma_f32_16x16x16_bf16 v[76:79], v[94:95], v[54:55], v[76:79]
    v_add_f32 v39, 0x358637bd, v39
    v_rcp_f32 v39, v39
    v_mul_f32 v38, v46, v38
    v_mul_f32 v32, v39, v32
    v_mul_f32 v33, v39, v33
    v_mul_f32 v34, v39, v34
    v_mul_f32 v35, v39, v35
    v_mul_f32 v38, v39, v38
    v_cvt_pk_bf16_f32 v32, v32, v33
    v_cvt_pk_bf16_f32 v33, v34, v35
    v_cvt_pk_bf16_f32 v34, v38, v38
    ds_write_b64 v40, v[32:33] offset:0
    ds_write_b16 v41, v34 offset:0
    v_add_f32 v63, 0x358637bd, v63
    v_rcp_f32 v63, v63
    v_mul_f32 v62, v46, v62
    v_mul_f32 v56, v63, v56
    v_mul_f32 v57, v63, v57
    v_mul_f32 v58, v63, v58
    v_mul_f32 v59, v63, v59
    v_mul_f32 v62, v63, v62
    v_cvt_pk_bf16_f32 v56, v56, v57
    v_cvt_pk_bf16_f32 v57, v58, v59
    v_cvt_pk_bf16_f32 v58, v62, v62
    ds_write_b64 v40, v[56:57] offset:1024
    ds_write_b16 v41, v58 offset:512
    v_add_f32 v71, 0x358637bd, v71
    v_rcp_f32 v71, v71
    v_mul_f32 v70, v46, v70
    v_mul_f32 v64, v71, v64
    v_mul_f32 v65, v71, v65
    v_mul_f32 v66, v71, v66
    v_mul_f32 v67, v71, v67
    v_mul_f32 v70, v71, v70
    v_cvt_pk_bf16_f32 v64, v64, v65
    v_cvt_pk_bf16_f32 v65, v66, v67
    v_cvt_pk_bf16_f32 v66, v70, v70
    ds_write_b64 v40, v[64:65] offset:2048
    ds_write_b16 v41, v66 offset:1024
    v_add_f32 v79, 0x358637bd, v79
    v_rcp_f32 v79, v79
    v_mul_f32 v78, v46, v78
    v_mul_f32 v72, v79, v72
    v_mul_f32 v73, v79, v73
    v_mul_f32 v74, v79, v74
    v_mul_f32 v75, v79, v75
    v_mul_f32 v78, v79, v78
    v_cvt_pk_bf16_f32 v72, v72, v73
    v_cvt_pk_bf16_f32 v73, v74, v75
    v_cvt_pk_bf16_f32 v74, v78, v78
    ds_write_b64 v40, v[72:73] offset:3072
    ds_write_b16 v41, v74 offset:1536
    s_mov_b64 exec, 1
    ds_add_u32 v13, v12 offset:88
    s_mov_b64 exec, -1
    v_mul_f32 v16, v224, v224
    v_mul_f32 v17, v225, v225
    v_mul_f32 v18, v226, v226
    v_mul_f32 v19, v227, v227
    v_fma_f32 v16, v16, v164, v160
    v_fma_f32 v17, v17, v164, v160
    v_fma_f32 v18, v18, v164, v160
    v_fma_f32 v19, v19, v164, v160
    v_mul_f32 v16, v16, v224
    v_mul_f32 v17, v17, v225
    v_mul_f32 v18, v18, v226
    v_mul_f32 v19, v19, v227
    v_exp_f32 v16, v16
    v_exp_f32 v17, v17
    v_exp_f32 v18, v18
    v_exp_f32 v19, v19
    v_fma_f32 v16, v16, v168, v168
    v_fma_f32 v17, v17, v168, v168
    v_fma_f32 v18, v18, v168, v168
    v_fma_f32 v19, v19, v168, v168
    v_rcp_f32 v16, v16
    v_rcp_f32 v17, v17
    v_rcp_f32 v18, v18
    v_rcp_f32 v19, v19
    v_mul_f32 v16, v16, v224
    v_mul_f32 v17, v17, v225
    v_mul_f32 v18, v18, v226
    v_mul_f32 v19, v19, v227
    v_cvt_pk_bf16_f32 v24, v16, v17
    v_cvt_pk_bf16_f32 v25, v18, v19
    ds_write_b64 v8, v[24:25] offset:32768
    v_mul_f32 v16, v228, v228
    v_mul_f32 v17, v229, v229
    v_mul_f32 v18, v230, v230
    v_mul_f32 v19, v231, v231
    v_fma_f32 v16, v16, v165, v161
    v_fma_f32 v17, v17, v165, v161
    v_fma_f32 v18, v18, v165, v161
    v_fma_f32 v19, v19, v165, v161
    v_mul_f32 v16, v16, v228
    v_mul_f32 v17, v17, v229
    v_mul_f32 v18, v18, v230
    v_mul_f32 v19, v19, v231
    v_exp_f32 v16, v16
    v_exp_f32 v17, v17
    v_exp_f32 v18, v18
    v_exp_f32 v19, v19
    v_fma_f32 v16, v16, v169, v169
    v_fma_f32 v17, v17, v169, v169
    v_fma_f32 v18, v18, v169, v169
    v_fma_f32 v19, v19, v169, v169
    v_rcp_f32 v16, v16
    v_rcp_f32 v17, v17
    v_rcp_f32 v18, v18
    v_rcp_f32 v19, v19
    v_mul_f32 v16, v16, v228
    v_mul_f32 v17, v17, v229
    v_mul_f32 v18, v18, v230
    v_mul_f32 v19, v19, v231
    v_cvt_pk_bf16_f32 v26, v16, v17
    v_cvt_pk_bf16_f32 v27, v18, v19
    ds_write_b64 v8, v[26:27] offset:33792
    v_mul_f32 v16, v232, v232
    v_mul_f32 v17, v233, v233
    v_mul_f32 v18, v234, v234
    v_mul_f32 v19, v235, v235
    v_fma_f32 v16, v16, v166, v162
    v_fma_f32 v17, v17, v166, v162
    v_fma_f32 v18, v18, v166, v162
    v_fma_f32 v19, v19, v166, v162
    v_mul_f32 v16, v16, v232
    v_mul_f32 v17, v17, v233
    v_mul_f32 v18, v18, v234
    v_mul_f32 v19, v19, v235
    v_exp_f32 v16, v16
    v_exp_f32 v17, v17
    v_exp_f32 v18, v18
    v_exp_f32 v19, v19
    v_fma_f32 v16, v16, v170, v170
    v_fma_f32 v17, v17, v170, v170
    v_fma_f32 v18, v18, v170, v170
    v_fma_f32 v19, v19, v170, v170
    v_rcp_f32 v16, v16
    v_rcp_f32 v17, v17
    v_rcp_f32 v18, v18
    v_rcp_f32 v19, v19
    v_mul_f32 v16, v16, v232
    v_mul_f32 v17, v17, v233
    v_mul_f32 v18, v18, v234
    v_mul_f32 v19, v19, v235
    v_cvt_pk_bf16_f32 v24, v16, v17
    v_cvt_pk_bf16_f32 v25, v18, v19
    ds_write_b64 v8, v[24:25] offset:34816
    v_mul_f32 v16, v236, v236
    v_mul_f32 v17, v237, v237
    v_mul_f32 v18, v238, v238
    v_mul_f32 v19, v239, v239
    v_fma_f32 v16, v16, v167, v163
    v_fma_f32 v17, v17, v167, v163
    v_fma_f32 v18, v18, v167, v163
    v_fma_f32 v19, v19, v167, v163
    v_mul_f32 v16, v16, v236
    v_mul_f32 v17, v17, v237
    v_mul_f32 v18, v18, v238
    v_mul_f32 v19, v19, v239
    v_exp_f32 v16, v16
    v_exp_f32 v17, v17
    v_exp_f32 v18, v18
    v_exp_f32 v19, v19
    v_fma_f32 v16, v16, v171, v171
    v_fma_f32 v17, v17, v171, v171
    v_fma_f32 v18, v18, v171, v171
    v_fma_f32 v19, v19, v171, v171
    v_rcp_f32 v16, v16
    v_rcp_f32 v17, v17
    v_rcp_f32 v18, v18
    v_rcp_f32 v19, v19
    v_mul_f32 v16, v16, v236
    v_mul_f32 v17, v17, v237
    v_mul_f32 v18, v18, v238
    v_mul_f32 v19, v19, v239
    v_cvt_pk_bf16_f32 v26, v16, v17
    v_cvt_pk_bf16_f32 v27, v18, v19
    ds_write_b64 v8, v[26:27] offset:35840
    s_mov_b64 exec, 1
    ds_add_u32 v13, v12 offset:92
    s_mov_b64 exec, -1
    s_waitcnt lgkmcnt(0)
    s_setprio 0
    s_add_u32 s24, s24, 4096
    buffer_load_dwordx4 v[160:163], v3, s[4:7], s24 offen offset:0 sc1
    buffer_load_dwordx4 v[164:167], v3, s[4:7], s24 offen offset:1024 sc1
    buffer_load_dwordx4 v[168:171], v3, s[4:7], s24 offen offset:2048 sc1
    buffer_load_dwordx4 v[172:175], v3, s[4:7], s24 offen offset:3072 sc1
    s_add_u32 s24, s24, 4096
    buffer_load_dwordx4 v[224:227], v3, s[4:7], s24 offen offset:0 sc1
    buffer_load_dwordx4 v[228:231], v3, s[4:7], s24 offen offset:1024 sc1
    buffer_load_dwordx4 v[232:235], v3, s[4:7], s24 offen offset:2048 sc1
    buffer_load_dwordx4 v[236:239], v3, s[4:7], s24 offen offset:3072 sc1
    s_add_u32 s24, s24, 4096
    buffer_load_dwordx4 v[240:243], v3, s[4:7], s24 offen offset:0 sc1
    buffer_load_dwordx4 v[244:247], v3, s[4:7], s24 offen offset:1024 sc1
    buffer_load_dwordx4 v[248:251], v3, s[4:7], s24 offen offset:2048 sc1
    buffer_load_dwordx4 v[252:255], v3, s[4:7], s24 offen offset:3072 sc1
    ds_read_b128 v[64:67], v3 offset:0
    ds_read_b128 v[68:71], v3 offset:1024
    ds_read_b128 v[72:75], v3 offset:2048
    ds_read_b128 v[76:79], v3 offset:3072
    s_barrier
    s_setprio 1
    s_waitcnt lgkmcnt(0)
    v_mfma_f32_16x16x32_bf16 v[176:179], v[128:131], v[64:67], 0
    ds_read_b128 v[80:83], v3 offset:4096
    v_mfma_f32_16x16x32_bf16 v[180:183], v[128:131], v[68:71], 0
    ds_read_b128 v[84:87], v3 offset:5120
    v_mfma_f32_16x16x32_bf16 v[184:187], v[128:131], v[72:75], 0
    s_add_u32 s24, s24, 4096
    v_mfma_f32_16x16x32_bf16 v[188:191], v[128:131], v[76:79], 0
    v_mfma_f32_16x16x32_bf16 v[204:207], v[132:135], v[76:79], 0
    buffer_load_dwordx4 v[128:131], v3, s[4:7], s24 offen offset:0 sc1
    v_mfma_f32_16x16x32_bf16 v[200:203], v[132:135], v[72:75], 0
    ds_read_b128 v[88:91], v3 offset:6144
    v_mfma_f32_16x16x32_bf16 v[196:199], v[132:135], v[68:71], 0
    ds_read_b128 v[92:95], v3 offset:7168
    v_mfma_f32_16x16x32_bf16 v[192:195], v[132:135], v[64:67], 0
    v_mfma_f32_16x16x32_bf16 v[208:211], v[136:139], v[64:67], 0
    buffer_load_dwordx4 v[132:135], v3, s[4:7], s24 offen offset:1024 sc1
    v_mfma_f32_16x16x32_bf16 v[212:215], v[136:139], v[68:71], 0
    v_mfma_f32_16x16x32_bf16 v[216:219], v[136:139], v[72:75], 0
    v_mfma_f32_16x16x32_bf16 v[220:223], v[136:139], v[76:79], 0
    s_waitcnt lgkmcnt(0)
    v_mfma_f32_16x16x32_bf16 v[176:179], v[140:143], v[80:83], v[176:179]
    buffer_load_dwordx4 v[136:139], v3, s[4:7], s24 offen offset:2048 sc1
    v_mfma_f32_16x16x32_bf16 v[180:183], v[140:143], v[84:87], v[180:183]
    ds_read_b128 v[64:67], v3 offset:8192
    v_mfma_f32_16x16x32_bf16 v[184:187], v[140:143], v[88:91], v[184:187]
    ds_read_b128 v[68:71], v3 offset:9216
    v_mfma_f32_16x16x32_bf16 v[188:191], v[140:143], v[92:95], v[188:191]
    v_mfma_f32_16x16x32_bf16 v[204:207], v[144:147], v[92:95], v[204:207]
    buffer_load_dwordx4 v[140:143], v3, s[4:7], s24 offen offset:3072 sc1
    v_mfma_f32_16x16x32_bf16 v[200:203], v[144:147], v[88:91], v[200:203]
    ds_read_b128 v[72:75], v3 offset:10240
    v_mfma_f32_16x16x32_bf16 v[196:199], v[144:147], v[84:87], v[196:199]
    s_add_u32 s24, s24, 4096
    v_mfma_f32_16x16x32_bf16 v[192:195], v[144:147], v[80:83], v[192:195]
    v_mfma_f32_16x16x32_bf16 v[208:211], v[148:151], v[80:83], v[208:211]
    buffer_load_dwordx4 v[144:147], v3, s[4:7], s24 offen offset:0 sc1
    v_mfma_f32_16x16x32_bf16 v[212:215], v[148:151], v[84:87], v[212:215]
    ds_read_b128 v[76:79], v3 offset:11264
    v_mfma_f32_16x16x32_bf16 v[216:219], v[148:151], v[88:91], v[216:219]
    v_mfma_f32_16x16x32_bf16 v[220:223], v[148:151], v[92:95], v[220:223]
    s_waitcnt lgkmcnt(0)
    v_mfma_f32_16x16x32_bf16 v[176:179], v[152:155], v[64:67], v[176:179]
    buffer_load_dwordx4 v[148:151], v3, s[4:7], s24 offen offset:1024 sc1
    v_mfma_f32_16x16x32_bf16 v[180:183], v[152:155], v[68:71], v[180:183]
    ds_read_b128 v[80:83], v3 offset:12288
    v_mfma_f32_16x16x32_bf16 v[184:187], v[152:155], v[72:75], v[184:187]
    ds_read_b128 v[84:87], v3 offset:13312
    v_mfma_f32_16x16x32_bf16 v[188:191], v[152:155], v[76:79], v[188:191]
    v_mfma_f32_16x16x32_bf16 v[204:207], v[156:159], v[76:79], v[204:207]
    buffer_load_dwordx4 v[152:155], v3, s[4:7], s24 offen offset:2048 sc1
    v_mfma_f32_16x16x32_bf16 v[200:203], v[156:159], v[72:75], v[200:203]
    ds_read_b128 v[88:91], v3 offset:14336
    v_mfma_f32_16x16x32_bf16 v[196:199], v[156:159], v[68:71], v[196:199]
    ds_read_b128 v[92:95], v3 offset:15360
    v_mfma_f32_16x16x32_bf16 v[192:195], v[156:159], v[64:67], v[192:195]
    v_mfma_f32_16x16x32_bf16 v[208:211], v[96:99], v[64:67], v[208:211]
    buffer_load_dwordx4 v[156:159], v3, s[4:7], s24 offen offset:3072 sc1
    v_mfma_f32_16x16x32_bf16 v[212:215], v[96:99], v[68:71], v[212:215]
    v_mfma_f32_16x16x32_bf16 v[216:219], v[96:99], v[72:75], v[216:219]
    s_add_u32 s24, s24, 4096
    v_mfma_f32_16x16x32_bf16 v[220:223], v[96:99], v[76:79], v[220:223]
    s_waitcnt lgkmcnt(0)
    v_mfma_f32_16x16x32_bf16 v[176:179], v[100:103], v[80:83], v[176:179]
    buffer_load_dwordx4 v[96:99], v3, s[4:7], s24 offen offset:0 sc1
    v_mfma_f32_16x16x32_bf16 v[180:183], v[100:103], v[84:87], v[180:183]
    ds_read_b128 v[64:67], v3 offset:16384
    v_mfma_f32_16x16x32_bf16 v[184:187], v[100:103], v[88:91], v[184:187]
    ds_read_b128 v[68:71], v3 offset:17408
    v_mfma_f32_16x16x32_bf16 v[188:191], v[100:103], v[92:95], v[188:191]
    v_mfma_f32_16x16x32_bf16 v[204:207], v[104:107], v[92:95], v[204:207]
    buffer_load_dwordx4 v[100:103], v3, s[4:7], s24 offen offset:1024 sc1
    v_mfma_f32_16x16x32_bf16 v[200:203], v[104:107], v[88:91], v[200:203]
    ds_read_b128 v[72:75], v3 offset:18432
    v_mfma_f32_16x16x32_bf16 v[196:199], v[104:107], v[84:87], v[196:199]
    ds_read_b128 v[76:79], v3 offset:19456
    v_mfma_f32_16x16x32_bf16 v[192:195], v[104:107], v[80:83], v[192:195]
    v_mfma_f32_16x16x32_bf16 v[208:211], v[108:111], v[80:83], v[208:211]
    buffer_load_dwordx4 v[104:107], v3, s[4:7], s24 offen offset:2048 sc1
    v_mfma_f32_16x16x32_bf16 v[212:215], v[108:111], v[84:87], v[212:215]
    v_mfma_f32_16x16x32_bf16 v[216:219], v[108:111], v[88:91], v[216:219]
    v_mfma_f32_16x16x32_bf16 v[220:223], v[108:111], v[92:95], v[220:223]
    s_waitcnt lgkmcnt(0)
    v_mfma_f32_16x16x32_bf16 v[176:179], v[112:115], v[64:67], v[176:179]
    buffer_load_dwordx4 v[108:111], v3, s[4:7], s24 offen offset:3072 sc1
    v_mfma_f32_16x16x32_bf16 v[180:183], v[112:115], v[68:71], v[180:183]
    ds_read_b128 v[80:83], v3 offset:20480
    v_mfma_f32_16x16x32_bf16 v[184:187], v[112:115], v[72:75], v[184:187]
    s_add_u32 s24, s24, 4096
    v_mfma_f32_16x16x32_bf16 v[188:191], v[112:115], v[76:79], v[188:191]
    v_mfma_f32_16x16x32_bf16 v[204:207], v[116:119], v[76:79], v[204:207]
    buffer_load_dwordx4 v[112:115], v3, s[4:7], s24 offen offset:0 sc1
    v_mfma_f32_16x16x32_bf16 v[200:203], v[116:119], v[72:75], v[200:203]
    ds_read_b128 v[84:87], v3 offset:21504
    v_mfma_f32_16x16x32_bf16 v[196:199], v[116:119], v[68:71], v[196:199]
    ds_read_b128 v[88:91], v3 offset:22528
    v_mfma_f32_16x16x32_bf16 v[192:195], v[116:119], v[64:67], v[192:195]
    v_mfma_f32_16x16x32_bf16 v[208:211], v[120:123], v[64:67], v[208:211]
    buffer_load_dwordx4 v[116:119], v3, s[4:7], s24 offen offset:1024 sc1
    v_mfma_f32_16x16x32_bf16 v[212:215], v[120:123], v[68:71], v[212:215]
    ds_read_b128 v[92:95], v3 offset:23552
    v_mfma_f32_16x16x32_bf16 v[216:219], v[120:123], v[72:75], v[216:219]
    v_mfma_f32_16x16x32_bf16 v[220:223], v[120:123], v[76:79], v[220:223]
    s_waitcnt vmcnt(25) lgkmcnt(0)
    v_mfma_f32_16x16x32_bf16 v[176:179], v[124:127], v[80:83], v[176:179]
    buffer_load_dwordx4 v[120:123], v3, s[4:7], s24 offen offset:2048 sc1
    v_mfma_f32_16x16x32_bf16 v[180:183], v[124:127], v[84:87], v[180:183]
    ds_read_b128 v[64:67], v3 offset:24576
    v_mfma_f32_16x16x32_bf16 v[184:187], v[124:127], v[88:91], v[184:187]
    ds_read_b128 v[68:71], v3 offset:25600
    v_mfma_f32_16x16x32_bf16 v[188:191], v[124:127], v[92:95], v[188:191]
    v_mfma_f32_16x16x32_bf16 v[204:207], v[160:163], v[92:95], v[204:207]
    buffer_load_dwordx4 v[124:127], v3, s[4:7], s24 offen offset:3072 sc1
    v_mfma_f32_16x16x32_bf16 v[200:203], v[160:163], v[88:91], v[200:203]
    ds_read_b128 v[72:75], v3 offset:26624
    v_mfma_f32_16x16x32_bf16 v[196:199], v[160:163], v[84:87], v[196:199]
    s_add_u32 s24, s24, 4096
    v_mfma_f32_16x16x32_bf16 v[192:195], v[160:163], v[80:83], v[192:195]
    s_waitcnt vmcnt(25)
    v_mfma_f32_16x16x32_bf16 v[208:211], v[164:167], v[80:83], v[208:211]
    buffer_load_dwordx4 v[160:163], v3, s[4:7], s24 offen offset:0 sc1
    v_mfma_f32_16x16x32_bf16 v[212:215], v[164:167], v[84:87], v[212:215]
    ds_read_b128 v[76:79], v3 offset:27648
    v_mfma_f32_16x16x32_bf16 v[216:219], v[164:167], v[88:91], v[216:219]
    v_mfma_f32_16x16x32_bf16 v[220:223], v[164:167], v[92:95], v[220:223]
    s_waitcnt vmcnt(25) lgkmcnt(0)
    v_mfma_f32_16x16x32_bf16 v[176:179], v[168:171], v[64:67], v[176:179]
    buffer_load_dwordx4 v[164:167], v3, s[4:7], s24 offen offset:1024 sc1
    v_mfma_f32_16x16x32_bf16 v[180:183], v[168:171], v[68:71], v[180:183]
    ds_read_b128 v[80:83], v3 offset:28672
    v_mfma_f32_16x16x32_bf16 v[184:187], v[168:171], v[72:75], v[184:187]
    ds_read_b128 v[84:87], v3 offset:29696
    v_mfma_f32_16x16x32_bf16 v[188:191], v[168:171], v[76:79], v[188:191]
    v_mfma_f32_16x16x32_bf16 v[204:207], v[172:175], v[76:79], v[204:207]
    buffer_load_dwordx4 v[168:171], v3, s[4:7], s24 offen offset:2048 sc1
    v_mfma_f32_16x16x32_bf16 v[200:203], v[172:175], v[72:75], v[200:203]
    ds_read_b128 v[88:91], v3 offset:30720
    v_mfma_f32_16x16x32_bf16 v[196:199], v[172:175], v[68:71], v[196:199]
    ds_read_b128 v[92:95], v3 offset:31744
    v_mfma_f32_16x16x32_bf16 v[192:195], v[172:175], v[64:67], v[192:195]
    s_waitcnt vmcnt(25)
    v_mfma_f32_16x16x32_bf16 v[208:211], v[224:227], v[64:67], v[208:211]
    buffer_load_dwordx4 v[172:175], v3, s[4:7], s24 offen offset:3072 sc1
    v_mfma_f32_16x16x32_bf16 v[212:215], v[224:227], v[68:71], v[212:215]
    v_mfma_f32_16x16x32_bf16 v[216:219], v[224:227], v[72:75], v[216:219]
    s_add_u32 s24, s24, 4096
    v_mfma_f32_16x16x32_bf16 v[220:223], v[224:227], v[76:79], v[220:223]
    s_waitcnt vmcnt(25) lgkmcnt(0)
    v_mfma_f32_16x16x32_bf16 v[176:179], v[228:231], v[80:83], v[176:179]
    buffer_load_dwordx4 v[224:227], v3, s[4:7], s24 offen offset:0 sc1
    v_mfma_f32_16x16x32_bf16 v[180:183], v[228:231], v[84:87], v[180:183]
    ds_read_b128 v[64:67], v3 offset:32768
    v_mfma_f32_16x16x32_bf16 v[184:187], v[228:231], v[88:91], v[184:187]
    ds_read_b128 v[68:71], v3 offset:33792
    v_mfma_f32_16x16x32_bf16 v[188:191], v[228:231], v[92:95], v[188:191]
    v_mfma_f32_16x16x32_bf16 v[204:207], v[232:235], v[92:95], v[204:207]
    buffer_load_dwordx4 v[228:231], v3, s[4:7], s24 offen offset:1024 sc1
    v_mfma_f32_16x16x32_bf16 v[200:203], v[232:235], v[88:91], v[200:203]
    ds_read_b128 v[72:75], v3 offset:34816
    v_mfma_f32_16x16x32_bf16 v[196:199], v[232:235], v[84:87], v[196:199]
    ds_read_b128 v[76:79], v3 offset:35840
    v_mfma_f32_16x16x32_bf16 v[192:195], v[232:235], v[80:83], v[192:195]
    s_waitcnt vmcnt(25)
    v_mfma_f32_16x16x32_bf16 v[208:211], v[236:239], v[80:83], v[208:211]
    buffer_load_dwordx4 v[232:235], v3, s[4:7], s24 offen offset:2048 sc1
    v_mfma_f32_16x16x32_bf16 v[212:215], v[236:239], v[84:87], v[212:215]
    v_mfma_f32_16x16x32_bf16 v[216:219], v[236:239], v[88:91], v[216:219]
    v_mfma_f32_16x16x32_bf16 v[220:223], v[236:239], v[92:95], v[220:223]
    s_waitcnt vmcnt(25) lgkmcnt(0)
    v_mfma_f32_16x16x32_bf16 v[176:179], v[240:243], v[64:67], v[176:179]
    buffer_load_dwordx4 v[236:239], v3, s[4:7], s24 offen offset:3072 sc1
    v_mfma_f32_16x16x32_bf16 v[180:183], v[240:243], v[68:71], v[180:183]
    ds_read_b128 v[80:83], v3 offset:36864
    v_mfma_f32_16x16x32_bf16 v[184:187], v[240:243], v[72:75], v[184:187]
    s_add_u32 s24, s24, 4096
    v_mfma_f32_16x16x32_bf16 v[188:191], v[240:243], v[76:79], v[188:191]
    v_mfma_f32_16x16x32_bf16 v[204:207], v[244:247], v[76:79], v[204:207]
    buffer_load_dwordx4 v[240:243], v3, s[4:7], s24 offen offset:0 sc1
    v_mfma_f32_16x16x32_bf16 v[200:203], v[244:247], v[72:75], v[200:203]
    ds_read_b128 v[84:87], v3 offset:37888
    v_mfma_f32_16x16x32_bf16 v[196:199], v[244:247], v[68:71], v[196:199]
    ds_read_b128 v[88:91], v3 offset:38912
    v_mfma_f32_16x16x32_bf16 v[192:195], v[244:247], v[64:67], v[192:195]
    s_waitcnt vmcnt(25)
    v_mfma_f32_16x16x32_bf16 v[208:211], v[248:251], v[64:67], v[208:211]
    buffer_load_dwordx4 v[244:247], v3, s[4:7], s24 offen offset:1024 sc1
    v_mfma_f32_16x16x32_bf16 v[212:215], v[248:251], v[68:71], v[212:215]
    ds_read_b128 v[92:95], v3 offset:39936
    v_mfma_f32_16x16x32_bf16 v[216:219], v[248:251], v[72:75], v[216:219]
    v_mfma_f32_16x16x32_bf16 v[220:223], v[248:251], v[76:79], v[220:223]
    s_waitcnt vmcnt(25) lgkmcnt(0)
    v_mfma_f32_16x16x32_bf16 v[176:179], v[252:255], v[80:83], v[176:179]
    buffer_load_dwordx4 v[248:251], v3, s[4:7], s24 offen offset:2048 sc1
    v_mfma_f32_16x16x32_bf16 v[180:183], v[252:255], v[84:87], v[180:183]
    ds_read_b128 v[64:67], v3 offset:40960
    v_mfma_f32_16x16x32_bf16 v[184:187], v[252:255], v[88:91], v[184:187]
    ds_read_b128 v[68:71], v3 offset:41984
    v_mfma_f32_16x16x32_bf16 v[188:191], v[252:255], v[92:95], v[188:191]
    v_mfma_f32_16x16x32_bf16 v[204:207], v[128:131], v[92:95], v[204:207]
    buffer_load_dwordx4 v[252:255], v3, s[4:7], s24 offen offset:3072 sc1
    v_mfma_f32_16x16x32_bf16 v[200:203], v[128:131], v[88:91], v[200:203]
    ds_read_b128 v[72:75], v3 offset:43008
    v_mfma_f32_16x16x32_bf16 v[196:199], v[128:131], v[84:87], v[196:199]
    s_add_u32 s24, s24, 4096
    v_mfma_f32_16x16x32_bf16 v[192:195], v[128:131], v[80:83], v[192:195]
    s_waitcnt vmcnt(25)
    v_mfma_f32_16x16x32_bf16 v[208:211], v[132:135], v[80:83], v[208:211]
    buffer_load_dwordx4 v[128:131], v3, s[4:7], s24 offen offset:0 sc1
    v_mfma_f32_16x16x32_bf16 v[212:215], v[132:135], v[84:87], v[212:215]
    ds_read_b128 v[76:79], v3 offset:44032
    v_mfma_f32_16x16x32_bf16 v[216:219], v[132:135], v[88:91], v[216:219]
    v_mfma_f32_16x16x32_bf16 v[220:223], v[132:135], v[92:95], v[220:223]
    s_waitcnt vmcnt(25) lgkmcnt(0)
    v_mfma_f32_16x16x32_bf16 v[176:179], v[136:139], v[64:67], v[176:179]
    buffer_load_dwordx4 v[132:135], v3, s[4:7], s24 offen offset:1024 sc1
    v_mfma_f32_16x16x32_bf16 v[180:183], v[136:139], v[68:71], v[180:183]
    ds_read_b128 v[80:83], v3 offset:45056
    v_mfma_f32_16x16x32_bf16 v[184:187], v[136:139], v[72:75], v[184:187]
    ds_read_b128 v[84:87], v3 offset:46080
    v_mfma_f32_16x16x32_bf16 v[188:191], v[136:139], v[76:79], v[188:191]
    v_mfma_f32_16x16x32_bf16 v[204:207], v[140:143], v[76:79], v[204:207]
    buffer_load_dwordx4 v[136:139], v3, s[4:7], s24 offen offset:2048 sc1
    v_mfma_f32_16x16x32_bf16 v[200:203], v[140:143], v[72:75], v[200:203]
    ds_read_b128 v[88:91], v3 offset:47104
    v_mfma_f32_16x16x32_bf16 v[196:199], v[140:143], v[68:71], v[196:199]
    ds_read_b128 v[92:95], v3 offset:48128
    v_mfma_f32_16x16x32_bf16 v[192:195], v[140:143], v[64:67], v[192:195]
    s_waitcnt vmcnt(25)
    v_mfma_f32_16x16x32_bf16 v[208:211], v[144:147], v[64:67], v[208:211]
    buffer_load_dwordx4 v[140:143], v3, s[4:7], s24 offen offset:3072 sc1
    v_mfma_f32_16x16x32_bf16 v[212:215], v[144:147], v[68:71], v[212:215]
    v_mfma_f32_16x16x32_bf16 v[216:219], v[144:147], v[72:75], v[216:219]
    s_add_u32 s24, s24, 4096
    v_mfma_f32_16x16x32_bf16 v[220:223], v[144:147], v[76:79], v[220:223]
    s_waitcnt vmcnt(25) lgkmcnt(0)
    v_mfma_f32_16x16x32_bf16 v[176:179], v[148:151], v[80:83], v[176:179]
    buffer_load_dwordx4 v[144:147], v3, s[4:7], s24 offen offset:0 sc1
    v_mfma_f32_16x16x32_bf16 v[180:183], v[148:151], v[84:87], v[180:183]
    ds_read_b128 v[64:67], v3 offset:49152
    v_mfma_f32_16x16x32_bf16 v[184:187], v[148:151], v[88:91], v[184:187]
    ds_read_b128 v[68:71], v3 offset:50176
    v_mfma_f32_16x16x32_bf16 v[188:191], v[148:151], v[92:95], v[188:191]
    v_mfma_f32_16x16x32_bf16 v[204:207], v[152:155], v[92:95], v[204:207]
    buffer_load_dwordx4 v[148:151], v3, s[4:7], s24 offen offset:1024 sc1
    v_mfma_f32_16x16x32_bf16 v[200:203], v[152:155], v[88:91], v[200:203]
    ds_read_b128 v[72:75], v3 offset:51200
    v_mfma_f32_16x16x32_bf16 v[196:199], v[152:155], v[84:87], v[196:199]
    ds_read_b128 v[76:79], v3 offset:52224
    v_mfma_f32_16x16x32_bf16 v[192:195], v[152:155], v[80:83], v[192:195]
    s_waitcnt vmcnt(25)
    v_mfma_f32_16x16x32_bf16 v[208:211], v[156:159], v[80:83], v[208:211]
    v_mfma_f32_16x16x32_bf16 v[212:215], v[156:159], v[84:87], v[212:215]
    v_mfma_f32_16x16x32_bf16 v[216:219], v[156:159], v[88:91], v[216:219]
    v_mfma_f32_16x16x32_bf16 v[220:223], v[156:159], v[92:95], v[220:223]
    s_waitcnt vmcnt(24) lgkmcnt(0)
    v_mfma_f32_16x16x32_bf16 v[176:179], v[96:99], v[64:67], v[176:179]
    ds_read_b128 v[80:83], v3 offset:53248
    v_mfma_f32_16x16x32_bf16 v[180:183], v[96:99], v[68:71], v[180:183]
    ds_read_b128 v[84:87], v3 offset:54272
    v_mfma_f32_16x16x32_bf16 v[184:187], v[96:99], v[72:75], v[184:187]
    ds_read_b128 v[88:91], v3 offset:55296
    v_mfma_f32_16x16x32_bf16 v[188:191], v[96:99], v[76:79], v[188:191]
    v_mfma_f32_16x16x32_bf16 v[204:207], v[100:103], v[76:79], v[204:207]
    ds_read_b128 v[92:95], v3 offset:56320
    v_mfma_f32_16x16x32_bf16 v[200:203], v[100:103], v[72:75], v[200:203]
    v_mfma_f32_16x16x32_bf16 v[196:199], v[100:103], v[68:71], v[196:199]
    v_mfma_f32_16x16x32_bf16 v[192:195], v[100:103], v[64:67], v[192:195]
    s_waitcnt vmcnt(22)
    v_mfma_f32_16x16x32_bf16 v[208:211], v[104:107], v[64:67], v[208:211]
    v_mfma_f32_16x16x32_bf16 v[212:215], v[104:107], v[68:71], v[212:215]
    v_mfma_f32_16x16x32_bf16 v[216:219], v[104:107], v[72:75], v[216:219]
    v_mfma_f32_16x16x32_bf16 v[220:223], v[104:107], v[76:79], v[220:223]
    s_waitcnt vmcnt(21) lgkmcnt(0)
    v_mfma_f32_16x16x32_bf16 v[176:179], v[108:111], v[80:83], v[176:179]
    ds_read_b128 v[64:67], v3 offset:57344
    v_mfma_f32_16x16x32_bf16 v[180:183], v[108:111], v[84:87], v[180:183]
    ds_read_b128 v[68:71], v3 offset:58368
    v_mfma_f32_16x16x32_bf16 v[184:187], v[108:111], v[88:91], v[184:187]
    ds_read_b128 v[72:75], v3 offset:59392
    v_mfma_f32_16x16x32_bf16 v[188:191], v[108:111], v[92:95], v[188:191]
    v_mfma_f32_16x16x32_bf16 v[204:207], v[112:115], v[92:95], v[204:207]
    ds_read_b128 v[76:79], v3 offset:60416
    v_mfma_f32_16x16x32_bf16 v[200:203], v[112:115], v[88:91], v[200:203]
    v_mfma_f32_16x16x32_bf16 v[196:199], v[112:115], v[84:87], v[196:199]
    v_mfma_f32_16x16x32_bf16 v[192:195], v[112:115], v[80:83], v[192:195]
    s_waitcnt vmcnt(19)
    v_mfma_f32_16x16x32_bf16 v[208:211], v[116:119], v[80:83], v[208:211]
    v_mfma_f32_16x16x32_bf16 v[212:215], v[116:119], v[84:87], v[212:215]
    v_mfma_f32_16x16x32_bf16 v[216:219], v[116:119], v[88:91], v[216:219]
    v_mfma_f32_16x16x32_bf16 v[220:223], v[116:119], v[92:95], v[220:223]
    s_waitcnt vmcnt(18) lgkmcnt(0)
    v_mfma_f32_16x16x32_bf16 v[176:179], v[120:123], v[64:67], v[176:179]
    ds_read_b128 v[80:83], v3 offset:61440
    v_mfma_f32_16x16x32_bf16 v[180:183], v[120:123], v[68:71], v[180:183]
    ds_read_b128 v[84:87], v3 offset:62464
    v_mfma_f32_16x16x32_bf16 v[184:187], v[120:123], v[72:75], v[184:187]
    ds_read_b128 v[88:91], v3 offset:63488
    v_mfma_f32_16x16x32_bf16 v[188:191], v[120:123], v[76:79], v[188:191]
    v_mfma_f32_16x16x32_bf16 v[204:207], v[124:127], v[76:79], v[204:207]
    ds_read_b128 v[92:95], v3 offset:64512
    v_mfma_f32_16x16x32_bf16 v[200:203], v[124:127], v[72:75], v[200:203]
    v_mfma_f32_16x16x32_bf16 v[196:199], v[124:127], v[68:71], v[196:199]
    v_mfma_f32_16x16x32_bf16 v[192:195], v[124:127], v[64:67], v[192:195]
    s_waitcnt vmcnt(16)
    v_mfma_f32_16x16x32_bf16 v[208:211], v[160:163], v[64:67], v[208:211]
    v_mfma_f32_16x16x32_bf16 v[212:215], v[160:163], v[68:71], v[212:215]
    v_mfma_f32_16x16x32_bf16 v[216:219], v[160:163], v[72:75], v[216:219]
    v_mfma_f32_16x16x32_bf16 v[220:223], v[160:163], v[76:79], v[220:223]
    s_waitcnt vmcnt(15) lgkmcnt(0)
    v_mfma_f32_16x16x32_bf16 v[176:179], v[164:167], v[80:83], v[176:179]
    ds_read_b128 v[64:67], v5 offset:16384
    v_mfma_f32_16x16x32_bf16 v[180:183], v[164:167], v[84:87], v[180:183]
    ds_read_b128 v[68:71], v5 offset:17408
    v_mfma_f32_16x16x32_bf16 v[184:187], v[164:167], v[88:91], v[184:187]
    ds_read_b128 v[72:75], v5 offset:18432
    v_mfma_f32_16x16x32_bf16 v[188:191], v[164:167], v[92:95], v[188:191]
    v_mfma_f32_16x16x32_bf16 v[204:207], v[168:171], v[92:95], v[204:207]
    ds_read_b128 v[76:79], v5 offset:19456
    v_mfma_f32_16x16x32_bf16 v[200:203], v[168:171], v[88:91], v[200:203]
    v_mfma_f32_16x16x32_bf16 v[196:199], v[168:171], v[84:87], v[196:199]
    v_mfma_f32_16x16x32_bf16 v[192:195], v[168:171], v[80:83], v[192:195]
    s_waitcnt vmcnt(13)
    v_mfma_f32_16x16x32_bf16 v[208:211], v[172:175], v[80:83], v[208:211]
    v_mfma_f32_16x16x32_bf16 v[212:215], v[172:175], v[84:87], v[212:215]
    v_mfma_f32_16x16x32_bf16 v[216:219], v[172:175], v[88:91], v[216:219]
    v_mfma_f32_16x16x32_bf16 v[220:223], v[172:175], v[92:95], v[220:223]
    s_waitcnt vmcnt(12) lgkmcnt(0)
    v_mfma_f32_16x16x32_bf16 v[176:179], v[224:227], v[64:67], v[176:179]
    ds_read_b128 v[80:83], v5 offset:20480
    v_mfma_f32_16x16x32_bf16 v[180:183], v[224:227], v[68:71], v[180:183]
    ds_read_b128 v[84:87], v5 offset:21504
    v_mfma_f32_16x16x32_bf16 v[184:187], v[224:227], v[72:75], v[184:187]
    ds_read_b128 v[88:91], v5 offset:22528
    v_mfma_f32_16x16x32_bf16 v[188:191], v[224:227], v[76:79], v[188:191]
    v_mfma_f32_16x16x32_bf16 v[204:207], v[228:231], v[76:79], v[204:207]
    ds_read_b128 v[92:95], v5 offset:23552
    v_mfma_f32_16x16x32_bf16 v[200:203], v[228:231], v[72:75], v[200:203]
    v_mfma_f32_16x16x32_bf16 v[196:199], v[228:231], v[68:71], v[196:199]
    v_mfma_f32_16x16x32_bf16 v[192:195], v[228:231], v[64:67], v[192:195]
    s_waitcnt vmcnt(10)
    v_mfma_f32_16x16x32_bf16 v[208:211], v[232:235], v[64:67], v[208:211]
    v_mfma_f32_16x16x32_bf16 v[212:215], v[232:235], v[68:71], v[212:215]
    v_mfma_f32_16x16x32_bf16 v[216:219], v[232:235], v[72:75], v[216:219]
    v_mfma_f32_16x16x32_bf16 v[220:223], v[232:235], v[76:79], v[220:223]
    s_waitcnt vmcnt(9) lgkmcnt(0)
    v_mfma_f32_16x16x32_bf16 v[176:179], v[236:239], v[80:83], v[176:179]
    ds_read_b64 v[64:65], v6 offset:0
    v_mfma_f32_16x16x32_bf16 v[180:183], v[236:239], v[84:87], v[180:183]
    ds_read_b64 v[68:69], v6 offset:512
    v_mfma_f32_16x16x32_bf16 v[184:187], v[236:239], v[88:91], v[184:187]
    ds_read_b64 v[72:73], v6 offset:1024
    v_mfma_f32_16x16x32_bf16 v[188:191], v[236:239], v[92:95], v[188:191]
    v_mfma_f32_16x16x32_bf16 v[204:207], v[240:243], v[92:95], v[204:207]
    ds_read_b64 v[76:77], v6 offset:1536
    v_mfma_f32_16x16x32_bf16 v[200:203], v[240:243], v[88:91], v[200:203]
    v_mfma_f32_16x16x32_bf16 v[196:199], v[240:243], v[84:87], v[196:199]
    v_mfma_f32_16x16x32_bf16 v[192:195], v[240:243], v[80:83], v[192:195]
    s_waitcnt vmcnt(7)
    v_mfma_f32_16x16x32_bf16 v[208:211], v[244:247], v[80:83], v[208:211]
    v_mfma_f32_16x16x32_bf16 v[212:215], v[244:247], v[84:87], v[212:215]
    v_mfma_f32_16x16x32_bf16 v[216:219], v[244:247], v[88:91], v[216:219]
    v_mfma_f32_16x16x32_bf16 v[220:223], v[244:247], v[92:95], v[220:223]
    s_waitcnt vmcnt(6) lgkmcnt(0)
    v_mfma_f32_16x16x16_bf16 v[176:179], v[248:249], v[64:65], v[176:179]
    ds_read_b128 v[80:83], v4 offset:0
    v_mfma_f32_16x16x16_bf16 v[180:183], v[248:249], v[68:69], v[180:183]
    ds_read_b128 v[84:87], v4 offset:1024
    v_mfma_f32_16x16x16_bf16 v[184:187], v[248:249], v[72:73], v[184:187]
    ds_read_b128 v[88:91], v4 offset:2048
    v_mfma_f32_16x16x16_bf16 v[188:191], v[248:249], v[76:77], v[188:191]
    v_mfma_f32_16x16x16_bf16 v[204:207], v[250:251], v[76:77], v[204:207]
    ds_read_b128 v[92:95], v4 offset:3072
    v_mfma_f32_16x16x16_bf16 v[200:203], v[250:251], v[72:73], v[200:203]
    v_mfma_f32_16x16x16_bf16 v[196:199], v[250:251], v[68:69], v[196:199]
    v_mfma_f32_16x16x16_bf16 v[192:195], v[250:251], v[64:65], v[192:195]
    s_waitcnt vmcnt(5)
    v_mfma_f32_16x16x16_bf16 v[208:211], v[252:253], v[64:65], v[208:211]
    v_mfma_f32_16x16x16_bf16 v[212:215], v[252:253], v[68:69], v[212:215]
    v_mfma_f32_16x16x16_bf16 v[216:219], v[252:253], v[72:73], v[216:219]
    v_mfma_f32_16x16x16_bf16 v[220:223], v[252:253], v[76:77], v[220:223]
    s_waitcnt vmcnt(4) lgkmcnt(0)
    v_mfma_f32_16x16x32_bf16 v[176:179], v[128:131], v[80:83], v[176:179]
    ds_read_b128 v[64:67], v4 offset:4096
    v_mfma_f32_16x16x32_bf16 v[180:183], v[128:131], v[84:87], v[180:183]
    ds_read_b128 v[68:71], v4 offset:5120
    v_mfma_f32_16x16x32_bf16 v[184:187], v[128:131], v[88:91], v[184:187]
    ds_read_b128 v[72:75], v4 offset:6144
    v_mfma_f32_16x16x32_bf16 v[188:191], v[128:131], v[92:95], v[188:191]
    v_mfma_f32_16x16x32_bf16 v[204:207], v[132:135], v[92:95], v[204:207]
    ds_read_b128 v[76:79], v4 offset:7168
    v_mfma_f32_16x16x32_bf16 v[200:203], v[132:135], v[88:91], v[200:203]
    v_mfma_f32_16x16x32_bf16 v[196:199], v[132:135], v[84:87], v[196:199]
    v_mfma_f32_16x16x32_bf16 v[192:195], v[132:135], v[80:83], v[192:195]
    s_waitcnt vmcnt(2)
    v_mfma_f32_16x16x32_bf16 v[208:211], v[136:139], v[80:83], v[208:211]
    v_mfma_f32_16x16x32_bf16 v[212:215], v[136:139], v[84:87], v[212:215]
    v_mfma_f32_16x16x32_bf16 v[216:219], v[136:139], v[88:91], v[216:219]
    v_mfma_f32_16x16x32_bf16 v[220:223], v[136:139], v[92:95], v[220:223]
    s_waitcnt vmcnt(1) lgkmcnt(0)
    v_mfma_f32_16x16x32_bf16 v[176:179], v[140:143], v[64:67], v[176:179]
    v_mfma_f32_16x16x32_bf16 v[180:183], v[140:143], v[68:71], v[180:183]
    v_mfma_f32_16x16x32_bf16 v[184:187], v[140:143], v[72:75], v[184:187]
    v_mfma_f32_16x16x32_bf16 v[188:191], v[140:143], v[76:79], v[188:191]
    v_mfma_f32_16x16x32_bf16 v[204:207], v[144:147], v[76:79], v[204:207]
    v_mfma_f32_16x16x32_bf16 v[200:203], v[144:147], v[72:75], v[200:203]
    v_mfma_f32_16x16x32_bf16 v[196:199], v[144:147], v[68:71], v[196:199]
    v_mfma_f32_16x16x32_bf16 v[192:195], v[144:147], v[64:67], v[192:195]
    s_waitcnt vmcnt(0)
    v_mfma_f32_16x16x32_bf16 v[208:211], v[148:151], v[64:67], v[208:211]
    v_mfma_f32_16x16x32_bf16 v[212:215], v[148:151], v[68:71], v[212:215]
    v_mfma_f32_16x16x32_bf16 v[216:219], v[148:151], v[72:75], v[216:219]
    v_mfma_f32_16x16x32_bf16 v[220:223], v[148:151], v[76:79], v[220:223]
    s_setprio 0
    s_barrier
    s_and_b32 s31, s23, 3
    v_lshrrev_b32 v16, 2, v1
    v_cmp_eq_u32 vcc, s31, v16
    v_mov_b32 v17, 0x40000000
    s_cmp_lt_u32 s23, 4
    s_cselect_b64 s[84:85], vcc, 0
    s_cselect_b64 s[86:87], 0, vcc
    v_cndmask_b32 v9, v9, v17, s[84:85]
    v_cndmask_b32 v10, v10, v17, s[86:87]
    s_lshl_b32 s31, s21, 8
    s_add_u32 s31, s31, 73728
    v_and_b32 v16, 3, v0
    v_lshl_add_u32 v16, v2, 2, v16
    v_lshl_add_u32 v16, v16, 4, s31
    v_add_u32 v17, 90112, v3
    v_cndmask_b32 v42, v17, v16, s[84:85]
    v_cndmask_b32 v43, v17, v16, s[86:87]
    s_setprio 2
    s_mov_b32 s25, 262144
    v_cvt_pk_bf16_f32 v16, v176, v177
    v_cvt_pk_bf16_f32 v17, v178, v179
    v_cvt_pk_bf16_f32 v18, v180, v181
    v_cvt_pk_bf16_f32 v19, v182, v183
    buffer_store_dwordx4 v[16:19], v9, s[4:7], s25 offen sc1
    ds_write_b128 v42, v[16:19] offset:4096
    v_cvt_pk_bf16_f32 v20, v184, v185
    v_cvt_pk_bf16_f32 v21, v186, v187
    v_cvt_pk_bf16_f32 v22, v188, v189
    v_cvt_pk_bf16_f32 v23, v190, v191
    buffer_store_dwordx4 v[20:23], v10, s[4:7], s25 offen sc1
    ds_write_b128 v43, v[20:23] offset:4096
    v_bfe_u32 v52, v0, 2, 2
    v_lshrrev_b32 v53, 5, v0
    v_lshl_add_u32 v52, v52, 1, v53
    s_lshl_b32 s33, s21, 3
    v_add_u32 v52, s33, v52
    s_and_b32 s33, s23, 3
    s_lshl_b32 s33, s33, 2
    v_and_b32 v53, 3, v0
    v_add_u32 v53, s33, v53
    s_lshr_b32 s33, s23, 2
    s_lshl_b32 s33, s33, 1
    s_lshl2_add_u32 s33, s22, s33
    v_and_b32 v54, 1, v2
    v_add_u32 v54, s33, v54
    v_lshl_add_u32 v55, v54, 4, v53
    v_mul_u32_u24 v55, 1152, v55
    v_lshl_add_u32 v40, v52, 4, v55
    buffer_load_dwordx4 v[240:243], v40, s[8:11], 0 offen
    v_mul_u32_u24 v55, 57, v52
    v_lshrrev_b32 v55, 9, v55
    v_mul_u32_u24 v56, 9, v55
    v_sub_u32 v56, v52, v56
    v_cmp_eq_u32 vcc, 8, v56
    v_and_b32 v57, 1, v56
    v_lshl_add_u32 v57, v55, 1, v57
    v_lshrrev_b32 v58, 1, v56
    v_lshl_add_u32 v57, v57, 2, v58
    v_lshl_add_u32 v57, v57, 4, v53
    v_lshlrev_b32 v57, 4, v57
    v_lshl_add_u32 v58, v55, 5, v53
    v_lshlrev_b32 v58, 3, v58
    v_add_u32 v58, 16384, v58
    v_cndmask_b32 v57, v57, v58, vcc
    v_mov_b32 v59, 0x80
    v_cndmask_b32 v59, 8, v59, vcc
    v_mul_u32_u24 v54, 18432, v54
    v_add_u32 v49, v57, v54
    v_add_u32 v50, v49, v59
    s_mov_b32 s33, 5767168
    buffer_load_dwordx2 v[244:245], v49, s[4:7], s33 offen sc1
    buffer_load_dwordx2 v[246:247], v50, s[4:7], s33 offen sc1
    v_and_b32 v48, 3, v1
    v_cmp_eq_u32 vcc, v48, v2
    v_bfe_u32 v48, v1, 2, 1
    v_lshrrev_b32 v49, 3, v1
    v_lshl_add_u32 v48, v48, 1, v49
    v_cndmask_b32 v48, 7, v48, vcc
    v_mov_b32 v49, 0x3f80
    v_cmp_eq_u32 vcc, 0, v48
    s_nop 1
    v_cndmask_b32 v32, 0, v49, vcc
    v_lshlrev_b32 v36, 16, v32
    v_cmp_eq_u32 vcc, 1, v48
    s_nop 1
    v_cndmask_b32 v33, 0, v49, vcc
    v_lshlrev_b32 v37, 16, v33
    v_cmp_eq_u32 vcc, 2, v48
    s_nop 1
    v_cndmask_b32 v34, 0, v49, vcc
    v_lshlrev_b32 v38, 16, v34
    v_cmp_eq_u32 vcc, 3, v48
    s_nop 1
    v_cndmask_b32 v35, 0, v49, vcc
    v_lshlrev_b32 v39, 16, v35
    s_waitcnt vmcnt(4)
    s_mov_b32 s25, 327680
    v_cvt_pk_bf16_f32 v24, v192, v193
    v_cvt_pk_bf16_f32 v25, v194, v195
    v_cvt_pk_bf16_f32 v26, v196, v197
    v_cvt_pk_bf16_f32 v27, v198, v199
    buffer_store_dwordx4 v[24:27], v9, s[4:7], s25 offen sc1
    ds_write_b128 v42, v[24:27] offset:5120
    s_waitcnt vmcnt(4)
    v_cvt_pk_bf16_f32 v28, v200, v201
    v_cvt_pk_bf16_f32 v29, v202, v203
    v_cvt_pk_bf16_f32 v30, v204, v205
    v_cvt_pk_bf16_f32 v31, v206, v207
    buffer_store_dwordx4 v[28:31], v10, s[4:7], s25 offen sc1
    ds_write_b128 v43, v[28:31] offset:5120
    s_waitcnt vmcnt(1)
    s_mov_b32 s25, 393216
    v_cvt_pk_bf16_f32 v16, v208, v209
    v_cvt_pk_bf16_f32 v17, v210, v211
    v_cvt_pk_bf16_f32 v18, v212, v213
    v_cvt_pk_bf16_f32 v19, v214, v215
    buffer_store_dwordx4 v[16:19], v9, s[4:7], s25 offen sc1
    ds_write_b128 v42, v[16:19] offset:6144
    s_waitcnt vmcnt(1)
    v_cvt_pk_bf16_f32 v20, v216, v217
    v_cvt_pk_bf16_f32 v21, v218, v219
    v_cvt_pk_bf16_f32 v22, v220, v221
    v_cvt_pk_bf16_f32 v23, v222, v223
    buffer_store_dwordx4 v[20:23], v10, s[4:7], s25 offen sc1
    ds_write_b128 v43, v[20:23] offset:6144
    s_mul_i32 s33, s22, 9
    s_add_u32 s33, s33, s21
    s_lshl_b32 s33, s33, 16
    s_lshl_b32 s34, s23, 13
    s_add_u32 s33, s33, s34
    s_add_u32 s33, s33, 22020096
    s_mov_b32 s12, s54
    s_and_b32 s13, s55, 0xffff
    s_mov_b32 s14, 2359296
    s_mov_b32 s15, 0x20000
    s_mul_i32 s31, s22, 1024
    s_add_u32 s31, s31, 12
    s_lshl_b32 s32, s21, 10
    s_add_u32 s32, s32, 73728
    v_add_u32 v148, s32, v3
    s_lshl_b32 s34, s23, 10
    s_mov_b32 s26, 0
L_poll_82:
    s_mov_b32 s3, 0
    s_atomic_add s3, s[44:45], s31 glc
    s_waitcnt lgkmcnt(0)
    s_cmp_ge_u32 s3, 8
    s_cbranch_scc1 L_pdone_83
    s_add_u32 s26, s26, 1
    s_cmp_lt_u32 s26, 40000
    s_cbranch_scc1 L_poll_82
L_pdone_83:
    ds_read_b128 v[96:99], v148
    s_add_u32 s34, s34, 1024
    s_and_b32 s34, s34, 8191
    s_add_u32 s32, s33, s34
    buffer_load_dwordx4 v[100:103], v3, s[4:7], s32 offen sc1
    s_add_u32 s34, s34, 1024
    s_and_b32 s34, s34, 8191
    s_add_u32 s32, s33, s34
    buffer_load_dwordx4 v[104:107], v3, s[4:7], s32 offen sc1
    s_add_u32 s34, s34, 1024
    s_and_b32 s34, s34, 8191
    s_add_u32 s32, s33, s34
    buffer_load_dwordx4 v[108:111], v3, s[4:7], s32 offen sc1
    s_add_u32 s34, s34, 1024
    s_and_b32 s34, s34, 8191
    s_add_u32 s32, s33, s34
    buffer_load_dwordx4 v[112:115], v3, s[4:7], s32 offen sc1
    s_add_u32 s34, s34, 1024
    s_and_b32 s34, s34, 8191
    s_add_u32 s32, s33, s34
    buffer_load_dwordx4 v[116:119], v3, s[4:7], s32 offen sc1
    s_add_u32 s34, s34, 1024
    s_and_b32 s34, s34, 8191
    s_add_u32 s32, s33, s34
    buffer_load_dwordx4 v[120:123], v3, s[4:7], s32 offen sc1
    s_add_u32 s34, s34, 1024
    s_and_b32 s34, s34, 8191
    s_add_u32 s32, s33, s34
    buffer_load_dwordx4 v[124:127], v3, s[4:7], s32 offen sc1
    s_waitcnt vmcnt(8)
    s_mul_i32 s31, s22, 1024
    s_add_u32 s31, s31, 268
    s_waitcnt vmcnt(7)
    s_mov_b64 exec, 1
    ds_add_rtn_u32 v14, v13, v12 offset:132
    s_mov_b64 exec, -1
    s_waitcnt lgkmcnt(0)
    v_readfirstlane_b32 s3, v14
    s_nop 0
    s_cmp_lg_u32 s3, 3
    s_cbranch_scc1 L_arr_84
    s_mov_b32 s1, 1
    s_atomic_add s1, s[44:45], s31
L_arr_84:
    s_mov_b32 s89, 8
    s_cmp_lg_u32 s21, 0
    s_cbranch_scc1 L_nop8
    v_bfe_u32 v20, v0, 2, 2
    v_lshrrev_b32 v21, 5, v0
    v_lshl_add_u32 v20, v20, 1, v21
    s_lshl_b32 s33, s89, 3
    v_add_u32 v20, s33, v20
    s_and_b32 s33, s23, 3
    s_lshl_b32 s33, s33, 2
    v_and_b32 v21, 3, v0
    v_add_u32 v21, s33, v21
    s_lshr_b32 s33, s23, 2
    s_lshl_b32 s33, s33, 1
    s_lshl2_add_u32 s33, s22, s33
    v_and_b32 v22, 1, v2
    v_add_u32 v22, s33, v22
    v_lshl_add_u32 v23, v22, 4, v21
    v_mul_u32_u24 v23, 1152, v23
    v_lshl_add_u32 v41, v20, 4, v23
    buffer_load_dwordx4 v[248:251], v41, s[8:11], 0 offen
    v_mul_u32_u24 v23, 57, v20
    v_lshrrev_b32 v23, 9, v23
    v_mul_u32_u24 v24, 9, v23
    v_sub_u32 v24, v20, v24
    v_cmp_eq_u32 vcc, 8, v24
    v_and_b32 v25, 1, v24
    v_lshl_add_u32 v25, v23, 1, v25
    v_lshrrev_b32 v26, 1, v24
    v_lshl_add_u32 v25, v25, 2, v26
    v_lshl_add_u32 v25, v25, 4, v21
    v_lshlrev_b32 v25, 4, v25
    v_lshl_add_u32 v26, v23, 5, v21
    v_lshlrev_b32 v26, 3, v26
    v_add_u32 v26, 16384, v26
    v_cndmask_b32 v25, v25, v26, vcc
    v_mov_b32 v27, 0x80
    v_cndmask_b32 v27, 8, v27, vcc
    v_mul_u32_u24 v22, 18432, v22
    v_add_u32 v17, v25, v22
    v_add_u32 v18, v17, v27
    s_mov_b32 s33, 5767168
    buffer_load_dwordx2 v[252:253], v17, s[4:7], s33 offen sc1
    buffer_load_dwordx2 v[254:255], v18, s[4:7], s33 offen sc1
L_nop8:
    v_lshlrev_b32 v140, 16, v240
    v_and_b32 v141, s28, v240
    v_lshlrev_b32 v149, 16, v244
    v_and_b32 v150, s28, v244
    v_add_f32 v140, v140, v149
    v_add_f32 v141, v141, v150
    v_lshlrev_b32 v142, 16, v241
    v_and_b32 v143, s28, v241
    v_lshlrev_b32 v149, 16, v245
    v_and_b32 v150, s28, v245
    v_add_f32 v142, v142, v149
    v_add_f32 v143, v143, v150
    v_lshlrev_b32 v144, 16, v242
    v_and_b32 v145, s28, v242
    v_lshlrev_b32 v149, 16, v246
    v_and_b32 v150, s28, v246
    v_add_f32 v144, v144, v149
    v_add_f32 v145, v145, v150
    v_lshlrev_b32 v146, 16, v243
    v_and_b32 v147, s28, v243
    v_lshlrev_b32 v149, 16, v247
    v_and_b32 v150, s28, v247
    v_add_f32 v146, v146, v149
    v_add_f32 v147, v147, v150
    v_mfma_f32_16x16x32_bf16 v[140:143], v[32:35], v[96:99], v[140:143]
    s_nop 0
    v_mfma_f32_16x16x32_bf16 v[144:147], v[36:39], v[96:99], v[144:147]
    s_waitcnt vmcnt(6)
    v_mfma_f32_16x16x32_bf16 v[140:143], v[32:35], v[100:103], v[140:143]
    v_mfma_f32_16x16x32_bf16 v[144:147], v[36:39], v[100:103], v[144:147]
    s_waitcnt vmcnt(5)
    v_mfma_f32_16x16x32_bf16 v[140:143], v[32:35], v[104:107], v[140:143]
    v_mfma_f32_16x16x32_bf16 v[144:147], v[36:39], v[104:107], v[144:147]
    s_waitcnt vmcnt(4)
    v_mfma_f32_16x16x32_bf16 v[140:143], v[32:35], v[108:111], v[140:143]
    v_mfma_f32_16x16x32_bf16 v[144:147], v[36:39], v[108:111], v[144:147]
    s_waitcnt vmcnt(3)
    v_mfma_f32_16x16x32_bf16 v[140:143], v[32:35], v[112:115], v[140:143]
    v_mfma_f32_16x16x32_bf16 v[144:147], v[36:39], v[112:115], v[144:147]
    s_waitcnt vmcnt(2)
    v_mfma_f32_16x16x32_bf16 v[140:143], v[32:35], v[116:119], v[140:143]
    v_mfma_f32_16x16x32_bf16 v[144:147], v[36:39], v[116:119], v[144:147]
    s_waitcnt vmcnt(1)
    v_mfma_f32_16x16x32_bf16 v[140:143], v[32:35], v[120:123], v[140:143]
    v_mfma_f32_16x16x32_bf16 v[144:147], v[36:39], v[120:123], v[144:147]
    s_waitcnt vmcnt(0)
    v_mfma_f32_16x16x32_bf16 v[140:143], v[32:35], v[124:127], v[140:143]
    v_mfma_f32_16x16x32_bf16 v[144:147], v[36:39], v[124:127], v[144:147]
    s_nop 6
    v_cvt_pk_bf16_f32 v240, v140, v141
    v_cvt_pk_bf16_f32 v241, v142, v143
    v_cvt_pk_bf16_f32 v242, v144, v145
    v_cvt_pk_bf16_f32 v243, v146, v147
    buffer_store_dwordx4 v[240:243], v40, s[12:15], 0 offen sc1
    s_cmp_lg_u32 s21, 0
    s_cbranch_scc1 L_nor8
    s_waitcnt vmcnt(0)
    s_mul_i32 s33, s22, 9
    s_add_u32 s33, s33, s89
    s_lshl_b32 s33, s33, 16
    s_lshl_b32 s34, s23, 13
    s_add_u32 s33, s33, s34
    s_add_u32 s33, s33, 22020096
    s_mov_b32 s12, s54
    s_and_b32 s13, s55, 0xffff
    s_mov_b32 s14, 2359296
    s_mov_b32 s15, 0x20000
    s_mul_i32 s31, s22, 1024
    s_add_u32 s31, s31, 524
    s_lshl_b32 s32, s89, 10
    s_add_u32 s32, s32, 73728
    v_add_u32 v148, s32, v3
    s_lshl_b32 s34, s23, 10
    s_mov_b32 s26, 0
L_poll_85:
    s_mov_b32 s3, 0
    s_atomic_add s3, s[44:45], s31 glc
    s_waitcnt lgkmcnt(0)
    s_cmp_ge_u32 s3, 8
    s_cbranch_scc1 L_pdone_86
    s_add_u32 s26, s26, 1
    s_cmp_lt_u32 s26, 40000
    s_cbranch_scc1 L_poll_85
L_pdone_86:
    ds_read_b128 v[96:99], v148
    s_add_u32 s34, s34, 1024
    s_and_b32 s34, s34, 8191
    s_add_u32 s32, s33, s34
    buffer_load_dwordx4 v[100:103], v3, s[4:7], s32 offen sc1
    s_add_u32 s34, s34, 1024
    s_and_b32 s34, s34, 8191
    s_add_u32 s32, s33, s34
    buffer_load_dwordx4 v[104:107], v3, s[4:7], s32 offen sc1
    s_add_u32 s34, s34, 1024
    s_and_b32 s34, s34, 8191
    s_add_u32 s32, s33, s34
    buffer_load_dwordx4 v[108:111], v3, s[4:7], s32 offen sc1
    s_add_u32 s34, s34, 1024
    s_and_b32 s34, s34, 8191
    s_add_u32 s32, s33, s34
    buffer_load_dwordx4 v[112:115], v3, s[4:7], s32 offen sc1
    s_add_u32 s34, s34, 1024
    s_and_b32 s34, s34, 8191
    s_add_u32 s32, s33, s34
    buffer_load_dwordx4 v[116:119], v3, s[4:7], s32 offen sc1
    s_add_u32 s34, s34, 1024
    s_and_b32 s34, s34, 8191
    s_add_u32 s32, s33, s34
    buffer_load_dwordx4 v[120:123], v3, s[4:7], s32 offen sc1
    s_add_u32 s34, s34, 1024
    s_and_b32 s34, s34, 8191
    s_add_u32 s32, s33, s34
    buffer_load_dwordx4 v[124:127], v3, s[4:7], s32 offen sc1
    v_lshlrev_b32 v140, 16, v248
    v_and_b32 v141, s28, v248
    v_lshlrev_b32 v149, 16, v252
    v_and_b32 v150, s28, v252
    v_add_f32 v140, v140, v149
    v_add_f32 v141, v141, v150
    v_lshlrev_b32 v142, 16, v249
    v_and_b32 v143, s28, v249
    v_lshlrev_b32 v149, 16, v253
    v_and_b32 v150, s28, v253
    v_add_f32 v142, v142, v149
    v_add_f32 v143, v143, v150
    v_lshlrev_b32 v144, 16, v250
    v_and_b32 v145, s28, v250
    v_lshlrev_b32 v149, 16, v254
    v_and_b32 v150, s28, v254
    v_add_f32 v144, v144, v149
    v_add_f32 v145, v145, v150
    v_lshlrev_b32 v146, 16, v251
    v_and_b32 v147, s28, v251
    v_lshlrev_b32 v149, 16, v255
    v_and_b32 v150, s28, v255
    v_add_f32 v146, v146, v149
    v_add_f32 v147, v147, v150
    s_waitcnt lgkmcnt(0)
    v_mfma_f32_16x16x32_bf16 v[140:143], v[32:35], v[96:99], v[140:143]
    v_mfma_f32_16x16x32_bf16 v[144:147], v[36:39], v[96:99], v[144:147]
    s_waitcnt vmcnt(6)
    v_mfma_f32_16x16x32_bf16 v[140:143], v[32:35], v[100:103], v[140:143]
    v_mfma_f32_16x16x32_bf16 v[144:147], v[36:39], v[100:103], v[144:147]
    s_waitcnt vmcnt(5)
    v_mfma_f32_16x16x32_bf16 v[140:143], v[32:35], v[104:107], v[140:143]
    v_mfma_f32_16x16x32_bf16 v[144:147], v[36:39], v[104:107], v[144:147]
    s_waitcnt vmcnt(4)
    v_mfma_f32_16x16x32_bf16 v[140:143], v[32:35], v[108:111], v[140:143]
    v_mfma_f32_16x16x32_bf16 v[144:147], v[36:39], v[108:111], v[144:147]
    s_waitcnt vmcnt(3)
    v_mfma_f32_16x16x32_bf16 v[140:143], v[32:35], v[112:115], v[140:143]
    v_mfma_f32_16x16x32_bf16 v[144:147], v[36:39], v[112:115], v[144:147]
    s_waitcnt vmcnt(2)
    v_mfma_f32_16x16x32_bf16 v[140:143], v[32:35], v[116:119], v[140:143]
    v_mfma_f32_16x16x32_bf16 v[144:147], v[36:39], v[116:119], v[144:147]
    s_waitcnt vmcnt(1)
    v_mfma_f32_16x16x32_bf16 v[140:143], v[32:35], v[120:123], v[140:143]
    v_mfma_f32_16x16x32_bf16 v[144:147], v[36:39], v[120:123], v[144:147]
    s_waitcnt vmcnt(0)
    v_mfma_f32_16x16x32_bf16 v[140:143], v[32:35], v[124:127], v[140:143]
    v_mfma_f32_16x16x32_bf16 v[144:147], v[36:39], v[124:127], v[144:147]
    s_nop 6
    v_cvt_pk_bf16_f32 v248, v140, v141
    v_cvt_pk_bf16_f32 v249, v142, v143
    v_cvt_pk_bf16_f32 v250, v144, v145
    v_cvt_pk_bf16_f32 v251, v146, v147
    buffer_store_dwordx4 v[248:251], v41, s[12:15], 0 offen sc1
L_nor8:
L_fin:
L_end:
    s_endpgm
.p2align 8
.type L_table,@object
L_table:
.long 896,82944,4608,9216,1152,20736,9121792,537089024
.long 592896,663552,18432,36864,4608,1152,67108864,268572672
.long 1327104,1152,147456,294912,9216,36864,8933376,218112
.long 4645760,1152,147456,294912,9216,36864,9844736,137216
.long 151680,663552,18432,36864,4608,73728,9882624,268572672
.long 592896,663552,18432,36864,4608,1152,67109888,268572672
.long 3318016,1152,147456,294912,9216,36864,8966144,218112
.long 147712,663552,18432,36864,4608,73728,9023488,268653568
.long 19200,82944,1152,0,20736,0,9915392,537008128
.long 592896,663552,18432,36864,4608,1152,67110912,268572672
.long 590336,1152,36864,663552,9216,1327104,8998912,218112
.long 371200,663552,18432,36864,4608,73728,9056256,268653568
.long 592896,663552,18432,36864,4608,1152,67111936,268572672
.long 592896,663552,18432,36864,4608,1152,67111936,268572672
.long 1991552,1152,147456,294912,9216,36864,9811968,137216
.long 896,663552,18432,36864,4608,73728,9089024,268653568
.long 1024,82944,4608,9216,1152,20736,9122816,537089024
.long 592896,663552,18432,36864,4608,1152,67112960,268572672
.long 1327232,1152,147456,294912,9216,36864,8934400,218112
.long 4645888,1152,147456,294912,9216,36864,9845760,137216
.long 295424,663552,18432,36864,4608,1152,9883648,268572672
.long 592896,663552,18432,36864,4608,1152,67113984,268572672
.long 3318144,1152,147456,294912,9216,36864,8967168,218112
.long 147840,663552,18432,36864,4608,73728,9024512,268653568
.long 590336,663552,18432,36864,4608,1152,9916416,268572672
.long 592896,663552,18432,36864,4608,1152,67115008,268572672
.long 3244032,1152,36864,663552,9216,1327104,8999936,218112
.long 371328,663552,18432,36864,4608,73728,9057280,268653568
.long 592896,663552,18432,36864,4608,1152,67116032,268572672
.long 592896,663552,18432,36864,4608,1152,67116032,268572672
.long 1991680,1152,147456,294912,9216,36864,9812992,137216
.long 1024,663552,18432,36864,4608,73728,9090048,268653568
.long 42368,82944,4608,9216,1152,20736,9123840,537089024
.long 592896,663552,18432,36864,4608,1152,67117056,268572672
.long 1327360,1152,147456,294912,9216,36864,8935424,218112
.long 4719232,1152,147456,294912,9216,36864,9846784,137216
.long 295552,663552,18432,36864,4608,1152,9884672,268572672
.long 592896,663552,18432,36864,4608,1152,67118080,268572672
.long 3318272,1152,147456,294912,9216,36864,8968192,218112
.long 148608,663552,18432,36864,4608,73728,9025536,268653568
.long 590464,663552,18432,36864,4608,1152,9917440,268572672
.long 592896,663552,18432,36864,4608,1152,67119104,268572672
.long 3244160,1152,36864,663552,9216,1327104,9000960,218112
.long 372096,663552,18432,36864,4608,73728,9058304,268653568
.long 592896,663552,18432,36864,4608,1152,67120128,268572672
.long 592896,663552,18432,36864,4608,1152,67120128,268572672
.long 2065024,1152,147456,294912,9216,36864,9814016,137216
.long 2048,663552,18432,36864,4608,73728,9091072,268653568
.long 42496,82944,4608,9216,1152,20736,9124864,537089024
.long 592896,663552,18432,36864,4608,1152,67121152,268572672
.long 1327488,1152,147456,294912,9216,36864,8936448,218112
.long 4719360,1152,147456,294912,9216,36864,9847808,137216
.long 295680,663552,18432,36864,4608,1152,9885696,268572672
.long 592896,663552,18432,36864,4608,1152,67122176,268572672
.long 3391488,1152,147456,294912,9216,36864,8969216,218112
.long 148736,663552,18432,36864,4608,73728,9026560,268653568
.long 590592,663552,18432,36864,4608,1152,9918464,268572672
.long 592896,663552,18432,36864,4608,1152,67123200,268572672
.long 3244288,1152,36864,663552,9216,1327104,9001984,218112
.long 372224,663552,18432,36864,4608,73728,9059328,268653568
.long 592896,663552,18432,36864,4608,1152,67124224,268572672
.long 592896,663552,18432,36864,4608,1152,67124224,268572672
.long 2065152,1152,147456,294912,9216,36864,9815040,137216
.long 2176,663552,18432,36864,4608,73728,9092096,268653568
.long 19328,82944,1152,0,20736,128,9125888,537089024
.long 592896,663552,18432,36864,4608,1152,67125248,268572672
.long 1327616,1152,147456,294912,9216,36864,8937472,218112
.long 4719488,1152,147456,294912,9216,36864,9848832,137216
.long 297728,663552,18432,36864,4608,1152,9886720,268572672
.long 592896,663552,18432,36864,4608,1152,67126272,268572672
.long 3391616,1152,147456,294912,9216,36864,8970240,218112
.long 148864,663552,18432,36864,4608,73728,9027584,268653568
.long 592640,663552,18432,36864,4608,1152,9919488,268572672
.long 592896,663552,18432,36864,4608,1152,67127296,268572672
.long 3244416,1152,36864,663552,9216,1327104,9003008,218112
.long 372352,663552,18432,36864,4608,73728,9060352,268653568
.long 592896,663552,18432,36864,4608,1152,67128320,268572672
.long 592896,663552,18432,36864,4608,1152,67128320,268572672
.long 2065280,1152,147456,294912,9216,36864,9816064,137216
.long 3200,663552,18432,36864,4608,73728,9093120,268653568
.long 590720,663552,18432,36864,4608,1152,9126912,268653568
.long 592896,663552,18432,36864,4608,1152,67129344,268572672
.long 1400832,1152,147456,294912,9216,36864,8938496,218112
.long 4719616,1152,147456,294912,9216,36864,9849856,137216
.long 297856,663552,18432,36864,4608,1152,9887744,268572672
.long 592896,663552,18432,36864,4608,1152,67130368,268572672
.long 3391744,1152,147456,294912,9216,36864,8971264,218112
.long 148992,663552,18432,36864,4608,73728,9028608,268653568
.long 592768,663552,18432,36864,4608,1152,9920512,268572672
.long 592896,663552,18432,36864,4608,1152,67131392,268572672
.long 3244544,1152,36864,663552,9216,1327104,9004032,218112
.long 372480,663552,18432,36864,4608,73728,9061376,268653568
.long 592896,663552,18432,36864,4608,1152,67132416,268572672
.long 592896,663552,18432,36864,4608,1152,67132416,268572672
.long 2065408,1152,147456,294912,9216,36864,9817088,137216
.long 3328,663552,18432,36864,4608,73728,9094144,268653568
.long 590848,663552,18432,36864,4608,1152,9127936,268653568
.long 592896,663552,18432,36864,4608,1152,67133440,268572672
.long 1400960,1152,147456,294912,9216,36864,8939520,218112
.long 590464,1152,36864,663552,9216,1327104,9850880,137216
.long 297984,663552,18432,36864,4608,1152,9888768,268572672
.long 592896,663552,18432,36864,4608,1152,67134464,268572672
.long 3391872,1152,147456,294912,9216,36864,8972288,218112
.long 149760,663552,18432,36864,4608,73728,9029632,268653568
.long 592896,663552,18432,36864,4608,1152,9921536,268572672
.long 592896,663552,18432,36864,4608,1152,67135488,268572672
.long 640,1152,147456,294912,9216,36864,9785344,137216
.long 516096,663552,18432,36864,4608,1152,9062400,268653568
.long 592896,663552,18432,36864,4608,1152,67136512,268572672
.long 592896,663552,18432,36864,4608,1152,67136512,268572672
.long 2654848,1152,147456,294912,9216,36864,9818112,137216
.long 4352,663552,18432,36864,4608,73728,9095168,268653568
.long 593024,663552,18432,36864,4608,1152,9128960,268653568
.long 592896,663552,18432,36864,4608,1152,67137536,268572672
.long 1401088,1152,147456,294912,9216,36864,8940544,218112
.long 590592,1152,36864,663552,9216,1327104,9851904,137216
.long 369152,663552,18432,36864,4608,73728,9889792,268572672
.long 592896,663552,18432,36864,4608,1152,67138560,268572672
.long 3392000,1152,147456,294912,9216,36864,8973312,218112
.long 149888,663552,18432,36864,4608,73728,9030656,268653568
.long 592896,663552,18432,36864,4608,1152,67139584,268572672
.long 592896,663552,18432,36864,4608,1152,67139584,268572672
.long 768,1152,147456,294912,9216,36864,9786368,137216
.long 516224,663552,18432,36864,4608,1152,9063424,268653568
.long 592896,663552,18432,36864,4608,1152,67140608,268572672
.long 592896,663552,18432,36864,4608,1152,67140608,268572672
.long 2654976,1152,147456,294912,9216,36864,9819136,137216
.long 4480,663552,18432,36864,4608,73728,9096192,268653568
.long 593152,663552,18432,36864,4608,1152,9129984,268653568
.long 592896,663552,18432,36864,4608,1152,67141632,268572672
.long 1401216,1152,147456,294912,9216,36864,8941568,218112
.long 590720,1152,36864,663552,9216,1327104,9852928,137216
.long 369280,663552,18432,36864,4608,73728,9890816,268572672
.long 592896,663552,18432,36864,4608,1152,67142656,268572672
.long 3981312,1152,147456,294912,9216,36864,8974336,218112
.long 150016,663552,18432,36864,4608,73728,9031680,268653568
.long 592896,663552,18432,36864,4608,1152,67143680,268572672
.long 592896,663552,18432,36864,4608,1152,67143680,268572672
.long 896,1152,147456,294912,9216,36864,9787392,137216
.long 516352,663552,18432,36864,4608,1152,9064448,268653568
.long 592896,663552,18432,36864,4608,1152,67144704,268572672
.long 592896,663552,18432,36864,4608,1152,67144704,268572672
.long 2655104,1152,147456,294912,9216,36864,9820160,137216
.long 148352,663552,18432,36864,4608,73728,9097216,268653568
.long 512,663552,18432,36864,4608,73728,9859072,268572672
.long 592896,663552,18432,36864,4608,1152,67145728,268572672
.long 1401344,1152,147456,294912,9216,36864,8942592,218112
.long 590848,1152,36864,663552,9216,1327104,9853952,137216
.long 369408,663552,18432,36864,4608,73728,9891840,268572672
.long 592896,663552,18432,36864,4608,1152,67146752,268572672
.long 3981440,1152,147456,294912,9216,36864,8975360,218112
.long 150144,663552,18432,36864,4608,73728,9032704,268653568
.long 592896,663552,18432,36864,4608,1152,67147776,268572672
.long 592896,663552,18432,36864,4608,1152,67147776,268572672
.long 1024,1152,147456,294912,9216,36864,9788416,137216
.long 516480,663552,18432,36864,4608,1152,9065472,268653568
.long 592896,663552,18432,36864,4608,1152,67148800,268572672
.long 592896,663552,18432,36864,4608,1152,67148800,268572672
.long 2655232,1152,147456,294912,9216,36864,9821184,137216
.long 148480,663552,18432,36864,4608,73728,9098240,268653568
.long 640,663552,18432,36864,4608,73728,9860096,268572672
.long 592896,663552,18432,36864,4608,1152,67149824,268572672
.long 1990656,1152,147456,294912,9216,36864,8943616,218112
.long 3244672,1152,36864,663552,9216,1327104,9854976,137216
.long 370304,663552,18432,36864,4608,73728,9892864,268572672
.long 592896,663552,18432,36864,4608,1152,67150848,268572672
.long 3981568,1152,147456,294912,9216,36864,8976384,218112
.long 150912,663552,18432,36864,4608,73728,9033728,268653568
.long 592896,663552,18432,36864,4608,1152,67151872,268572672
.long 592896,663552,18432,36864,4608,1152,67151872,268572672
.long 74368,1152,147456,294912,9216,36864,9789440,137216
.long 518400,663552,18432,36864,4608,1152,9066496,268653568
.long 592896,663552,18432,36864,4608,1152,67152896,268572672
.long 592896,663552,18432,36864,4608,1152,67152896,268572672
.long 2728576,1152,147456,294912,9216,36864,9822208,137216
.long 149504,663552,18432,36864,4608,73728,9099264,268653568
.long 768,663552,18432,36864,4608,73728,9861120,268572672
.long 592896,663552,18432,36864,4608,1152,67153920,268572672
.long 1990784,1152,147456,294912,9216,36864,8944640,218112
.long 3244800,1152,36864,663552,9216,1327104,9856000,137216
.long 370432,663552,18432,36864,4608,73728,9893888,268572672
.long 592896,663552,18432,36864,4608,1152,67154944,268572672
.long 3981696,1152,147456,294912,9216,36864,8977408,218112
.long 151040,663552,18432,36864,4608,73728,9034752,268653568
.long 592896,663552,18432,36864,4608,1152,67155968,268572672
.long 592896,663552,18432,36864,4608,1152,67155968,268572672
.long 74496,1152,147456,294912,9216,36864,9790464,137216
.long 518528,663552,18432,36864,4608,1152,9067520,268653568
.long 592896,663552,18432,36864,4608,1152,67156992,268572672
.long 592896,663552,18432,36864,4608,1152,67156992,268572672
.long 2728704,1152,147456,294912,9216,36864,9823232,137216
.long 149632,663552,18432,36864,4608,73728,9100288,268653568
.long 1664,663552,18432,36864,4608,73728,9862144,268572672
.long 592896,663552,18432,36864,4608,1152,67158016,268572672
.long 1990912,1152,147456,294912,9216,36864,8945664,218112
.long 3244928,1152,36864,663552,9216,1327104,9857024,137216
.long 370560,663552,18432,36864,4608,73728,9894912,268572672
.long 592896,663552,18432,36864,4608,1152,67159040,268572672
.long 3981824,1152,147456,294912,9216,36864,8978432,218112
.long 151168,663552,18432,36864,4608,73728,9035776,268653568
.long 592896,663552,18432,36864,4608,1152,67160064,268572672
.long 592896,663552,18432,36864,4608,1152,67160064,268572672
.long 74624,1152,147456,294912,9216,36864,9791488,137216
.long 518656,663552,18432,36864,4608,1152,9068544,268653568
.long 592896,663552,18432,36864,4608,1152,67161088,268572672
.long 592896,663552,18432,36864,4608,1152,67161088,268572672
.long 2728832,1152,147456,294912,9216,36864,9824256,137216
.long 150656,663552,18432,36864,4608,73728,9101312,268653568
.long 1792,663552,18432,36864,4608,73728,9863168,268572672
.long 592896,663552,18432,36864,4608,1152,67162112,268572672
.long 1991040,1152,147456,294912,9216,36864,8946688,218112
.long 3245056,1152,36864,663552,9216,1327104,9858048,137216
.long 371456,663552,18432,36864,4608,73728,9895936,268572672
.long 592896,663552,18432,36864,4608,1152,67163136,268572672
.long 4055040,1152,147456,294912,9216,36864,8979456,218112
.long 151296,663552,18432,36864,4608,73728,9036800,268653568
.long 592896,663552,18432,36864,4608,1152,67164160,268572672
.long 592896,663552,18432,36864,4608,1152,67164160,268572672
.long 74752,1152,147456,294912,9216,36864,9792512,137216
.long 518784,663552,18432,36864,4608,1152,9069568,268653568
.long 592896,663552,18432,36864,4608,1152,67165184,268572672
.long 592896,663552,18432,36864,4608,1152,67165184,268572672
.long 2728960,1152,147456,294912,9216,36864,9825280,137216
.long 150784,663552,18432,36864,4608,73728,9102336,268653568
.long 1920,663552,18432,36864,4608,73728,9864192,268572672
.long 592896,663552,18432,36864,4608,1152,67166208,268572672
.long 1991168,1152,147456,294912,9216,36864,8947712,218112
.long 0,663552,18432,36864,4608,73728,9005056,268653568
.long 371584,663552,18432,36864,4608,73728,9896960,268572672
.long 592896,663552,18432,36864,4608,1152,67167232,268572672
.long 4055168,1152,147456,294912,9216,36864,8980480,218112
.long 294912,663552,18432,36864,4608,1152,9037824,268653568
.long 592896,663552,18432,36864,4608,1152,67168256,268572672
.long 592896,663552,18432,36864,4608,1152,67168256,268572672
.long 664192,1152,147456,294912,9216,36864,9793536,137216
.long 0,82944,4608,9216,1152,20736,9070592,537089024
.long 592896,663552,18432,36864,4608,1152,67169280,268572672
.long 592896,663552,18432,36864,4608,1152,67169280,268572672
.long 3318400,1152,147456,294912,9216,36864,9826304,137216
.long 151808,663552,18432,36864,4608,73728,9103360,268653568
.long 2816,663552,18432,36864,4608,73728,9865216,268572672
.long 592896,663552,18432,36864,4608,1152,67170304,268572672
.long 2064384,1152,147456,294912,9216,36864,8948736,218112
.long 128,663552,18432,36864,4608,73728,9006080,268653568
.long 371712,663552,18432,36864,4608,73728,9897984,268572672
.long 592896,663552,18432,36864,4608,1152,67171328,268572672
.long 4055296,1152,147456,294912,9216,36864,8981504,218112
.long 295040,663552,18432,36864,4608,1152,9038848,268653568
.long 592896,663552,18432,36864,4608,1152,67172352,268572672
.long 592896,663552,18432,36864,4608,1152,67172352,268572672
.long 664320,1152,147456,294912,9216,36864,9794560,137216
.long 128,82944,4608,9216,1152,20736,9071616,537089024
.long 592896,663552,18432,36864,4608,1152,67173376,268572672
.long 592896,663552,18432,36864,4608,1152,67173376,268572672
.long 3318528,1152,147456,294912,9216,36864,9827328,137216
.long 151936,663552,18432,36864,4608,73728,9104384,268653568
.long 2944,663552,18432,36864,4608,73728,9866240,268572672
.long 592896,663552,18432,36864,4608,1152,67174400,268572672
.long 2064512,1152,147456,294912,9216,36864,8949760,218112
.long 256,663552,18432,36864,4608,73728,9007104,268653568
.long 372608,663552,18432,36864,4608,73728,9899008,268572672
.long 592896,663552,18432,36864,4608,1152,67175424,268572672
.long 4055424,1152,147456,294912,9216,36864,8982528,218112
.long 295168,663552,18432,36864,4608,1152,9039872,268653568
.long 592896,663552,18432,36864,4608,1152,67176448,268572672
.long 592896,663552,18432,36864,4608,1152,67176448,268572672
.long 664448,1152,147456,294912,9216,36864,9795584,137216
.long 256,82944,4608,9216,1152,20736,9072640,537089024
.long 592896,663552,18432,36864,4608,1152,67177472,268572672
.long 592896,663552,18432,36864,4608,1152,67177472,268572672
.long 3318656,1152,147456,294912,9216,36864,9828352,137216
.long 295808,663552,18432,36864,4608,1152,9105408,268653568
.long 3072,663552,18432,36864,4608,73728,9867264,268572672
.long 592896,663552,18432,36864,4608,1152,67178496,268572672
.long 2064640,1152,147456,294912,9216,36864,8950784,218112
.long 384,663552,18432,36864,4608,73728,9008128,268653568
.long 372736,663552,18432,36864,4608,73728,9900032,268572672
.long 592896,663552,18432,36864,4608,1152,67179520,268572672
.long 4055552,1152,147456,294912,9216,36864,8983552,218112
.long 295296,663552,18432,36864,4608,1152,9040896,268653568
.long 592896,663552,18432,36864,4608,1152,67180544,268572672
.long 592896,663552,18432,36864,4608,1152,67180544,268572672
.long 664576,1152,147456,294912,9216,36864,9796608,137216
.long 384,82944,4608,9216,1152,20736,9073664,537089024
.long 592896,663552,18432,36864,4608,1152,67181568,268572672
.long 592896,663552,18432,36864,4608,1152,67181568,268572672
.long 3318784,1152,147456,294912,9216,36864,9829376,137216
.long 295936,663552,18432,36864,4608,1152,9106432,268653568
.long 3968,663552,18432,36864,4608,73728,9868288,268572672
.long 0,144,4608,9216,1152,18432,10334208,805307392
.long 2064768,1152,147456,294912,9216,36864,8951808,218112
.long 1152,663552,18432,36864,4608,73728,9009152,268653568
.long 372864,663552,18432,36864,4608,73728,9901056,268572672
.long 580608,144,4608,9216,1152,18432,10398720,805307392
.long 4644864,1152,147456,294912,9216,36864,8984576,218112
.long 297216,663552,18432,36864,4608,1152,9041920,268653568
.long 592896,663552,18432,36864,4608,1152,67184640,268572672
.long 414720,144,4608,9216,1152,18432,10380288,1073742848
.long 737920,1152,147456,294912,9216,36864,9797632,137216
.long 41472,82944,4608,9216,1152,20736,9074688,537089024
.long 592896,663552,18432,36864,4608,1152,67185664,268572672
.long 73856,1152,147456,294912,9216,36864,8919040,218112
.long 3392128,1152,147456,294912,9216,36864,9830400,137216
.long 298112,663552,18432,36864,4608,1152,9107456,268653568
.long 4096,663552,18432,36864,4608,73728,9869312,268572672
.long 36864,144,4608,9216,1152,18432,10338816,805307392
.long 2064896,1152,147456,294912,9216,36864,8952832,218112
.long 1280,663552,18432,36864,4608,73728,9010176,268653568
.long 516608,663552,18432,36864,4608,1152,9902080,268572672
.long 617472,144,4608,9216,1152,18432,10403328,805307392
.long 4644992,1152,147456,294912,9216,36864,8985600,218112
.long 297344,663552,18432,36864,4608,1152,9042944,268653568
.long 592896,663552,18432,36864,4608,1152,67188736,268572672
.long 451584,144,4608,9216,1152,18432,10384896,1073742848
.long 738048,1152,147456,294912,9216,36864,9798656,137216
.long 41600,82944,4608,9216,1152,20736,9075712,537089024
.long 592896,663552,18432,36864,4608,1152,67189760,268572672
.long 73984,1152,147456,294912,9216,36864,8920064,218112
.long 3392256,1152,147456,294912,9216,36864,9831424,137216
.long 298240,663552,18432,36864,4608,1152,9108480,268653568
.long 4224,663552,18432,36864,4608,73728,9870336,268572672
.long 82944,144,4608,9216,1152,18432,10343424,805307392
.long 2654208,1152,147456,294912,9216,36864,8953856,218112
.long 1408,663552,18432,36864,4608,73728,9011200,268653568
.long 516736,663552,18432,36864,4608,1152,9903104,268572672
.long 73728,144,4608,82944,1152,165888,10407936,805307392
.long 4645120,1152,147456,294912,9216,36864,8986624,218112
.long 297472,663552,18432,36864,4608,1152,9043968,268653568
.long 592896,663552,18432,36864,4608,1152,67192832,268572672
.long 497664,144,4608,9216,1152,18432,10389504,1073742848
.long 738176,1152,147456,294912,9216,36864,9799680,137216
.long 41728,82944,4608,9216,1152,20736,9076736,537089024
.long 592896,663552,18432,36864,4608,1152,67193856,268572672
.long 74112,1152,147456,294912,9216,36864,8921088,218112
.long 3392384,1152,147456,294912,9216,36864,9832448,137216
.long 369536,663552,18432,36864,4608,73728,9109504,268653568
.long 147968,663552,18432,36864,4608,73728,9871360,268572672
.long 119808,144,4608,9216,1152,18432,10348032,805307392
.long 2654336,1152,147456,294912,9216,36864,8954880,218112
.long 1536,663552,18432,36864,4608,73728,9012224,268653568
.long 516864,663552,18432,36864,4608,1152,9904128,268572672
.long 405504,144,4608,82944,1152,165888,10412544,805307392
.long 4645248,1152,147456,294912,9216,36864,8987648,218112
.long 297600,663552,18432,36864,4608,1152,9044992,268653568
.long 592896,663552,18432,36864,4608,1152,67196928,268572672
.long 534528,144,4608,9216,1152,18432,10394112,1073742848
.long 738304,1152,147456,294912,9216,36864,9800704,137216
.long 41856,82944,4608,9216,1152,20736,9077760,537089024
.long 592896,663552,18432,36864,4608,1152,67197952,268572672
.long 74240,1152,147456,294912,9216,36864,8922112,218112
.long 3392512,1152,147456,294912,9216,36864,9833472,137216
.long 369664,663552,18432,36864,4608,73728,9110528,268653568
.long 148096,663552,18432,36864,4608,73728,9872384,268572672
.long 165888,144,4608,9216,1152,18432,10352640,805307392
.long 2654464,1152,147456,294912,9216,36864,8955904,218112
.long 2304,663552,18432,36864,4608,73728,9013248,268653568
.long 518912,663552,18432,36864,4608,1152,9905152,268572672
.long 0,144,4608,9216,1152,18432,10334208,1073742848
.long 4645376,1152,147456,294912,9216,36864,8988672,218112
.long 368640,663552,18432,36864,4608,73728,9046016,268653568
.long 592896,663552,18432,36864,4608,1152,67201024,268572672
.long 580608,144,4608,9216,1152,18432,10398720,1073742848
.long 1327744,1152,147456,294912,9216,36864,9801728,137216
.long 18432,82944,1152,0,20736,128,9078784,537089024
.long 592896,663552,18432,36864,4608,1152,67202048,268572672
.long 663552,1152,147456,294912,9216,36864,8923136,218112
.long 3981952,1152,147456,294912,9216,36864,9834496,137216
.long 370688,663552,18432,36864,4608,73728,9111552,268653568
.long 148224,663552,18432,36864,4608,73728,9873408,268572672
.long 202752,144,4608,9216,1152,18432,10357248,805307392
.long 2654592,1152,147456,294912,9216,36864,8956928,218112
.long 2432,663552,18432,36864,4608,73728,9014272,268653568
.long 519040,663552,18432,36864,4608,1152,9906176,268572672
.long 36864,144,4608,9216,1152,18432,10338816,1073742848
.long 4718592,1152,147456,294912,9216,36864,8989696,218112
.long 368768,663552,18432,36864,4608,73728,9047040,268653568
.long 592896,663552,18432,36864,4608,1152,67205120,268572672
.long 617472,144,4608,9216,1152,18432,10403328,1073742848
.long 1327872,1152,147456,294912,9216,36864,9802752,137216
.long 18688,82944,1152,0,20736,128,9079808,537089024
.long 592896,663552,18432,36864,4608,1152,67206144,268572672
.long 663680,1152,147456,294912,9216,36864,8924160,218112
.long 3982080,1152,147456,294912,9216,36864,9835520,137216
.long 370816,663552,18432,36864,4608,73728,9112576,268653568
.long 149120,663552,18432,36864,4608,73728,9874432,268572672
.long 248832,144,4608,9216,1152,18432,10361856,805307392
.long 2654720,1152,147456,294912,9216,36864,8957952,218112
.long 2560,663552,18432,36864,4608,73728,9015296,268653568
.long 519168,663552,18432,36864,4608,1152,9907200,268572672
.long 82944,144,4608,9216,1152,18432,10343424,1073742848
.long 4718720,1152,147456,294912,9216,36864,8990720,218112
.long 368896,663552,18432,36864,4608,73728,9048064,268653568
.long 592896,663552,18432,36864,4608,1152,67209216,268572672
.long 73728,144,4608,82944,1152,165888,10407936,1073742848
.long 1328000,1152,147456,294912,9216,36864,9803776,137216
.long 589824,663552,18432,36864,4608,1152,9080832,268653568
.long 592896,663552,18432,36864,4608,1152,67210240,268572672
.long 663808,1152,147456,294912,9216,36864,8925184,218112
.long 3982208,1152,147456,294912,9216,36864,9836544,137216
.long 371840,663552,18432,36864,4608,73728,9113600,268653568
.long 149248,663552,18432,36864,4608,73728,9875456,268572672
.long 285696,144,4608,9216,1152,18432,10366464,805307392
.long 2727936,1152,147456,294912,9216,36864,8958976,218112
.long 2688,663552,18432,36864,4608,73728,9016320,268653568
.long 512,82944,4608,9216,1152,20736,9908224,537008128
.long 119808,144,4608,9216,1152,18432,10348032,1073742848
.long 4718848,1152,147456,294912,9216,36864,8991744,218112
.long 369024,663552,18432,36864,4608,73728,9049088,268653568
.long 592896,663552,18432,36864,4608,1152,67213312,268572672
.long 405504,144,4608,82944,1152,165888,10412544,1073742848
.long 1328128,1152,147456,294912,9216,36864,9804800,137216
.long 589952,663552,18432,36864,4608,1152,9081856,268653568
.long 592896,663552,18432,36864,4608,1152,67214336,268572672
.long 663936,1152,147456,294912,9216,36864,8926208,218112
.long 3982336,1152,147456,294912,9216,36864,9837568,137216
.long 371968,663552,18432,36864,4608,73728,9114624,268653568
.long 149376,663552,18432,36864,4608,73728,9876480,268572672
.long 331776,144,4608,9216,1152,18432,10371072,805307392
.long 2728064,1152,147456,294912,9216,36864,8960000,218112
.long 3456,663552,18432,36864,4608,73728,9017344,268653568
.long 640,82944,4608,9216,1152,20736,9909248,537008128
.long 165888,144,4608,9216,1152,18432,10352640,1073742848
.long 4718976,1152,147456,294912,9216,36864,8992768,218112
.long 369792,663552,18432,36864,4608,73728,9050112,268653568
.long 592896,663552,18432,36864,4608,1152,67217408,268572672
.long 0,1152,147456,294912,9216,36864,8912896,218112
.long 1401472,1152,147456,294912,9216,36864,9805824,137216
.long 590080,663552,18432,36864,4608,1152,9082880,268653568
.long 592896,663552,18432,36864,4608,1152,67218432,268572672
.long 664064,1152,147456,294912,9216,36864,8927232,218112
.long 4055680,1152,147456,294912,9216,36864,9838592,137216
.long 372992,663552,18432,36864,4608,73728,9115648,268653568
.long 150272,663552,18432,36864,4608,73728,9877504,268572672
.long 368640,144,4608,9216,1152,18432,10375680,805307392
.long 2728192,1152,147456,294912,9216,36864,8961024,218112
.long 3584,663552,18432,36864,4608,73728,9018368,268653568
.long 768,82944,4608,9216,1152,20736,9910272,537008128
.long 202752,144,4608,9216,1152,18432,10357248,1073742848
.long 4719104,1152,147456,294912,9216,36864,8993792,218112
.long 369920,663552,18432,36864,4608,73728,9051136,268653568
.long 592896,663552,18432,36864,4608,1152,67221504,268572672
.long 128,1152,147456,294912,9216,36864,8913920,218112
.long 1401600,1152,147456,294912,9216,36864,9806848,137216
.long 590208,663552,18432,36864,4608,1152,9083904,268653568
.long 592896,663552,18432,36864,4608,1152,67222528,268572672
.long 737280,1152,147456,294912,9216,36864,8928256,218112
.long 4055808,1152,147456,294912,9216,36864,9839616,137216
.long 373120,663552,18432,36864,4608,73728,9116672,268653568
.long 150400,663552,18432,36864,4608,73728,9878528,268572672
.long 414720,144,4608,9216,1152,18432,10380288,805307392
.long 2728320,1152,147456,294912,9216,36864,8962048,218112
.long 3712,663552,18432,36864,4608,73728,9019392,268653568
.long 41984,82944,4608,9216,1152,20736,9911296,537008128
.long 248832,144,4608,9216,1152,18432,10361856,1073742848
.long 589824,1152,36864,663552,9216,1327104,8994816,218112
.long 370048,663552,18432,36864,4608,73728,9052160,268653568
.long 592896,663552,18432,36864,4608,1152,67225600,268572672
.long 256,1152,147456,294912,9216,36864,8914944,218112
.long 1401728,1152,147456,294912,9216,36864,9807872,137216
.long 592128,663552,18432,36864,4608,1152,9084928,268653568
.long 592896,663552,18432,36864,4608,1152,67226624,268572672
.long 737408,1152,147456,294912,9216,36864,8929280,218112
.long 4055936,1152,147456,294912,9216,36864,9840640,137216
.long 516992,663552,18432,36864,4608,1152,9117696,268653568
.long 150528,663552,18432,36864,4608,73728,9879552,268572672
.long 451584,144,4608,9216,1152,18432,10384896,805307392
.long 2728448,1152,147456,294912,9216,36864,8963072,218112
.long 3840,663552,18432,36864,4608,73728,9020416,268653568
.long 42112,82944,4608,9216,1152,20736,9912320,537008128
.long 285696,144,4608,9216,1152,18432,10366464,1073742848
.long 589952,1152,36864,663552,9216,1327104,8995840,218112
.long 370176,663552,18432,36864,4608,73728,9053184,268653568
.long 592896,663552,18432,36864,4608,1152,67229696,268572672
.long 384,1152,147456,294912,9216,36864,8915968,218112
.long 1401856,1152,147456,294912,9216,36864,9808896,137216
.long 592256,663552,18432,36864,4608,1152,9085952,268653568
.long 592896,663552,18432,36864,4608,1152,67230720,268572672
.long 737536,1152,147456,294912,9216,36864,8930304,218112
.long 4056064,1152,147456,294912,9216,36864,9841664,137216
.long 517120,663552,18432,36864,4608,1152,9118720,268653568
.long 151424,663552,18432,36864,4608,73728,9880576,268572672
.long 497664,144,4608,9216,1152,18432,10389504,805307392
.long 3317760,1152,147456,294912,9216,36864,8964096,218112
.long 147456,663552,18432,36864,4608,73728,9021440,268653568
.long 42240,82944,4608,9216,1152,20736,9913344,537008128
.long 331776,144,4608,9216,1152,18432,10371072,1073742848
.long 590080,1152,36864,663552,9216,1327104,8996864,218112
.long 370944,663552,18432,36864,4608,73728,9054208,268653568
.long 592896,663552,18432,36864,4608,1152,67233792,268572672
.long 512,1152,147456,294912,9216,36864,8916992,218112
.long 1991296,1152,147456,294912,9216,36864,9809920,137216
.long 592384,663552,18432,36864,4608,1152,9086976,268653568
.long 592896,663552,18432,36864,4608,1152,67234816,268572672
.long 737664,1152,147456,294912,9216,36864,8931328,218112
.long 4645504,1152,147456,294912,9216,36864,9842688,137216
.long 519296,663552,18432,36864,4608,1152,9119744,268653568
.long 151552,663552,18432,36864,4608,73728,9881600,268572672
.long 534528,144,4608,9216,1152,18432,10394112,805307392
.long 3317888,1152,147456,294912,9216,36864,8965120,218112
.long 147584,663552,18432,36864,4608,73728,9022464,268653568
.long 18944,82944,1152,0,20736,128,9914368,537008128
.long 368640,144,4608,9216,1152,18432,10375680,1073742848
.long 590208,1152,36864,663552,9216,1327104,8997888,218112
.long 371072,663552,18432,36864,4608,73728,9055232,268653568
.long 592896,663552,18432,36864,4608,1152,67237888,268572672
.long 73728,1152,147456,294912,9216,36864,8918016,218112
.long 1991424,1152,147456,294912,9216,36864,9810944,137216
.long 592512,663552,18432,36864,4608,1152,9088000,268653568
.long 592896,663552,18432,36864,4608,1152,67238912,268572672
.long 737792,1152,147456,294912,9216,36864,8932352,218112
.long 4645632,1152,147456,294912,9216,36864,9843712,137216
.long 519424,663552,18432,36864,4608,1152,9120768,268653568
.section .rodata,"a"
.p2align 6
.amdhsa_kernel parallel_sum__linear_kernel_hedgehog__mixer_s_mlp__prompt_kernel
  .amdhsa_next_free_vgpr 256
  .amdhsa_next_free_sgpr 102
  .amdhsa_accum_offset 256
  .amdhsa_group_segment_fixed_size 0
  .amdhsa_kernarg_size 96
  .amdhsa_user_sgpr_count 2
  .amdhsa_user_sgpr_kernarg_segment_ptr 1
  .amdhsa_system_sgpr_workgroup_id_x 1
.end_amdhsa_kernel
```
